```python
import torch

def _softmax(x, axis=-1):
    return torch.softmax(x, dim=axis)
def _gelu(x):
    return torch.nn.functional.gelu(x, approximate="tanh")
def _silu(x):
    return torch.nn.functional.silu(x)
def _sigmoid(x):
    return torch.sigmoid(x)
def _layernorm(x, axis=-1, eps=1e-5):
    m = x.mean(dim=axis, keepdim=True)
    v = x.var(dim=axis, keepdim=True, unbiased=False)
    return (x - m) / torch.sqrt(v + eps)
def _scatter_add(tgt, idx, src, axis=0):
    return tgt.clone().index_add_(axis, idx, src)
def _segment_sum(src, seg, n):
    out = torch.zeros((n,) + src.shape[1:], dtype=src.dtype)
    return out.index_add_(0, seg, src)
def _pad(x, pw):
    flat = tuple(v for pair in reversed(pw) for v in pair)
    return torch.nn.functional.pad(x, flat)

kernel_name = 'gated_mix__softmax_full_mha__mixer_s_mlp__prompt'

def setup_inputs():

    _w = (lambda a: (lambda t: t.to(torch.bfloat16) if t.is_floating_point() else t)(torch.as_tensor(a)))
    def _A_setup():
        B, S, D = 1, 2048, 1024
        return {
            "x": _w((lambda *s: torch.randn(*s, dtype=torch.bfloat16) * 0.1)(B, S, D)),
            "wqkv": _w((lambda *s: torch.randn(*s, dtype=torch.bfloat16) * 0.4)(D, 3 * D)),
            "wo": _w((lambda *s: torch.randn(*s, dtype=torch.bfloat16) * 0.4)(D, D)),
        }
    _A_in = _A_setup()

    def _B_setup():
        B, S, D, F = 1, 2048, 1024, 3584
        return {
            "x":  _w((lambda *s: torch.randn(*s, dtype=torch.bfloat16) * 0.1)(B, S, D)),
            "w1": _w((lambda *s: torch.randn(*s, dtype=torch.bfloat16) * 3.2)(D, D) * (D ** -0.5)),
            "w2": _w((lambda *s: torch.randn(*s, dtype=torch.bfloat16) * 3.2)(D, D) * (D ** -0.5)),
            "w3": _w((lambda *s: torch.randn(*s, dtype=torch.bfloat16) * 3.2)(D, F) * (D ** -0.5)),
            "w4": _w((lambda *s: torch.randn(*s, dtype=torch.bfloat16) * 3.2)(F, D) * (F ** -0.5)),
        }
    _B_in = _B_setup()

    return {
        "A_x": _A_in["x"],
        "A_wqkv": _A_in["wqkv"],
        "A_wo": _A_in["wo"],
        "B_x": _B_in["x"],
        "B_w1": _B_in["w1"],
        "B_w2": _B_in["w2"],
        "B_w3": _B_in["w3"],
        "B_w4": _B_in["w4"],
        "gate_w": _w((lambda *s: torch.randn(*s, dtype=torch.bfloat16) * 0.4)(1024) * 16.0),
    }

def reference(A_x, A_wqkv, A_wo, B_x, B_w1, B_w2, B_w3, B_w4, gate_w):
    def _A_ref(x, wqkv, wo):
        B, S, D = x.shape
        H = 32; Dh = D // H
        qkv = (lambda x, *d: x.permute(*d))((x @ wqkv).reshape(B, S, 3, H, Dh), 2, 0, 3, 1, 4)
        q, k, v = qkv[0], qkv[1], qkv[2]
        scale = Dh ** -0.5
        scores = torch.einsum("bhqd,bhkd->bhqk", q, k) * scale
        p = _softmax(scores, axis=-1)
        o = torch.einsum("bhqk,bhkd->bhqd", p, v)
        return (lambda x, *d: x.permute(*d))(o, 0, 2, 1, 3).reshape(B, S, D) @ wo

    def _B_ref(x, w1, w2, w3, w4):
        B, S, D = x.shape
        h = _gelu(_layernorm(x, axis=-1) @ w1)
        c = D // 4
        g0 = _pad(h[:, :, 0*c:1*c], ((0, 0), (1, 0), (0, 0)))[:, :S, :]
        g1 = _pad(h[:, :, 1*c:2*c], ((0, 0), (0, 1), (0, 0)))[:, 1:, :]
        g2 = _pad(h[:, :, 2*c:3*c], ((0, 0), (2, 0), (0, 0)))[:, :S, :]
        g3 = _pad(h[:, :, 3*c:   ], ((0, 0), (0, 2), (0, 0)))[:, 2:, :]
        hs = torch.concatenate([g0, g1, g2, g3], axis=-1) @ w2
        x1 = x + hs
        h2 = _gelu(_layernorm(x1, axis=-1) @ w3) @ w4
        return x1 + h2

    x = A_x
    g = _sigmoid((x * gate_w).sum(-1, keepdims=True))
    a = _A_ref(x, A_wqkv, A_wo)
    b = _B_ref(x, B_w1, B_w2, B_w3, B_w4)
    return g * a + (1 - g) * b
```

```asm
; @launch grid=(256,1,1) block=(512,1,1) lds=163840
.amdgcn_target "amdgcn-amd-amdhsa--gfx950"
.text
.globl gated_mix__softmax_full_mha__mixer_s_mlp__prompt_kernel
.p2align 8
.type gated_mix__softmax_full_mha__mixer_s_mlp__prompt_kernel,@function
gated_mix__softmax_full_mha__mixer_s_mlp__prompt_kernel:
    s_cmp_ge_u32 s2, 256
    s_cbranch_scc1 gated_mix__softmax_full_mha__mixer_s_mlp__prompt_kernel_end
    s_load_dwordx16 s[64:79], s[0:1], 0
    s_load_dwordx8 s[80:87], s[0:1], 64
    s_lshr_b32 s28, s2, 3
    s_getpc_b64 s[4:5]
gated_mix__softmax_full_mha__mixer_s_mlp__prompt_kernel_pc1:
    s_sub_u32 s4, s4, gated_mix__softmax_full_mha__mixer_s_mlp__prompt_kernel_pc1-gated_mix__softmax_full_mha__mixer_s_mlp__prompt_kernel
    s_subb_u32 s5, s5, 0
    s_lshl_b32 s3, s28, 11
    v_lshl_add_u32 v136, v0, 2, s3
    s_mov_b32 s3, gated_mix__softmax_full_mha__mixer_s_mlp__prompt_kernel_end-gated_mix__softmax_full_mha__mixer_s_mlp__prompt_kernel
    v_min_u32 v136, s3, v136
    v_mov_b32 v137, s5
    v_add_co_u32 v136, vcc, s4, v136
    s_nop 1
    v_addc_co_u32 v137, vcc, 0, v137, vcc
    global_load_dword v138, v[136:137], off
    v_lshrrev_b32 v1, 6, v0
    v_and_b32 v0, 63, v0
    v_readfirstlane_b32 s24, v1
    v_lshlrev_b32 v1, 4, v0
    s_and_b32 s27, s2, 7
    s_mov_b32 s32, 0
    s_mov_b32 s34, 0
    s_and_b32 s3, s27, 1
    s_lshl_b32 s3, s3, 3
    s_and_b32 s4, s28, 7
    s_add_u32 s29, s3, s4
    s_lshr_b32 s3, s27, 1
    s_lshl_b32 s3, s3, 2
    s_lshr_b32 s4, s28, 3
    s_add_u32 s30, s3, s4
    s_mov_b32 s39, 4294868992
    s_and_b32 s3, s27, 3
    s_lshl_b32 s3, s3, 2
    s_and_b32 s4, s28, 3
    s_add_u32 s54, s3, s4
    s_lshr_b32 s3, s28, 2
    s_lshl_b32 s3, s3, 1
    s_lshr_b32 s4, s27, 2
    s_add_u32 s55, s3, s4
    s_lshl_b32 s3, s30, 1
    s_and_b32 s4, s28, 1
    s_add_u32 s51, s3, s4
    s_lshr_b32 s41, s29, 1
    s_lshl_b32 s3, s41, 3
    s_add_u32 s52, s3, s24
    s_cmp_lt_u32 s24, 4
    s_cbranch_scc1 gated_mix__softmax_full_mha__mixer_s_mlp__prompt_kernel_G
    s_sub_u32 s25, s24, 4
    v_lshrrev_b32 v128, 3, v0
    v_and_b32 v129, 7, v0
    s_lshl_b32 s3, s41, 8
    s_lshl_b32 s4, s25, 6
    s_add_u32 s3, s3, s4
    v_lshrrev_b32 v130, 1, v128
    v_xor_b32 v130, v130, v129
    v_add_u32 v131, s3, v128
    v_lshlrev_b32 v131, 11, v131
    v_lshl_add_u32 v32, v130, 4, v131
    v_xor_b32 v130, 64, v32
    v_add_u32 v33, 15360, v130
    v_add_u32 v34, 30720, v32
    v_add_u32 v35, 46080, v130
    v_add_u32 v36, 65536, v32
    v_add_u32 v37, 80896, v130
    v_add_u32 v38, 96256, v32
    v_add_u32 v39, 111616, v130
    s_mul_i32 s3, s25, 192
    s_lshl_b32 s4, s51, 6
    v_and_b32 v133, 3, v0
    v_add_u32 v128, s3, v0
    v_add_u32 v128, 0, v128
    v_mul_u32_u24 v129, 0x1556, v128
    v_lshrrev_b32 v129, 16, v129
    v_mul_u32_u24 v130, 12, v129
    v_sub_u32 v130, v128, v130
    v_lshrrev_b32 v131, 2, v130
    v_lshrrev_b32 v132, 2, v129
    v_and_b32 v132, 2, v132
    v_xor_b32 v130, v133, v132
    v_mul_u32_u24 v129, 6144, v129
    v_lshl_add_u32 v129, v131, 11, v129
    v_lshl_add_u32 v129, v130, 4, v129
    v_add_u32 v40, s4, v129
    s_sub_u32 s4, s4, 1024
    v_add_u32 v128, s3, v0
    v_add_u32 v128, 64, v128
    v_mul_u32_u24 v129, 0x1556, v128
    v_lshrrev_b32 v129, 16, v129
    v_mul_u32_u24 v130, 12, v129
    v_sub_u32 v130, v128, v130
    v_lshrrev_b32 v131, 2, v130
    v_lshrrev_b32 v132, 2, v129
    v_and_b32 v132, 2, v132
    v_xor_b32 v130, v133, v132
    v_mul_u32_u24 v129, 6144, v129
    v_lshl_add_u32 v129, v131, 11, v129
    v_lshl_add_u32 v129, v130, 4, v129
    v_add_u32 v41, s4, v129
    s_sub_u32 s4, s4, 1024
    v_add_u32 v128, s3, v0
    v_add_u32 v128, 128, v128
    v_mul_u32_u24 v129, 0x1556, v128
    v_lshrrev_b32 v129, 16, v129
    v_mul_u32_u24 v130, 12, v129
    v_sub_u32 v130, v128, v130
    v_lshrrev_b32 v131, 2, v130
    v_lshrrev_b32 v132, 2, v129
    v_and_b32 v132, 2, v132
    v_xor_b32 v130, v133, v132
    v_mul_u32_u24 v129, 6144, v129
    v_lshl_add_u32 v129, v131, 11, v129
    v_lshl_add_u32 v129, v130, 4, v129
    v_add_u32 v42, s4, v129
    s_sub_u32 s4, s4, 1024
    v_lshrrev_b32 v128, 2, v0
    v_lshrrev_b32 v129, 4, v0
    v_and_b32 v129, 2, v129
    v_xor_b32 v129, v133, v129
    s_lshl_b32 s3, s25, 4
    v_add_u32 v128, s3, v128
    v_lshlrev_b32 v128, 11, v128
    v_lshl_add_u32 v128, v129, 4, v128
    s_add_u32 s63, s51, 2
    s_and_b32 s63, s63, 31
    s_lshr_b32 s100, s63, 1
    s_lshl_b32 s4, s63, 6
    v_add_u32 v43, s4, v128
    s_lshl_b32 s37, s25, 13
    s_mul_i32 s38, s25, 3072
    s_add_u32 s38, s38, 32768
    s_lshl_b32 s50, s25, 10
    s_add_u32 s50, s50, 45056
    s_mov_b32 s35, 0
    s_mov_b32 s36, 0
    s_mov_b32 s53, 0
    s_waitcnt lgkmcnt(0)
    s_mov_b32 s8, s64
    s_mov_b32 s9, s65
    s_mov_b32 s10, 4194304
    s_mov_b32 s11, 0x20000
    s_mov_b32 s12, s66
    s_mov_b32 s13, s67
    s_mov_b32 s14, 6291456
    s_mov_b32 s15, 0x20000
    s_mov_b32 s44, s72
    s_mov_b32 s45, s73
    s_mov_b32 s46, 2097152
    s_mov_b32 s47, 0x20000
    s_or_b32 s4, s30, 3
    s_lshr_b32 s3, s66, 7
    s_add_u32 s3, s3, s4
    s_and_b32 s3, s3, 7
    s_lshl_b32 s4, s4, 7
    s_lshr_b32 s5, s28, 3
    s_lshl_b32 s6, s5, 11
    s_add_u32 s4, s4, s6
    s_and_b32 s6, s28, 7
    s_lshl_b32 s6, s6, 2
    s_add_u32 s6, s6, s25
    s_mul_i32 s6, s6, 12288
    s_add_u32 s4, s4, s6
    s_add_u32 s4, s4, 393216
    s_cmp_eq_u32 s3, 3
    s_cselect_b32 s3, 16, 0
    s_cmp_eq_u32 s5, 3
    s_cselect_b32 s3, 0, s3
    s_cmp_eq_u32 s3, 0
    s_cselect_b32 s99, 0x40000000, s4
    s_add_u32 s3, s99, 0
    s_min_u32 s3, s3, 6283264
    s_buffer_load_dword s98, s[12:15], s3 offset:0x0
    s_buffer_load_dword s98, s[12:15], s3 offset:0x40
    s_buffer_load_dword s98, s[12:15], s3 offset:0x1800
    s_buffer_load_dword s98, s[12:15], s3 offset:0x1840
    s_add_u32 s3, s99, 393216
    s_min_u32 s3, s3, 6283264
    s_buffer_load_dword s98, s[12:15], s3 offset:0x0
    s_buffer_load_dword s98, s[12:15], s3 offset:0x40
    s_buffer_load_dword s98, s[12:15], s3 offset:0x1800
    s_buffer_load_dword s98, s[12:15], s3 offset:0x1840
    s_add_u32 s3, s99, 786432
    s_min_u32 s3, s3, 6283264
    s_buffer_load_dword s98, s[12:15], s3 offset:0x0
    s_buffer_load_dword s98, s[12:15], s3 offset:0x40
    s_buffer_load_dword s98, s[12:15], s3 offset:0x1800
    s_buffer_load_dword s98, s[12:15], s3 offset:0x1840
    s_add_u32 m0, s34, s50
    s_nop 0
    buffer_load_dwordx4 v43, s[44:47], s53 offen lds
    s_add_u32 s53, s53, 131072
    s_add_u32 m0, s34, s37
    s_nop 0
    buffer_load_dwordx4 v32, s[8:11], s35 offen offset:0  lds
    buffer_load_dwordx4 v33, s[8:11], s35 offen offset:1024  lds
    buffer_load_dwordx4 v34, s[8:11], s35 offen offset:2048  lds
    buffer_load_dwordx4 v35, s[8:11], s35 offen offset:3072  lds
    s_add_u32 m0, m0, 4096
    s_nop 0
    buffer_load_dwordx4 v36, s[8:11], s35 offen offset:0  lds
    buffer_load_dwordx4 v37, s[8:11], s35 offen offset:1024  lds
    buffer_load_dwordx4 v38, s[8:11], s35 offen offset:2048  lds
    buffer_load_dwordx4 v39, s[8:11], s35 offen offset:3072  lds
    s_add_u32 m0, s34, s38
    s_nop 0
    buffer_load_dwordx4 v40, s[12:15], s36 offen offset:0  lds
    buffer_load_dwordx4 v41, s[12:15], s36 offen offset:1024  lds
    buffer_load_dwordx4 v42, s[12:15], s36 offen offset:2048  lds
    s_add_u32 s35, s35, 128
    s_add_u32 s36, s36, 393216
    s_add_u32 s34, s34, 49152
    s_cmp_eq_u32 s34, 147456
    s_cselect_b32 s34, 0, s34
    s_add_u32 m0, s34, s50
    s_nop 0
    buffer_load_dwordx4 v43, s[44:47], s53 offen lds
    s_add_u32 s53, s53, 131072
    s_add_u32 m0, s34, s37
    s_nop 0
    buffer_load_dwordx4 v32, s[8:11], s35 offen offset:0  lds
    buffer_load_dwordx4 v33, s[8:11], s35 offen offset:1024  lds
    buffer_load_dwordx4 v34, s[8:11], s35 offen offset:2048  lds
    buffer_load_dwordx4 v35, s[8:11], s35 offen offset:3072  lds
    s_add_u32 m0, m0, 4096
    s_nop 0
    buffer_load_dwordx4 v36, s[8:11], s35 offen offset:0  lds
    buffer_load_dwordx4 v37, s[8:11], s35 offen offset:1024  lds
    buffer_load_dwordx4 v38, s[8:11], s35 offen offset:2048  lds
    buffer_load_dwordx4 v39, s[8:11], s35 offen offset:3072  lds
    s_add_u32 m0, s34, s38
    s_nop 0
    buffer_load_dwordx4 v40, s[12:15], s36 offen offset:0  lds
    buffer_load_dwordx4 v41, s[12:15], s36 offen offset:1024  lds
    buffer_load_dwordx4 v42, s[12:15], s36 offen offset:2048  lds
    s_add_u32 s35, s35, 128
    s_add_u32 s36, s36, 393216
    s_add_u32 s34, s34, 49152
    s_cmp_eq_u32 s34, 147456
    s_cselect_b32 s34, 0, s34
    s_mov_b32 s16, s86
    s_mov_b32 s17, s87
    s_mov_b32 s18, 62914560
    s_mov_b32 s19, 0x20000
    s_mov_b32 s88, s84
    s_mov_b32 s89, s85
    s_mov_b32 s90, 256
    s_mov_b32 s91, 0x20000
    s_waitcnt vmcnt(12)
    s_barrier
    s_mov_b32 s62, 0
    s_add_u32 m0, s34, s50
    s_nop 0
    buffer_load_dwordx4 v43, s[44:47], s53 offen lds
    s_add_u32 s53, s53, 131072
    s_add_u32 m0, s34, s37
    s_nop 0
    buffer_load_dwordx4 v32, s[8:11], s35 offen offset:0  lds
    buffer_load_dwordx4 v33, s[8:11], s35 offen offset:1024  lds
    buffer_load_dwordx4 v34, s[8:11], s35 offen offset:2048  lds
    buffer_load_dwordx4 v35, s[8:11], s35 offen offset:3072  lds
    s_add_u32 m0, m0, 4096
    s_nop 0
    buffer_load_dwordx4 v36, s[8:11], s35 offen offset:0  lds
    buffer_load_dwordx4 v37, s[8:11], s35 offen offset:1024  lds
    buffer_load_dwordx4 v38, s[8:11], s35 offen offset:2048  lds
    buffer_load_dwordx4 v39, s[8:11], s35 offen offset:3072  lds
    s_add_u32 m0, s34, s38
    s_nop 0
    buffer_load_dwordx4 v40, s[12:15], s36 offen offset:0  lds
    buffer_load_dwordx4 v41, s[12:15], s36 offen offset:1024  lds
    buffer_load_dwordx4 v42, s[12:15], s36 offen offset:2048  lds
    s_add_u32 s35, s35, 128
    s_add_u32 s36, s36, 393216
    s_add_u32 s34, s34, 49152
    s_cmp_eq_u32 s34, 147456
    s_cselect_b32 s34, 0, s34
    s_lshl_b32 s3, s2, 2
    s_and_b32 s4, s24, 3
    s_add_u32 s3, s3, s4
    s_mul_i32 s3, s3, 384
    s_add_u32 s3, s3, 1572864
    s_add_u32 s6, s66, s3
    s_addc_u32 s7, s67, 0
    s_load_dword s98, s[6:7], 0
    s_load_dword s98, s[6:7], 64
    s_load_dword s98, s[6:7], 128
    s_load_dword s98, s[6:7], 192
    s_load_dword s98, s[6:7], 256
    s_load_dword s98, s[6:7], 320
    s_add_u32 s3, s99, s36
    s_min_u32 s3, s3, 6283264
    s_buffer_load_dword s98, s[12:15], s3 offset:0x0
    s_buffer_load_dword s98, s[12:15], s3 offset:0x40
    s_buffer_load_dword s98, s[12:15], s3 offset:0x1800
    s_buffer_load_dword s98, s[12:15], s3 offset:0x1840
    s_waitcnt vmcnt(12)
    s_barrier
    s_add_u32 m0, s34, s50
    s_nop 0
    buffer_load_dwordx4 v43, s[44:47], s53 offen lds
    s_add_u32 s53, s53, 131072
    s_add_u32 m0, s34, s37
    s_nop 0
    buffer_load_dwordx4 v32, s[8:11], s35 offen offset:0  lds
    buffer_load_dwordx4 v33, s[8:11], s35 offen offset:1024  lds
    buffer_load_dwordx4 v34, s[8:11], s35 offen offset:2048  lds
    buffer_load_dwordx4 v35, s[8:11], s35 offen offset:3072  lds
    s_add_u32 m0, m0, 4096
    s_nop 0
    buffer_load_dwordx4 v36, s[8:11], s35 offen offset:0  lds
    buffer_load_dwordx4 v37, s[8:11], s35 offen offset:1024  lds
    buffer_load_dwordx4 v38, s[8:11], s35 offen offset:2048  lds
    buffer_load_dwordx4 v39, s[8:11], s35 offen offset:3072  lds
    s_add_u32 m0, s34, s38
    s_nop 0
    buffer_load_dwordx4 v40, s[12:15], s36 offen offset:0  lds
    buffer_load_dwordx4 v41, s[12:15], s36 offen offset:1024  lds
    buffer_load_dwordx4 v42, s[12:15], s36 offen offset:2048  lds
    s_add_u32 s35, s35, 128
    s_add_u32 s36, s36, 393216
    s_add_u32 s34, s34, 49152
    s_cmp_eq_u32 s34, 147456
    s_cselect_b32 s34, 0, s34
    s_lshl_b32 s3, s2, 2
    s_and_b32 s4, s24, 3
    s_add_u32 s3, s3, s4
    s_mul_i32 s3, s3, 384
    s_add_u32 s3, s3, 1966080
    s_add_u32 s6, s66, s3
    s_addc_u32 s7, s67, 0
    s_load_dword s98, s[6:7], 0
    s_load_dword s98, s[6:7], 64
    s_load_dword s98, s[6:7], 128
    s_load_dword s98, s[6:7], 192
    s_load_dword s98, s[6:7], 256
    s_load_dword s98, s[6:7], 320
    s_add_u32 s3, s99, s36
    s_min_u32 s3, s3, 6283264
    s_buffer_load_dword s98, s[12:15], s3 offset:0x0
    s_buffer_load_dword s98, s[12:15], s3 offset:0x40
    s_buffer_load_dword s98, s[12:15], s3 offset:0x1800
    s_buffer_load_dword s98, s[12:15], s3 offset:0x1840
    s_waitcnt vmcnt(12)
    s_barrier
    s_cmp_eq_u32 s25, 0
    s_cbranch_scc0 gated_mix__softmax_full_mha__mixer_s_mlp__prompt_kernel_p12
    v_min_u32 v136, 31, v0
    v_lshlrev_b32 v136, 2, v136
    buffer_load_dword v137, v136, s[88:91], 0 offen sc1
gated_mix__softmax_full_mha__mixer_s_mlp__prompt_kernel_p12:
    s_add_u32 m0, s34, s50
    s_nop 0
    buffer_load_dwordx4 v43, s[44:47], s53 offen lds
    s_add_u32 s53, s53, 131072
    s_add_u32 m0, s34, s37
    s_nop 0
    buffer_load_dwordx4 v32, s[8:11], s35 offen offset:0  lds
    buffer_load_dwordx4 v33, s[8:11], s35 offen offset:1024  lds
    buffer_load_dwordx4 v34, s[8:11], s35 offen offset:2048  lds
    buffer_load_dwordx4 v35, s[8:11], s35 offen offset:3072  lds
    s_add_u32 m0, m0, 4096
    s_nop 0
    buffer_load_dwordx4 v36, s[8:11], s35 offen offset:0  lds
    buffer_load_dwordx4 v37, s[8:11], s35 offen offset:1024  lds
    buffer_load_dwordx4 v38, s[8:11], s35 offen offset:2048  lds
    buffer_load_dwordx4 v39, s[8:11], s35 offen offset:3072  lds
    s_add_u32 m0, s34, s38
    s_nop 0
    buffer_load_dwordx4 v40, s[12:15], s36 offen offset:0  lds
    buffer_load_dwordx4 v41, s[12:15], s36 offen offset:1024  lds
    buffer_load_dwordx4 v42, s[12:15], s36 offen offset:2048  lds
    s_add_u32 s35, s35, 128
    s_add_u32 s36, s36, 393216
    s_add_u32 s34, s34, 49152
    s_cmp_eq_u32 s34, 147456
    s_cselect_b32 s34, 0, s34
    s_lshl_b32 s3, s2, 2
    s_and_b32 s4, s24, 3
    s_add_u32 s3, s3, s4
    s_mul_i32 s3, s3, 384
    s_add_u32 s3, s3, 2359296
    s_add_u32 s6, s66, s3
    s_addc_u32 s7, s67, 0
    s_load_dword s98, s[6:7], 0
    s_load_dword s98, s[6:7], 64
    s_load_dword s98, s[6:7], 128
    s_load_dword s98, s[6:7], 192
    s_load_dword s98, s[6:7], 256
    s_load_dword s98, s[6:7], 320
    s_add_u32 s3, s99, s36
    s_min_u32 s3, s3, 6283264
    s_buffer_load_dword s98, s[12:15], s3 offset:0x0
    s_buffer_load_dword s98, s[12:15], s3 offset:0x40
    s_buffer_load_dword s98, s[12:15], s3 offset:0x1800
    s_buffer_load_dword s98, s[12:15], s3 offset:0x1840
    s_waitcnt vmcnt(12)
    s_cmp_eq_u32 s25, 0
    s_cbranch_scc0 gated_mix__softmax_full_mha__mixer_s_mlp__prompt_kernel_c13
    s_mov_b32 s5, 100000
gated_mix__softmax_full_mha__mixer_s_mlp__prompt_kernel_poll4:
    v_cmp_eq_u32 vcc, 0, v137
    s_nop 4
    s_cbranch_vccz gated_mix__softmax_full_mha__mixer_s_mlp__prompt_kernel_pollx5
    s_sub_u32 s5, s5, 1
    s_cmp_eq_u32 s5, 0
    s_cbranch_scc1 gated_mix__softmax_full_mha__mixer_s_mlp__prompt_kernel_pollx5
    s_sleep 4
    s_mov_b64 exec, vcc
    buffer_load_dword v137, v136, s[88:91], 0 offen sc1
    s_mov_b64 exec, -1
    s_waitcnt vmcnt(0)
    s_branch gated_mix__softmax_full_mha__mixer_s_mlp__prompt_kernel_poll4
gated_mix__softmax_full_mha__mixer_s_mlp__prompt_kernel_pollx5:
gated_mix__softmax_full_mha__mixer_s_mlp__prompt_kernel_c13:
    s_barrier
    s_add_u32 m0, s34, s50
    s_nop 0
    buffer_load_dwordx4 v43, s[44:47], s53 offen lds
    s_add_u32 s53, s53, 131072
    s_add_u32 m0, s34, s37
    s_nop 0
    buffer_load_dwordx4 v32, s[8:11], s35 offen offset:0  lds
    buffer_load_dwordx4 v33, s[8:11], s35 offen offset:1024  lds
    buffer_load_dwordx4 v34, s[8:11], s35 offen offset:2048  lds
    buffer_load_dwordx4 v35, s[8:11], s35 offen offset:3072  lds
    s_add_u32 m0, m0, 4096
    s_nop 0
    buffer_load_dwordx4 v36, s[8:11], s35 offen offset:0  lds
    buffer_load_dwordx4 v37, s[8:11], s35 offen offset:1024  lds
    buffer_load_dwordx4 v38, s[8:11], s35 offen offset:2048  lds
    buffer_load_dwordx4 v39, s[8:11], s35 offen offset:3072  lds
    s_add_u32 m0, s34, s38
    s_nop 0
    buffer_load_dwordx4 v40, s[12:15], s36 offen offset:0  lds
    buffer_load_dwordx4 v41, s[12:15], s36 offen offset:1024  lds
    buffer_load_dwordx4 v42, s[12:15], s36 offen offset:2048  lds
    s_add_u32 s35, s35, 128
    s_add_u32 s36, s36, 393216
    s_add_u32 s34, s34, 49152
    s_cmp_eq_u32 s34, 147456
    s_cselect_b32 s34, 0, s34
    s_lshl_b32 s3, s2, 2
    s_and_b32 s4, s24, 3
    s_add_u32 s3, s3, s4
    s_mul_i32 s3, s3, 384
    s_add_u32 s3, s3, 2752512
    s_add_u32 s6, s66, s3
    s_addc_u32 s7, s67, 0
    s_load_dword s98, s[6:7], 0
    s_load_dword s98, s[6:7], 64
    s_load_dword s98, s[6:7], 128
    s_load_dword s98, s[6:7], 192
    s_load_dword s98, s[6:7], 256
    s_load_dword s98, s[6:7], 320
    s_add_u32 s3, s99, s36
    s_min_u32 s3, s3, 6283264
    s_buffer_load_dword s98, s[12:15], s3 offset:0x0
    s_buffer_load_dword s98, s[12:15], s3 offset:0x40
    s_buffer_load_dword s98, s[12:15], s3 offset:0x1800
    s_buffer_load_dword s98, s[12:15], s3 offset:0x1840
    s_waitcnt vmcnt(12)
    s_barrier
    s_add_u32 m0, s34, s50
    s_nop 0
    buffer_load_dwordx4 v43, s[44:47], s53 offen lds
    s_add_u32 s53, s53, 131072
    s_add_u32 m0, s34, s37
    s_nop 0
    buffer_load_dwordx4 v32, s[8:11], s35 offen offset:0  lds
    buffer_load_dwordx4 v33, s[8:11], s35 offen offset:1024  lds
    buffer_load_dwordx4 v34, s[8:11], s35 offen offset:2048  lds
    buffer_load_dwordx4 v35, s[8:11], s35 offen offset:3072  lds
    s_add_u32 m0, m0, 4096
    s_nop 0
    buffer_load_dwordx4 v36, s[8:11], s35 offen offset:0  lds
    buffer_load_dwordx4 v37, s[8:11], s35 offen offset:1024  lds
    buffer_load_dwordx4 v38, s[8:11], s35 offen offset:2048  lds
    buffer_load_dwordx4 v39, s[8:11], s35 offen offset:3072  lds
    s_add_u32 m0, s34, s38
    s_nop 0
    buffer_load_dwordx4 v40, s[12:15], s36 offen offset:0  lds
    buffer_load_dwordx4 v41, s[12:15], s36 offen offset:1024  lds
    buffer_load_dwordx4 v42, s[12:15], s36 offen offset:2048  lds
    s_add_u32 s35, s35, 128
    s_add_u32 s36, s36, 393216
    s_add_u32 s34, s34, 49152
    s_cmp_eq_u32 s34, 147456
    s_cselect_b32 s34, 0, s34
    s_lshl_b32 s3, s2, 2
    s_and_b32 s4, s24, 3
    s_add_u32 s3, s3, s4
    s_mul_i32 s3, s3, 384
    s_add_u32 s3, s3, 3145728
    s_add_u32 s6, s66, s3
    s_addc_u32 s7, s67, 0
    s_load_dword s98, s[6:7], 0
    s_load_dword s98, s[6:7], 64
    s_load_dword s98, s[6:7], 128
    s_load_dword s98, s[6:7], 192
    s_load_dword s98, s[6:7], 256
    s_load_dword s98, s[6:7], 320
    s_add_u32 s3, s99, s36
    s_min_u32 s3, s3, 6283264
    s_buffer_load_dword s98, s[12:15], s3 offset:0x0
    s_buffer_load_dword s98, s[12:15], s3 offset:0x40
    s_buffer_load_dword s98, s[12:15], s3 offset:0x1800
    s_buffer_load_dword s98, s[12:15], s3 offset:0x1840
    s_waitcnt vmcnt(12)
    s_barrier
    s_add_u32 m0, s34, s50
    s_nop 0
    buffer_load_dwordx4 v43, s[44:47], s53 offen lds
    s_add_u32 s53, s53, 131072
    s_add_u32 m0, s34, s37
    s_nop 0
    buffer_load_dwordx4 v32, s[8:11], s35 offen offset:0  lds
    buffer_load_dwordx4 v33, s[8:11], s35 offen offset:1024  lds
    buffer_load_dwordx4 v34, s[8:11], s35 offen offset:2048  lds
    buffer_load_dwordx4 v35, s[8:11], s35 offen offset:3072  lds
    s_add_u32 m0, m0, 4096
    s_nop 0
    buffer_load_dwordx4 v36, s[8:11], s35 offen offset:0  lds
    buffer_load_dwordx4 v37, s[8:11], s35 offen offset:1024  lds
    buffer_load_dwordx4 v38, s[8:11], s35 offen offset:2048  lds
    buffer_load_dwordx4 v39, s[8:11], s35 offen offset:3072  lds
    s_add_u32 m0, s34, s38
    s_nop 0
    buffer_load_dwordx4 v40, s[12:15], s36 offen offset:0  lds
    buffer_load_dwordx4 v41, s[12:15], s36 offen offset:1024  lds
    buffer_load_dwordx4 v42, s[12:15], s36 offen offset:2048  lds
    s_add_u32 s35, s35, 128
    s_add_u32 s36, s36, 393216
    s_add_u32 s34, s34, 49152
    s_cmp_eq_u32 s34, 147456
    s_cselect_b32 s34, 0, s34
    s_lshl_b32 s3, s2, 2
    s_and_b32 s4, s24, 3
    s_add_u32 s3, s3, s4
    s_mul_i32 s3, s3, 384
    s_add_u32 s3, s3, 3538944
    s_add_u32 s6, s66, s3
    s_addc_u32 s7, s67, 0
    s_load_dword s98, s[6:7], 0
    s_load_dword s98, s[6:7], 64
    s_load_dword s98, s[6:7], 128
    s_load_dword s98, s[6:7], 192
    s_load_dword s98, s[6:7], 256
    s_load_dword s98, s[6:7], 320
    s_add_u32 s3, s99, s36
    s_min_u32 s3, s3, 6283264
    s_buffer_load_dword s98, s[12:15], s3 offset:0x0
    s_buffer_load_dword s98, s[12:15], s3 offset:0x40
    s_buffer_load_dword s98, s[12:15], s3 offset:0x1800
    s_buffer_load_dword s98, s[12:15], s3 offset:0x1840
    s_waitcnt vmcnt(12)
    s_barrier
    s_add_u32 m0, s34, s50
    s_nop 0
    buffer_load_dwordx4 v43, s[44:47], s53 offen lds
    s_add_u32 s53, s53, 131072
    s_add_u32 m0, s34, s37
    s_nop 0
    buffer_load_dwordx4 v32, s[8:11], s35 offen offset:0  lds
    buffer_load_dwordx4 v33, s[8:11], s35 offen offset:1024  lds
    buffer_load_dwordx4 v34, s[8:11], s35 offen offset:2048  lds
    buffer_load_dwordx4 v35, s[8:11], s35 offen offset:3072  lds
    s_add_u32 m0, m0, 4096
    s_nop 0
    buffer_load_dwordx4 v36, s[8:11], s35 offen offset:0  lds
    buffer_load_dwordx4 v37, s[8:11], s35 offen offset:1024  lds
    buffer_load_dwordx4 v38, s[8:11], s35 offen offset:2048  lds
    buffer_load_dwordx4 v39, s[8:11], s35 offen offset:3072  lds
    s_add_u32 m0, s34, s38
    s_nop 0
    buffer_load_dwordx4 v40, s[12:15], s36 offen offset:0  lds
    buffer_load_dwordx4 v41, s[12:15], s36 offen offset:1024  lds
    buffer_load_dwordx4 v42, s[12:15], s36 offen offset:2048  lds
    s_add_u32 s35, s35, 128
    s_add_u32 s36, s36, 393216
    s_add_u32 s34, s34, 49152
    s_cmp_eq_u32 s34, 147456
    s_cselect_b32 s34, 0, s34
    s_lshl_b32 s3, s2, 2
    s_and_b32 s4, s24, 3
    s_add_u32 s3, s3, s4
    s_mul_i32 s3, s3, 384
    s_add_u32 s3, s3, 3932160
    s_add_u32 s6, s66, s3
    s_addc_u32 s7, s67, 0
    s_load_dword s98, s[6:7], 0
    s_load_dword s98, s[6:7], 64
    s_load_dword s98, s[6:7], 128
    s_load_dword s98, s[6:7], 192
    s_load_dword s98, s[6:7], 256
    s_load_dword s98, s[6:7], 320
    s_add_u32 s3, s99, s36
    s_min_u32 s3, s3, 6283264
    s_buffer_load_dword s98, s[12:15], s3 offset:0x0
    s_buffer_load_dword s98, s[12:15], s3 offset:0x40
    s_buffer_load_dword s98, s[12:15], s3 offset:0x1800
    s_buffer_load_dword s98, s[12:15], s3 offset:0x1840
    s_waitcnt vmcnt(12)
    s_barrier
    s_add_u32 m0, s34, s50
    s_nop 0
    buffer_load_dwordx4 v43, s[44:47], s53 offen lds
    s_add_u32 s53, s53, 131072
    s_add_u32 m0, s34, s37
    s_nop 0
    buffer_load_dwordx4 v32, s[8:11], s35 offen offset:0  lds
    buffer_load_dwordx4 v33, s[8:11], s35 offen offset:1024  lds
    buffer_load_dwordx4 v34, s[8:11], s35 offen offset:2048  lds
    buffer_load_dwordx4 v35, s[8:11], s35 offen offset:3072  lds
    s_add_u32 m0, m0, 4096
    s_nop 0
    buffer_load_dwordx4 v36, s[8:11], s35 offen offset:0  lds
    buffer_load_dwordx4 v37, s[8:11], s35 offen offset:1024  lds
    buffer_load_dwordx4 v38, s[8:11], s35 offen offset:2048  lds
    buffer_load_dwordx4 v39, s[8:11], s35 offen offset:3072  lds
    s_add_u32 m0, s34, s38
    s_nop 0
    buffer_load_dwordx4 v40, s[12:15], s36 offen offset:0  lds
    buffer_load_dwordx4 v41, s[12:15], s36 offen offset:1024  lds
    buffer_load_dwordx4 v42, s[12:15], s36 offen offset:2048  lds
    s_add_u32 s35, s35, 128
    s_add_u32 s36, s36, 393216
    s_add_u32 s34, s34, 49152
    s_cmp_eq_u32 s34, 147456
    s_cselect_b32 s34, 0, s34
    s_lshl_b32 s3, s2, 2
    s_and_b32 s4, s24, 3
    s_add_u32 s3, s3, s4
    s_mul_i32 s3, s3, 384
    s_add_u32 s3, s3, 4325376
    s_add_u32 s6, s66, s3
    s_addc_u32 s7, s67, 0
    s_load_dword s98, s[6:7], 0
    s_load_dword s98, s[6:7], 64
    s_load_dword s98, s[6:7], 128
    s_load_dword s98, s[6:7], 192
    s_load_dword s98, s[6:7], 256
    s_load_dword s98, s[6:7], 320
    s_add_u32 s3, s99, s36
    s_min_u32 s3, s3, 6283264
    s_buffer_load_dword s98, s[12:15], s3 offset:0x0
    s_buffer_load_dword s98, s[12:15], s3 offset:0x40
    s_buffer_load_dword s98, s[12:15], s3 offset:0x1800
    s_buffer_load_dword s98, s[12:15], s3 offset:0x1840
    s_waitcnt vmcnt(12)
    s_barrier
    s_add_u32 m0, s34, s50
    s_nop 0
    buffer_load_dwordx4 v43, s[44:47], s53 offen lds
    s_add_u32 s53, s53, 131072
    s_add_u32 m0, s34, s37
    s_nop 0
    buffer_load_dwordx4 v32, s[8:11], s35 offen offset:0  lds
    buffer_load_dwordx4 v33, s[8:11], s35 offen offset:1024  lds
    buffer_load_dwordx4 v34, s[8:11], s35 offen offset:2048  lds
    buffer_load_dwordx4 v35, s[8:11], s35 offen offset:3072  lds
    s_add_u32 m0, m0, 4096
    s_nop 0
    buffer_load_dwordx4 v36, s[8:11], s35 offen offset:0  lds
    buffer_load_dwordx4 v37, s[8:11], s35 offen offset:1024  lds
    buffer_load_dwordx4 v38, s[8:11], s35 offen offset:2048  lds
    buffer_load_dwordx4 v39, s[8:11], s35 offen offset:3072  lds
    s_add_u32 m0, s34, s38
    s_nop 0
    buffer_load_dwordx4 v40, s[12:15], s36 offen offset:0  lds
    buffer_load_dwordx4 v41, s[12:15], s36 offen offset:1024  lds
    buffer_load_dwordx4 v42, s[12:15], s36 offen offset:2048  lds
    s_add_u32 s35, s35, 128
    s_add_u32 s36, s36, 393216
    s_add_u32 s34, s34, 49152
    s_cmp_eq_u32 s34, 147456
    s_cselect_b32 s34, 0, s34
    s_lshl_b32 s3, s2, 2
    s_and_b32 s4, s24, 3
    s_add_u32 s3, s3, s4
    s_mul_i32 s3, s3, 384
    s_add_u32 s3, s3, 4718592
    s_add_u32 s6, s66, s3
    s_addc_u32 s7, s67, 0
    s_load_dword s98, s[6:7], 0
    s_load_dword s98, s[6:7], 64
    s_load_dword s98, s[6:7], 128
    s_load_dword s98, s[6:7], 192
    s_load_dword s98, s[6:7], 256
    s_load_dword s98, s[6:7], 320
    s_add_u32 s3, s99, s36
    s_min_u32 s3, s3, 6283264
    s_buffer_load_dword s98, s[12:15], s3 offset:0x0
    s_buffer_load_dword s98, s[12:15], s3 offset:0x40
    s_buffer_load_dword s98, s[12:15], s3 offset:0x1800
    s_buffer_load_dword s98, s[12:15], s3 offset:0x1840
    s_waitcnt vmcnt(12)
    s_barrier
    s_add_u32 m0, s34, s50
    s_nop 0
    buffer_load_dwordx4 v43, s[44:47], s53 offen lds
    s_add_u32 s53, s53, 131072
    s_add_u32 m0, s34, s37
    s_nop 0
    buffer_load_dwordx4 v32, s[8:11], s35 offen offset:0  lds
    buffer_load_dwordx4 v33, s[8:11], s35 offen offset:1024  lds
    buffer_load_dwordx4 v34, s[8:11], s35 offen offset:2048  lds
    buffer_load_dwordx4 v35, s[8:11], s35 offen offset:3072  lds
    s_add_u32 m0, m0, 4096
    s_nop 0
    buffer_load_dwordx4 v36, s[8:11], s35 offen offset:0  lds
    buffer_load_dwordx4 v37, s[8:11], s35 offen offset:1024  lds
    buffer_load_dwordx4 v38, s[8:11], s35 offen offset:2048  lds
    buffer_load_dwordx4 v39, s[8:11], s35 offen offset:3072  lds
    s_add_u32 m0, s34, s38
    s_nop 0
    buffer_load_dwordx4 v40, s[12:15], s36 offen offset:0  lds
    buffer_load_dwordx4 v41, s[12:15], s36 offen offset:1024  lds
    buffer_load_dwordx4 v42, s[12:15], s36 offen offset:2048  lds
    s_add_u32 s35, s35, 128
    s_add_u32 s36, s36, 393216
    s_add_u32 s34, s34, 49152
    s_cmp_eq_u32 s34, 147456
    s_cselect_b32 s34, 0, s34
    s_lshl_b32 s3, s2, 2
    s_and_b32 s4, s24, 3
    s_add_u32 s3, s3, s4
    s_mul_i32 s3, s3, 384
    s_add_u32 s3, s3, 5111808
    s_add_u32 s6, s66, s3
    s_addc_u32 s7, s67, 0
    s_load_dword s98, s[6:7], 0
    s_load_dword s98, s[6:7], 64
    s_load_dword s98, s[6:7], 128
    s_load_dword s98, s[6:7], 192
    s_load_dword s98, s[6:7], 256
    s_load_dword s98, s[6:7], 320
    s_add_u32 s3, s99, s36
    s_min_u32 s3, s3, 6283264
    s_buffer_load_dword s98, s[12:15], s3 offset:0x0
    s_buffer_load_dword s98, s[12:15], s3 offset:0x40
    s_buffer_load_dword s98, s[12:15], s3 offset:0x1800
    s_buffer_load_dword s98, s[12:15], s3 offset:0x1840
    s_waitcnt vmcnt(12)
    s_barrier
    s_add_u32 m0, s34, s50
    s_nop 0
    buffer_load_dwordx4 v43, s[44:47], s53 offen lds
    s_add_u32 s53, s53, 131072
    s_add_u32 m0, s34, s37
    s_nop 0
    buffer_load_dwordx4 v32, s[8:11], s35 offen offset:0  lds
    buffer_load_dwordx4 v33, s[8:11], s35 offen offset:1024  lds
    buffer_load_dwordx4 v34, s[8:11], s35 offen offset:2048  lds
    buffer_load_dwordx4 v35, s[8:11], s35 offen offset:3072  lds
    s_add_u32 m0, m0, 4096
    s_nop 0
    buffer_load_dwordx4 v36, s[8:11], s35 offen offset:0  lds
    buffer_load_dwordx4 v37, s[8:11], s35 offen offset:1024  lds
    buffer_load_dwordx4 v38, s[8:11], s35 offen offset:2048  lds
    buffer_load_dwordx4 v39, s[8:11], s35 offen offset:3072  lds
    s_add_u32 m0, s34, s38
    s_nop 0
    buffer_load_dwordx4 v40, s[12:15], s36 offen offset:0  lds
    buffer_load_dwordx4 v41, s[12:15], s36 offen offset:1024  lds
    buffer_load_dwordx4 v42, s[12:15], s36 offen offset:2048  lds
    s_add_u32 s35, s35, 128
    s_add_u32 s36, s36, 393216
    s_add_u32 s34, s34, 49152
    s_cmp_eq_u32 s34, 147456
    s_cselect_b32 s34, 0, s34
    s_lshl_b32 s3, s2, 2
    s_and_b32 s4, s24, 3
    s_add_u32 s3, s3, s4
    s_mul_i32 s3, s3, 384
    s_add_u32 s3, s3, 5505024
    s_add_u32 s6, s66, s3
    s_addc_u32 s7, s67, 0
    s_load_dword s98, s[6:7], 0
    s_load_dword s98, s[6:7], 64
    s_load_dword s98, s[6:7], 128
    s_load_dword s98, s[6:7], 192
    s_load_dword s98, s[6:7], 256
    s_load_dword s98, s[6:7], 320
    s_add_u32 s3, s99, s36
    s_min_u32 s3, s3, 6283264
    s_buffer_load_dword s98, s[12:15], s3 offset:0x0
    s_buffer_load_dword s98, s[12:15], s3 offset:0x40
    s_buffer_load_dword s98, s[12:15], s3 offset:0x1800
    s_buffer_load_dword s98, s[12:15], s3 offset:0x1840
    s_waitcnt vmcnt(12)
    s_barrier
    s_add_u32 m0, s34, s50
    s_nop 0
    buffer_load_dwordx4 v43, s[44:47], s53 offen lds
    s_add_u32 s53, s53, 131072
    s_add_u32 m0, s34, s37
    s_nop 0
    buffer_load_dwordx4 v32, s[8:11], s35 offen offset:0  lds
    buffer_load_dwordx4 v33, s[8:11], s35 offen offset:1024  lds
    buffer_load_dwordx4 v34, s[8:11], s35 offen offset:2048  lds
    buffer_load_dwordx4 v35, s[8:11], s35 offen offset:3072  lds
    s_add_u32 m0, m0, 4096
    s_nop 0
    buffer_load_dwordx4 v36, s[8:11], s35 offen offset:0  lds
    buffer_load_dwordx4 v37, s[8:11], s35 offen offset:1024  lds
    buffer_load_dwordx4 v38, s[8:11], s35 offen offset:2048  lds
    buffer_load_dwordx4 v39, s[8:11], s35 offen offset:3072  lds
    s_add_u32 m0, s34, s38
    s_nop 0
    buffer_load_dwordx4 v40, s[12:15], s36 offen offset:0  lds
    buffer_load_dwordx4 v41, s[12:15], s36 offen offset:1024  lds
    buffer_load_dwordx4 v42, s[12:15], s36 offen offset:2048  lds
    s_add_u32 s35, s35, 128
    s_add_u32 s36, s36, 393216
    s_add_u32 s34, s34, 49152
    s_cmp_eq_u32 s34, 147456
    s_cselect_b32 s34, 0, s34
    s_lshl_b32 s3, s2, 2
    s_and_b32 s4, s24, 3
    s_add_u32 s3, s3, s4
    s_mul_i32 s3, s3, 384
    s_add_u32 s3, s3, 5898240
    s_add_u32 s6, s66, s3
    s_addc_u32 s7, s67, 0
    s_load_dword s98, s[6:7], 0
    s_load_dword s98, s[6:7], 64
    s_load_dword s98, s[6:7], 128
    s_load_dword s98, s[6:7], 192
    s_load_dword s98, s[6:7], 256
    s_load_dword s98, s[6:7], 320
    s_getpc_b64 s[4:5]
gated_mix__softmax_full_mha__mixer_s_mlp__prompt_kernel_pc6:
    s_sub_u32 s4, s4, gated_mix__softmax_full_mha__mixer_s_mlp__prompt_kernel_pc6-gated_mix__softmax_full_mha__mixer_s_mlp__prompt_kernel
    s_subb_u32 s5, s5, 0
    s_lshl_b32 s3, s28, 11
    s_and_b32 s6, s24, 3
    s_lshl_b32 s6, s6, 9
    s_add_u32 s3, s3, s6
    v_lshl_add_u32 v136, v0, 3, s3
    s_mov_b32 s3, gated_mix__softmax_full_mha__mixer_s_mlp__prompt_kernel_end-gated_mix__softmax_full_mha__mixer_s_mlp__prompt_kernel
    v_min_u32 v136, s3, v136
    v_mov_b32 v137, s5
    v_add_co_u32 v136, vcc, s4, v136
    s_nop 1
    v_addc_co_u32 v137, vcc, 0, v137, vcc
    global_load_dword v138, v[136:137], off
    s_add_u32 s3, s99, s36
    s_min_u32 s3, s3, 6283264
    s_buffer_load_dword s98, s[12:15], s3 offset:0x0
    s_buffer_load_dword s98, s[12:15], s3 offset:0x40
    s_buffer_load_dword s98, s[12:15], s3 offset:0x1800
    s_buffer_load_dword s98, s[12:15], s3 offset:0x1840
    s_waitcnt vmcnt(13)
    s_barrier
    s_add_u32 m0, s34, s50
    s_nop 0
    buffer_load_dwordx4 v43, s[44:47], s53 offen lds
    s_add_u32 s53, s53, 131072
    s_add_u32 m0, s34, s37
    s_nop 0
    buffer_load_dwordx4 v32, s[8:11], s35 offen offset:0  lds
    buffer_load_dwordx4 v33, s[8:11], s35 offen offset:1024  lds
    buffer_load_dwordx4 v34, s[8:11], s35 offen offset:2048  lds
    buffer_load_dwordx4 v35, s[8:11], s35 offen offset:3072  lds
    s_add_u32 m0, m0, 4096
    s_nop 0
    buffer_load_dwordx4 v36, s[8:11], s35 offen offset:0  lds
    buffer_load_dwordx4 v37, s[8:11], s35 offen offset:1024  lds
    buffer_load_dwordx4 v38, s[8:11], s35 offen offset:2048  lds
    buffer_load_dwordx4 v39, s[8:11], s35 offen offset:3072  lds
    s_add_u32 m0, s34, s38
    s_nop 0
    buffer_load_dwordx4 v40, s[12:15], s36 offen offset:0  lds
    buffer_load_dwordx4 v41, s[12:15], s36 offen offset:1024  lds
    buffer_load_dwordx4 v42, s[12:15], s36 offen offset:2048  lds
    s_add_u32 s35, s35, 128
    s_add_u32 s36, s36, 393216
    s_add_u32 s34, s34, 49152
    s_cmp_eq_u32 s34, 147456
    s_cselect_b32 s34, 0, s34
    s_add_u32 s3, s99, s36
    s_min_u32 s3, s3, 6283264
    s_buffer_load_dword s98, s[12:15], s3 offset:0x0
    s_buffer_load_dword s98, s[12:15], s3 offset:0x40
    s_buffer_load_dword s98, s[12:15], s3 offset:0x1800
    s_buffer_load_dword s98, s[12:15], s3 offset:0x1840
    s_waitcnt vmcnt(12)
    s_barrier
    s_add_u32 m0, s34, s50
    s_nop 0
    buffer_load_dwordx4 v43, s[44:47], s53 offen lds
    s_add_u32 s53, s53, 131072
    s_add_u32 m0, s34, s37
    s_nop 0
    buffer_load_dwordx4 v32, s[8:11], s35 offen offset:0  lds
    buffer_load_dwordx4 v33, s[8:11], s35 offen offset:1024  lds
    buffer_load_dwordx4 v34, s[8:11], s35 offen offset:2048  lds
    buffer_load_dwordx4 v35, s[8:11], s35 offen offset:3072  lds
    s_add_u32 m0, m0, 4096
    s_nop 0
    buffer_load_dwordx4 v36, s[8:11], s35 offen offset:0  lds
    buffer_load_dwordx4 v37, s[8:11], s35 offen offset:1024  lds
    buffer_load_dwordx4 v38, s[8:11], s35 offen offset:2048  lds
    buffer_load_dwordx4 v39, s[8:11], s35 offen offset:3072  lds
    s_add_u32 m0, s34, s38
    s_nop 0
    buffer_load_dwordx4 v40, s[12:15], s36 offen offset:0  lds
    buffer_load_dwordx4 v41, s[12:15], s36 offen offset:1024  lds
    buffer_load_dwordx4 v42, s[12:15], s36 offen offset:2048  lds
    s_add_u32 s35, s35, 128
    s_add_u32 s36, s36, 393216
    s_add_u32 s34, s34, 49152
    s_cmp_eq_u32 s34, 147456
    s_cselect_b32 s34, 0, s34
    s_add_u32 s3, s99, s36
    s_min_u32 s3, s3, 6283264
    s_buffer_load_dword s98, s[12:15], s3 offset:0x0
    s_buffer_load_dword s98, s[12:15], s3 offset:0x40
    s_buffer_load_dword s98, s[12:15], s3 offset:0x1800
    s_buffer_load_dword s98, s[12:15], s3 offset:0x1840
    s_waitcnt vmcnt(12)
    s_barrier
    v_and_b32 v136, 31, v0
    v_and_b32 v138, 15, v0
    v_lshl_add_u32 v138, v138, 4, s100
    s_lshr_b32 s3, s41, 0
    s_lshl_b32 s3, s3, 5
    v_add_u32 v136, s3, v136
    v_cmp_gt_u32 vcc, 32, v0
    s_nop 1
    v_cndmask_b32 v136, v138, v136, vcc
    v_lshlrev_b32 v136, 7, v136
    s_mov_b32 s40, 45809664
    s_cmp_eq_u32 s25, 0
    s_cselect_b32 s40, s40, 62914560
    buffer_load_dwordx4 v[140:143], v136, s[16:19], s40 offen sc1
    s_lshl_b32 s3, s2, 2
    s_and_b32 s4, s24, 3
    s_add_u32 s3, s3, s4
    s_mov_b32 m0, 158720
    s_mov_b32 s20, s74
    s_mov_b32 s21, s75
    s_mov_b32 s22, 2097152
    s_mov_b32 s23, 0x20000
    s_mul_i32 s5, s3, 2048
    buffer_load_dwordx4 v[160:163], v1, s[20:23], s5 offen
    s_add_u32 s5, s5, 1024
    buffer_load_dwordx4 v[164:167], v1, s[20:23], s5 offen
    s_waitcnt vmcnt(3)
    s_barrier
    s_waitcnt lgkmcnt(0)
    v_mov_b32 v139, 153348
    s_cmp_eq_u32 s24, 4
    s_cbranch_scc0 gated_mix__softmax_full_mha__mixer_s_mlp__prompt_kernel_gw7
    s_mov_b32 s5, 100000
gated_mix__softmax_full_mha__mixer_s_mlp__prompt_kernel_poll10:
    s_waitcnt vmcnt(2)
    v_min3_u32 v137, v140, v141, v142
    v_min_u32 v137, v137, v143
    v_cmp_eq_u32 vcc, 0, v137
    s_nop 4
    s_cbranch_vccz gated_mix__softmax_full_mha__mixer_s_mlp__prompt_kernel_pollx11
    s_sub_u32 s5, s5, 1
    s_cmp_eq_u32 s5, 0
    s_cbranch_scc1 gated_mix__softmax_full_mha__mixer_s_mlp__prompt_kernel_pollx11
    s_sleep 4
    s_mov_b64 exec, vcc
    buffer_load_dwordx4 v[140:143], v136, s[16:19], s40 offen sc1
    s_mov_b64 exec, -1
    s_waitcnt vmcnt(0)
    s_branch gated_mix__softmax_full_mha__mixer_s_mlp__prompt_kernel_poll10
gated_mix__softmax_full_mha__mixer_s_mlp__prompt_kernel_pollx11:
    v_mov_b32 v139, 153348
    v_mov_b32 v137, 1
    ds_write_b32 v139, v137
    s_branch gated_mix__softmax_full_mha__mixer_s_mlp__prompt_kernel_gwe8
gated_mix__softmax_full_mha__mixer_s_mlp__prompt_kernel_gw7:
    s_mov_b32 s5, 1600000
gated_mix__softmax_full_mha__mixer_s_mlp__prompt_kernel_gws9:
    s_sleep 1
    ds_read_b32 v137, v139
    s_sub_u32 s5, s5, 1
    s_cmp_eq_u32 s5, 0
    s_cbranch_scc1 gated_mix__softmax_full_mha__mixer_s_mlp__prompt_kernel_gwe8
    s_waitcnt lgkmcnt(0)
    v_cmp_gt_u32 vcc, 1, v137
    s_nop 4
    s_cbranch_vccnz gated_mix__softmax_full_mha__mixer_s_mlp__prompt_kernel_gws9
gated_mix__softmax_full_mha__mixer_s_mlp__prompt_kernel_gwe8:
    v_lshlrev_b32 v60, 2, v0
    s_lshl_b32 s3, s41, 10
    s_lshl_b32 s4, s25, 8
    s_add_u32 s3, s3, s4
    s_lshl_b32 s3, s3, 2
    s_add_u32 s3, s3, 42991616
    s_add_u32 s4, s4, 147456
    v_add_u32 v58, s4, v60
    buffer_load_dwordx2 v[80:81], v1, s[16:19], s3 offen sc1
    v_lshrrev_b32 v61, 2, v0
    v_and_b32 v62, 3, v0
    v_lshlrev_b32 v61, 8, v61
    v_lshl_add_u32 v61, v62, 4, v61
    s_lshl_b32 s3, s100, 14
    s_lshl_b32 s4, s25, 6
    s_add_u32 s3, s3, s4
    s_add_u32 s3, s3, 45350912
    buffer_load_dwordx4 v[64:67], v61, s[16:19], s3 offen sc1
    s_add_u32 s3, s3, 4096
    buffer_load_dwordx4 v[68:71], v61, s[16:19], s3 offen sc1
    s_add_u32 s3, s3, 4096
    buffer_load_dwordx4 v[72:75], v61, s[16:19], s3 offen sc1
    s_add_u32 s3, s3, 4096
    buffer_load_dwordx4 v[76:79], v61, s[16:19], s3 offen sc1
    s_lshl_b32 s37, s25, 13
    s_lshl_b32 s38, s25, 12
    s_add_u32 s38, s38, 32768
    s_mov_b32 s36, 0
    s_add_u32 s8, s86, 12582912
    s_addc_u32 s9, s87, 0
    s_mov_b32 s10, 4194304
    s_mov_b32 s11, 0x20000
    s_lshl_b32 s3, s54, 3
    s_lshl_b32 s4, s25, 1
    s_add_u32 s3, s3, s4
    s_mul_i32 s3, s3, 32768
    v_add_u32 v32, s3, v1
    v_add_u32 v36, 32768, v32
    s_mov_b32 s35, 0
    s_mov_b32 s12, s74
    s_mov_b32 s13, s75
    s_mov_b32 s14, 2097152
    s_mov_b32 s15, 0x20000
    v_lshrrev_b32 v128, 3, v0
    v_and_b32 v129, 7, v0
    v_and_b32 v130, 6, v128
    v_xor_b32 v129, v129, v130
    s_lshl_b32 s3, s25, 5
    v_add_u32 v128, s3, v128
    v_lshlrev_b32 v128, 11, v128
    v_lshl_add_u32 v128, v129, 4, v128
    s_lshl_b32 s4, s55, 7
    v_add_u32 v40, s4, v128
    v_add_u32 v41, 15360, v40
    v_add_u32 v42, 30720, v40
    v_add_u32 v43, 46080, v40
    s_add_u32 s35, s35, 8192
    s_add_u32 s36, s36, 524288
    s_lshl_b32 s3, s51, 18
    s_add_u32 s3, s3, 4194304
    s_add_u32 s44, s86, s3
    s_addc_u32 s45, s87, 0
    s_mov_b32 s46, 0x40000
    s_mov_b32 s47, 0x20000
    s_lshl_b32 s4, s25, 10
    s_lshl_b32 s100, s41, 15
    s_add_u32 s100, s100, s4
    s_add_u32 s63, s4, 73728
    s_sub_u32 s3, s63, 32768
    s_cmp_ge_u32 s3, s100
    s_cselect_b32 s63, s63, s3
    s_add_u32 s48, s4, 147456
    s_waitcnt vmcnt(8)
    s_barrier
    v_mov_b32 v145, 0x3f803f80
    v_and_b32 v149, 6, v0
    v_cmp_eq_u32 vcc, 0, v149
    s_nop 1
    v_cndmask_b32 v144, 0, v145, vcc
    v_cmp_eq_u32 vcc, 4, v149
    s_nop 1
    v_cndmask_b32 v146, 0, v145, vcc
    v_and_b32 v149, 1, v0
    v_mov_b32 v147, v146
    v_mov_b32 v145, v144
    v_mul_u32_u24 v149, 0xaaaa, v149
    v_add_u32 v149, 0x4444, v149
    v_lshl_or_b32 v149, v149, 16, v149
    v_mov_b32 v120, 0
    v_mov_b32 v121, 0
    v_mov_b32 v122, 0
    v_mov_b32 v123, 0
    v_mov_b32 v124, 0
    v_mov_b32 v125, 0
    v_mov_b32 v126, 0
    v_mov_b32 v127, 0
    v_mov_b32 v116, 0
    v_mov_b32 v117, 0
    v_mov_b32 v118, 0
    v_mov_b32 v119, 0
    v_mov_b32 v192, 0
    v_mov_b32 v193, 0
    v_mov_b32 v194, 0
    v_mov_b32 v195, 0
    v_mov_b32 v196, 0
    v_mov_b32 v197, 0
    v_mov_b32 v198, 0
    v_mov_b32 v199, 0
    v_mov_b32 v200, 0
    v_mov_b32 v201, 0
    v_mov_b32 v202, 0
    v_mov_b32 v203, 0
    v_mov_b32 v204, 0
    v_mov_b32 v205, 0
    v_mov_b32 v206, 0
    v_mov_b32 v207, 0
    v_mov_b32 v208, 0
    v_mov_b32 v209, 0
    v_mov_b32 v210, 0
    v_mov_b32 v211, 0
    v_mov_b32 v212, 0
    v_mov_b32 v213, 0
    v_mov_b32 v214, 0
    v_mov_b32 v215, 0
    v_mov_b32 v216, 0
    v_mov_b32 v217, 0
    v_mov_b32 v218, 0
    v_mov_b32 v219, 0
    v_mov_b32 v220, 0
    v_mov_b32 v221, 0
    v_mov_b32 v222, 0
    v_mov_b32 v223, 0
    v_mov_b32 v240, 0
    v_mov_b32 v241, 0
    v_mov_b32 v242, 0
    v_mov_b32 v243, 0
    v_mov_b32 v244, 0
    v_mov_b32 v245, 0
    v_mov_b32 v246, 0
    v_mov_b32 v247, 0
    s_waitcnt vmcnt(4)
    ds_write_b32 v58, v81 offset:1024
    v_mov_b32 v59, v80
    s_waitcnt vmcnt(1)
    v_add_f32 v64, v64, v72
    v_add_f32 v65, v65, v73
    v_add_f32 v66, v66, v74
    v_add_f32 v67, v67, v75
    s_waitcnt vmcnt(0)
    v_add_f32 v68, v68, v76
    v_add_f32 v69, v69, v77
    v_add_f32 v70, v70, v78
    v_add_f32 v71, v71, v79
    v_add_f32 v64, v64, v68
    v_add_f32 v65, v65, v69
    v_add_f32 v66, v66, v70
    v_add_f32 v67, v67, v71
    s_nop 0
    v_permlane32_swap_b32 v64, v66
    v_permlane32_swap_b32 v65, v67
    v_add_f32 v64, v64, v66
    v_add_f32 v65, v65, v67
    s_nop 1
    v_permlane16_swap_b32 v64, v65
    v_add_f32 v64, v64, v65
    s_nop 1
    v_add_f32_dpp v64, v64, v64 row_ror:8 row_mask:0xf bank_mask:0xf
    s_nop 1
    v_add_f32_dpp v64, v64, v64 row_ror:4 row_mask:0xf bank_mask:0xf
    v_and_b32 v56, 3, v0
    v_lshrrev_b32 v57, 4, v0
    v_lshl_add_u32 v56, v56, 2, v57
    s_lshl_b32 s3, s25, 6
    v_lshl_add_u32 v56, v56, 2, s3
    v_add_u32 v56, 157696, v56
    ds_write_b32 v56, v64
    ds_write_b32 v58, v59
    s_waitcnt lgkmcnt(0)
    s_barrier
    s_setprio 1
    s_mov_b32 s32, s34
    v_add_u32 v148, s32, v1
    ds_read_b128 v[96:99], v148
    ds_read_b128 v[100:103], v148 offset:1024
    s_lshl_b32 s3, s25, 12
    v_add_u32 v128, s3, v148
    ds_read_b128 v[224:227], v128 offset:32768
    ds_read_b128 v[228:231], v128 offset:33792
    ds_read_b128 v[232:235], v128 offset:34816
    ds_read_b128 v[236:239], v128 offset:35840
    ds_read_b128 v[104:107], v148 offset:2048
    ds_read_b128 v[112:115], v148 offset:3072
    s_waitcnt lgkmcnt(5)
    v_mfma_f32_32x32x16_bf16 v[64:79], v[96:99], v[224:227], 0
    s_waitcnt lgkmcnt(4)
    v_mfma_f32_32x32x16_bf16 v[64:79], v[100:103], v[228:231], v[64:79]
    s_waitcnt lgkmcnt(3)
    v_mfma_f32_32x32x16_bf16 v[80:95], v[96:99], v[232:235], 0
    s_waitcnt lgkmcnt(2)
    v_mfma_f32_32x32x16_bf16 v[80:95], v[100:103], v[236:239], v[80:95]
    s_nop 7
    v_max3_f32 v248, v64, v65, v66
    v_max_f32 v248, v248, v67
    v_max3_f32 v248, v248, v68, v69
    v_max3_f32 v248, v248, v70, v71
    v_max3_f32 v248, v248, v72, v73
    v_max3_f32 v248, v248, v74, v75
    v_max3_f32 v248, v248, v76, v77
    v_max3_f32 v248, v248, v78, v79
    v_mov_b32 v128, v248
    s_nop 1
    v_permlane32_swap_b32 v248, v128
    v_max_f32 v248, v248, v128
    v_sub_f32 v248, 0, v248
    v_max3_f32 v249, v80, v81, v82
    v_max_f32 v249, v249, v83
    v_max3_f32 v249, v249, v84, v85
    v_max3_f32 v249, v249, v86, v87
    v_max3_f32 v249, v249, v88, v89
    v_max3_f32 v249, v249, v90, v91
    v_max3_f32 v249, v249, v92, v93
    v_max3_f32 v249, v249, v94, v95
    v_mov_b32 v128, v249
    s_nop 1
    v_permlane32_swap_b32 v249, v128
    v_max_f32 v249, v249, v128
    v_sub_f32 v249, 0, v249
    v_mov_b32 v48, v248
    v_mov_b32 v49, v248
    v_mov_b32 v50, v248
    v_mov_b32 v51, v248
    v_mov_b32 v52, v248
    v_mov_b32 v53, v248
    v_mov_b32 v54, v248
    v_mov_b32 v55, v248
    v_mov_b32 v56, v248
    v_mov_b32 v57, v248
    v_mov_b32 v58, v248
    v_mov_b32 v59, v248
    v_mov_b32 v60, v248
    v_mov_b32 v61, v248
    v_mov_b32 v62, v248
    v_mov_b32 v63, v248
    v_mov_b32 v2, v249
    v_mov_b32 v3, v249
    v_mov_b32 v4, v249
    v_mov_b32 v5, v249
    v_mov_b32 v6, v249
    v_mov_b32 v7, v249
    v_mov_b32 v8, v249
    v_mov_b32 v9, v249
    v_mov_b32 v10, v249
    v_mov_b32 v11, v249
    v_mov_b32 v12, v249
    v_mov_b32 v13, v249
    v_mov_b32 v14, v249
    v_mov_b32 v15, v249
    v_mov_b32 v16, v249
    v_mov_b32 v17, v249
    v_mfma_f32_32x32x16_bf16 v[64:79], v[96:99], v[224:227], v[48:63]
    v_mfma_f32_32x32x16_bf16 v[64:79], v[100:103], v[228:231], v[64:79]
    s_nop 9
    s_waitcnt lgkmcnt(0)
    s_mov_b32 s31, 4
    s_branch gated_mix__softmax_full_mha__mixer_s_mlp__prompt_kernel_am13
    .p2align 5
gated_mix__softmax_full_mha__mixer_s_mlp__prompt_kernel_al12:
    v_mfma_f32_32x32x16_bf16 v[80:95], v[96:99], v[232:235], v[2:17]
    ds_read_b128 v[96:99], v148 offset:0
    v_exp_f32 v64, v64
    v_exp_f32 v65, v65
    v_exp_f32 v66, v66
    v_mfma_f32_32x32x16_bf16 v[80:95], v[100:103], v[236:239], v[80:95]
    ds_read_b128 v[100:103], v148 offset:1024
    v_exp_f32 v67, v67
    v_exp_f32 v68, v68
    v_exp_f32 v69, v69
    v_smfmac_f32_16x16x64_bf16 v[244:247], v[144:147], v[120:127], v149
    v_exp_f32 v70, v70
    v_exp_f32 v71, v71
    v_mfma_f32_32x32x16_bf16 v[208:223], v[112:115], v[124:127], v[208:223]
    v_cvt_pk_bf16_f32 v120, v64, v65
    v_cvt_pk_bf16_f32 v121, v66, v67
    v_cvt_pk_bf16_f32 v122, v68, v69
    v_cvt_pk_bf16_f32 v123, v70, v71
    v_exp_f32 v72, v72
    v_exp_f32 v73, v73
    v_exp_f32 v74, v74
    v_exp_f32 v75, v75
    s_waitcnt lgkmcnt(0)
    v_mfma_f32_32x32x16_bf16 v[192:207], v[108:111], v[120:123], v[192:207]
    v_exp_f32 v76, v76
    v_exp_f32 v77, v77
    v_exp_f32 v78, v78
    v_exp_f32 v79, v79
    v_cvt_pk_bf16_f32 v124, v72, v73
    v_cvt_pk_bf16_f32 v125, v74, v75
    v_cvt_pk_bf16_f32 v126, v76, v77
    v_cvt_pk_bf16_f32 v127, v78, v79
    v_mfma_f32_32x32x16_bf16 v[64:79], v[96:99], v[224:227], v[48:63]
    ds_read_b128 v[104:107], v148 offset:2048
    v_exp_f32 v80, v80
    v_exp_f32 v81, v81
    v_exp_f32 v82, v82
    v_mfma_f32_32x32x16_bf16 v[64:79], v[100:103], v[228:231], v[64:79]
    ds_read_b128 v[112:115], v148 offset:3072
    v_exp_f32 v83, v83
    v_exp_f32 v84, v84
    v_exp_f32 v85, v85
    v_smfmac_f32_16x16x64_bf16 v[240:243], v[144:147], v[120:127], v149
    v_exp_f32 v86, v86
    v_exp_f32 v87, v87
    v_mfma_f32_32x32x16_bf16 v[192:207], v[116:119], v[124:127], v[192:207]
    v_cvt_pk_bf16_f32 v120, v80, v81
    v_cvt_pk_bf16_f32 v121, v82, v83
    v_cvt_pk_bf16_f32 v122, v84, v85
    v_cvt_pk_bf16_f32 v123, v86, v87
    v_exp_f32 v88, v88
    v_exp_f32 v89, v89
    v_exp_f32 v90, v90
    v_exp_f32 v91, v91
    v_mfma_f32_32x32x16_bf16 v[208:223], v[108:111], v[120:123], v[208:223]
    s_sub_u32 s31, s31, 1
    v_exp_f32 v92, v92
    v_exp_f32 v93, v93
    v_exp_f32 v94, v94
    v_exp_f32 v95, v95
    v_cvt_pk_bf16_f32 v124, v88, v89
    v_cvt_pk_bf16_f32 v125, v90, v91
    v_cvt_pk_bf16_f32 v126, v92, v93
    v_cvt_pk_bf16_f32 v127, v94, v95
gated_mix__softmax_full_mha__mixer_s_mlp__prompt_kernel_am13:
    v_mfma_f32_32x32x16_bf16 v[80:95], v[96:99], v[232:235], v[2:17]
    ds_read_b128 v[96:99], v148 offset:4096
    v_exp_f32 v64, v64
    v_exp_f32 v65, v65
    v_exp_f32 v66, v66
    v_mfma_f32_32x32x16_bf16 v[80:95], v[100:103], v[236:239], v[80:95]
    ds_read_b128 v[100:103], v148 offset:5120
    v_exp_f32 v67, v67
    v_exp_f32 v68, v68
    v_exp_f32 v69, v69
    v_smfmac_f32_16x16x64_bf16 v[244:247], v[144:147], v[120:127], v149
    v_exp_f32 v70, v70
    v_exp_f32 v71, v71
    v_mfma_f32_32x32x16_bf16 v[208:223], v[116:119], v[124:127], v[208:223]
    v_cvt_pk_bf16_f32 v120, v64, v65
    v_cvt_pk_bf16_f32 v121, v66, v67
    v_cvt_pk_bf16_f32 v122, v68, v69
    v_cvt_pk_bf16_f32 v123, v70, v71
    v_exp_f32 v72, v72
    v_exp_f32 v73, v73
    v_exp_f32 v74, v74
    v_exp_f32 v75, v75
    s_waitcnt lgkmcnt(0)
    v_mfma_f32_32x32x16_bf16 v[192:207], v[104:107], v[120:123], v[192:207]
    v_exp_f32 v76, v76
    v_exp_f32 v77, v77
    v_exp_f32 v78, v78
    v_exp_f32 v79, v79
    v_cvt_pk_bf16_f32 v124, v72, v73
    v_cvt_pk_bf16_f32 v125, v74, v75
    v_cvt_pk_bf16_f32 v126, v76, v77
    v_cvt_pk_bf16_f32 v127, v78, v79
    v_mfma_f32_32x32x16_bf16 v[64:79], v[96:99], v[224:227], v[48:63]
    ds_read_b128 v[108:111], v148 offset:6144
    v_exp_f32 v80, v80
    v_exp_f32 v81, v81
    v_exp_f32 v82, v82
    v_mfma_f32_32x32x16_bf16 v[64:79], v[100:103], v[228:231], v[64:79]
    ds_read_b128 v[116:119], v148 offset:7168
    v_exp_f32 v83, v83
    v_exp_f32 v84, v84
    v_exp_f32 v85, v85
    v_smfmac_f32_16x16x64_bf16 v[240:243], v[144:147], v[120:127], v149
    v_exp_f32 v86, v86
    v_exp_f32 v87, v87
    v_mfma_f32_32x32x16_bf16 v[192:207], v[112:115], v[124:127], v[192:207]
    v_cvt_pk_bf16_f32 v120, v80, v81
    v_cvt_pk_bf16_f32 v121, v82, v83
    v_cvt_pk_bf16_f32 v122, v84, v85
    v_cvt_pk_bf16_f32 v123, v86, v87
    v_exp_f32 v88, v88
    v_exp_f32 v89, v89
    v_exp_f32 v90, v90
    v_exp_f32 v91, v91
    v_mfma_f32_32x32x16_bf16 v[208:223], v[104:107], v[120:123], v[208:223]
    v_exp_f32 v92, v92
    v_exp_f32 v93, v93
    v_exp_f32 v94, v94
    v_exp_f32 v95, v95
    v_cvt_pk_bf16_f32 v124, v88, v89
    v_cvt_pk_bf16_f32 v125, v90, v91
    v_cvt_pk_bf16_f32 v126, v92, v93
    v_cvt_pk_bf16_f32 v127, v94, v95
    v_mfma_f32_32x32x16_bf16 v[80:95], v[96:99], v[232:235], v[2:17]
    ds_read_b128 v[96:99], v148 offset:8192
    v_exp_f32 v64, v64
    v_exp_f32 v65, v65
    v_exp_f32 v66, v66
    v_mfma_f32_32x32x16_bf16 v[80:95], v[100:103], v[236:239], v[80:95]
    ds_read_b128 v[100:103], v148 offset:9216
    v_exp_f32 v67, v67
    v_exp_f32 v68, v68
    v_exp_f32 v69, v69
    v_smfmac_f32_16x16x64_bf16 v[244:247], v[144:147], v[120:127], v149
    v_exp_f32 v70, v70
    v_exp_f32 v71, v71
    v_mfma_f32_32x32x16_bf16 v[208:223], v[112:115], v[124:127], v[208:223]
    v_cvt_pk_bf16_f32 v120, v64, v65
    v_cvt_pk_bf16_f32 v121, v66, v67
    v_cvt_pk_bf16_f32 v122, v68, v69
    v_cvt_pk_bf16_f32 v123, v70, v71
    v_exp_f32 v72, v72
    v_exp_f32 v73, v73
    v_exp_f32 v74, v74
    v_exp_f32 v75, v75
    s_waitcnt lgkmcnt(0)
    v_mfma_f32_32x32x16_bf16 v[192:207], v[108:111], v[120:123], v[192:207]
    v_exp_f32 v76, v76
    v_exp_f32 v77, v77
    v_exp_f32 v78, v78
    v_exp_f32 v79, v79
    v_cvt_pk_bf16_f32 v124, v72, v73
    v_cvt_pk_bf16_f32 v125, v74, v75
    v_cvt_pk_bf16_f32 v126, v76, v77
    v_cvt_pk_bf16_f32 v127, v78, v79
    v_mfma_f32_32x32x16_bf16 v[64:79], v[96:99], v[224:227], v[48:63]
    ds_read_b128 v[104:107], v148 offset:10240
    v_exp_f32 v80, v80
    v_exp_f32 v81, v81
    v_exp_f32 v82, v82
    v_mfma_f32_32x32x16_bf16 v[64:79], v[100:103], v[228:231], v[64:79]
    ds_read_b128 v[112:115], v148 offset:11264
    v_exp_f32 v83, v83
    v_exp_f32 v84, v84
    v_exp_f32 v85, v85
    v_smfmac_f32_16x16x64_bf16 v[240:243], v[144:147], v[120:127], v149
    v_exp_f32 v86, v86
    v_exp_f32 v87, v87
    v_mfma_f32_32x32x16_bf16 v[192:207], v[116:119], v[124:127], v[192:207]
    v_cvt_pk_bf16_f32 v120, v80, v81
    v_cvt_pk_bf16_f32 v121, v82, v83
    v_cvt_pk_bf16_f32 v122, v84, v85
    v_cvt_pk_bf16_f32 v123, v86, v87
    v_exp_f32 v88, v88
    v_exp_f32 v89, v89
    v_exp_f32 v90, v90
    v_exp_f32 v91, v91
    v_mfma_f32_32x32x16_bf16 v[208:223], v[108:111], v[120:123], v[208:223]
    v_exp_f32 v92, v92
    v_exp_f32 v93, v93
    v_exp_f32 v94, v94
    v_exp_f32 v95, v95
    v_cvt_pk_bf16_f32 v124, v88, v89
    v_cvt_pk_bf16_f32 v125, v90, v91
    v_cvt_pk_bf16_f32 v126, v92, v93
    v_cvt_pk_bf16_f32 v127, v94, v95
    v_mfma_f32_32x32x16_bf16 v[80:95], v[96:99], v[232:235], v[2:17]
    ds_read_b128 v[96:99], v148 offset:12288
    v_exp_f32 v64, v64
    v_exp_f32 v65, v65
    v_exp_f32 v66, v66
    v_mfma_f32_32x32x16_bf16 v[80:95], v[100:103], v[236:239], v[80:95]
    ds_read_b128 v[100:103], v148 offset:13312
    v_exp_f32 v67, v67
    v_exp_f32 v68, v68
    v_exp_f32 v69, v69
    v_smfmac_f32_16x16x64_bf16 v[244:247], v[144:147], v[120:127], v149
    v_exp_f32 v70, v70
    v_exp_f32 v71, v71
    v_mfma_f32_32x32x16_bf16 v[208:223], v[116:119], v[124:127], v[208:223]
    v_cvt_pk_bf16_f32 v120, v64, v65
    v_cvt_pk_bf16_f32 v121, v66, v67
    v_cvt_pk_bf16_f32 v122, v68, v69
    v_cvt_pk_bf16_f32 v123, v70, v71
    v_exp_f32 v72, v72
    v_exp_f32 v73, v73
    v_exp_f32 v74, v74
    v_exp_f32 v75, v75
    s_waitcnt lgkmcnt(0)
    v_mfma_f32_32x32x16_bf16 v[192:207], v[104:107], v[120:123], v[192:207]
    v_exp_f32 v76, v76
    v_exp_f32 v77, v77
    v_exp_f32 v78, v78
    v_exp_f32 v79, v79
    v_cvt_pk_bf16_f32 v124, v72, v73
    v_cvt_pk_bf16_f32 v125, v74, v75
    v_cvt_pk_bf16_f32 v126, v76, v77
    v_cvt_pk_bf16_f32 v127, v78, v79
    v_mfma_f32_32x32x16_bf16 v[64:79], v[96:99], v[224:227], v[48:63]
    ds_read_b128 v[108:111], v148 offset:14336
    v_exp_f32 v80, v80
    v_exp_f32 v81, v81
    v_exp_f32 v82, v82
    v_mfma_f32_32x32x16_bf16 v[64:79], v[100:103], v[228:231], v[64:79]
    ds_read_b128 v[116:119], v148 offset:15360
    v_exp_f32 v83, v83
    v_exp_f32 v84, v84
    v_exp_f32 v85, v85
    v_smfmac_f32_16x16x64_bf16 v[240:243], v[144:147], v[120:127], v149
    v_exp_f32 v86, v86
    v_exp_f32 v87, v87
    v_mfma_f32_32x32x16_bf16 v[192:207], v[112:115], v[124:127], v[192:207]
    v_cvt_pk_bf16_f32 v120, v80, v81
    v_cvt_pk_bf16_f32 v121, v82, v83
    v_cvt_pk_bf16_f32 v122, v84, v85
    v_cvt_pk_bf16_f32 v123, v86, v87
    v_exp_f32 v88, v88
    v_exp_f32 v89, v89
    v_exp_f32 v90, v90
    v_exp_f32 v91, v91
    v_mfma_f32_32x32x16_bf16 v[208:223], v[104:107], v[120:123], v[208:223]
    s_bitcmp1_b32 0xa, s31
    v_exp_f32 v92, v92
    v_exp_f32 v93, v93
    v_exp_f32 v94, v94
    v_exp_f32 v95, v95
    v_cvt_pk_bf16_f32 v124, v88, v89
    v_cvt_pk_bf16_f32 v125, v90, v91
    v_cvt_pk_bf16_f32 v126, v92, v93
    v_cvt_pk_bf16_f32 v127, v94, v95
    v_add_u32 v148, 16384, v148
    s_cbranch_scc0 gated_mix__softmax_full_mha__mixer_s_mlp__prompt_kernel_al12
    s_cmp_eq_u32 s31, 3
    s_cbranch_scc0 gated_mix__softmax_full_mha__mixer_s_mlp__prompt_kernel_an15
    s_add_u32 s32, s32, 49152
    s_cmp_eq_u32 s32, 147456
    s_cselect_b32 s33, s39, 49152
    s_cselect_b32 s32, 0, s32
    v_add_u32 v148, s32, v1
    s_waitcnt vmcnt(0) lgkmcnt(0)
    s_barrier
    s_branch gated_mix__softmax_full_mha__mixer_s_mlp__prompt_kernel_al12
gated_mix__softmax_full_mha__mixer_s_mlp__prompt_kernel_an15:
    s_mov_b32 s34, s32
    s_add_u32 s32, s32, 49152
    s_cmp_eq_u32 s32, 147456
    s_cselect_b32 s33, s39, 49152
    s_cselect_b32 s32, 0, s32
    v_add_u32 v148, s32, v1
    s_waitcnt lgkmcnt(0)
    s_barrier
    s_setprio 1
    s_mov_b32 s31, 3
gated_mix__softmax_full_mha__mixer_s_mlp__prompt_kernel_hl17:
    s_lshr_b32 s3, s32, 3
    s_add_u32 s3, s3, 147456
    v_add_u32 v148, s3, v1
    s_lshr_b32 s3, s34, 3
    s_add_u32 m0, s3, s48
    s_nop 0
    buffer_load_dwordx4 v1, s[44:47], s63 offen sc1 lds
    s_add_u32 s63, s63, 4096
    s_cmp_eq_u32 s63, s100
    s_cselect_b32 s3, 32768, 0
    s_add_u32 s63, s63, s3
    s_add_u32 m0, s34, s37
    s_nop 0
    buffer_load_dwordx4 v32, s[8:11], s35 offen offset:0 sc1 lds
    v_mfma_f32_32x32x16_bf16 v[80:95], v[96:99], v[232:235], v[2:17]
    buffer_load_dwordx4 v32, s[8:11], s35 offen offset:1024 sc1 lds
    ds_read_b128 v[96:99], v148 offset:0
    v_exp_f32 v64, v64
    v_exp_f32 v65, v65
    v_exp_f32 v66, v66
    v_mfma_f32_32x32x16_bf16 v[80:95], v[100:103], v[236:239], v[80:95]
    buffer_load_dwordx4 v32, s[8:11], s35 offen offset:2048 sc1 lds
    ds_read_b128 v[100:103], v148 offset:1024
    v_exp_f32 v67, v67
    v_exp_f32 v68, v68
    v_exp_f32 v69, v69
    v_smfmac_f32_16x16x64_bf16 v[244:247], v[144:147], v[120:127], v149
    buffer_load_dwordx4 v32, s[8:11], s35 offen offset:3072 sc1 lds
    v_exp_f32 v70, v70
    v_exp_f32 v71, v71
    v_mfma_f32_32x32x16_bf16 v[208:223], v[112:115], v[124:127], v[208:223]
    s_add_u32 m0, m0, 4096
    s_nop 0
    buffer_load_dwordx4 v36, s[8:11], s35 offen offset:0 sc1 lds
    v_cvt_pk_bf16_f32 v120, v64, v65
    v_cvt_pk_bf16_f32 v121, v66, v67
    v_cvt_pk_bf16_f32 v122, v68, v69
    v_cvt_pk_bf16_f32 v123, v70, v71
    v_exp_f32 v72, v72
    v_exp_f32 v73, v73
    v_exp_f32 v74, v74
    v_exp_f32 v75, v75
    s_waitcnt lgkmcnt(0)
    v_mfma_f32_32x32x16_bf16 v[192:207], v[108:111], v[120:123], v[192:207]
    buffer_load_dwordx4 v36, s[8:11], s35 offen offset:1024 sc1 lds
    buffer_load_dwordx4 v36, s[8:11], s35 offen offset:2048 sc1 lds
    v_exp_f32 v76, v76
    v_exp_f32 v77, v77
    v_exp_f32 v78, v78
    v_exp_f32 v79, v79
    v_cvt_pk_bf16_f32 v124, v72, v73
    v_cvt_pk_bf16_f32 v125, v74, v75
    v_cvt_pk_bf16_f32 v126, v76, v77
    v_cvt_pk_bf16_f32 v127, v78, v79
    v_mfma_f32_32x32x16_bf16 v[64:79], v[96:99], v[224:227], v[48:63]
    buffer_load_dwordx4 v36, s[8:11], s35 offen offset:3072 sc1 lds
    ds_read_b128 v[104:107], v148 offset:2048
    v_exp_f32 v80, v80
    v_exp_f32 v81, v81
    v_exp_f32 v82, v82
    v_mfma_f32_32x32x16_bf16 v[64:79], v[100:103], v[228:231], v[64:79]
    s_add_u32 m0, s34, s38
    s_nop 0
    buffer_load_dwordx4 v40, s[12:15], s36 offen offset:0  lds
    ds_read_b128 v[112:115], v148 offset:3072
    v_exp_f32 v83, v83
    v_exp_f32 v84, v84
    v_exp_f32 v85, v85
    v_smfmac_f32_16x16x64_bf16 v[240:243], v[144:147], v[120:127], v149
    buffer_load_dwordx4 v41, s[12:15], s36 offen offset:1024  lds
    v_exp_f32 v86, v86
    v_exp_f32 v87, v87
    v_mfma_f32_32x32x16_bf16 v[192:207], v[116:119], v[124:127], v[192:207]
    buffer_load_dwordx4 v42, s[12:15], s36 offen offset:2048  lds
    v_cvt_pk_bf16_f32 v120, v80, v81
    v_cvt_pk_bf16_f32 v121, v82, v83
    v_cvt_pk_bf16_f32 v122, v84, v85
    v_cvt_pk_bf16_f32 v123, v86, v87
    v_exp_f32 v88, v88
    v_exp_f32 v89, v89
    v_exp_f32 v90, v90
    v_exp_f32 v91, v91
    v_mfma_f32_32x32x16_bf16 v[208:223], v[108:111], v[120:123], v[208:223]
    buffer_load_dwordx4 v43, s[12:15], s36 offen offset:3072  lds
    s_add_u32 s35, s35, 4096
    s_add_u32 s36, s36, 262144
    s_add_u32 s34, s34, 49152
    s_cmp_eq_u32 s34, 147456
    s_cselect_b32 s34, 0, s34
    s_add_u32 s32, s32, 49152
    s_cmp_eq_u32 s32, 147456
    s_cselect_b32 s33, s39, 49152
    s_cselect_b32 s32, 0, s32
    v_exp_f32 v92, v92
    v_exp_f32 v93, v93
    v_exp_f32 v94, v94
    v_exp_f32 v95, v95
    v_cvt_pk_bf16_f32 v124, v88, v89
    v_cvt_pk_bf16_f32 v125, v90, v91
    v_cvt_pk_bf16_f32 v126, v92, v93
    v_cvt_pk_bf16_f32 v127, v94, v95
    s_waitcnt vmcnt(13) lgkmcnt(0)
    s_barrier
    s_lshr_b32 s3, s32, 3
    s_add_u32 s3, s3, 147456
    v_add_u32 v148, s3, v1
    s_lshr_b32 s3, s34, 3
    s_add_u32 m0, s3, s48
    s_nop 0
    buffer_load_dwordx4 v1, s[44:47], s63 offen sc1 lds
    s_add_u32 s63, s63, 4096
    s_cmp_eq_u32 s63, s100
    s_cselect_b32 s3, 32768, 0
    s_add_u32 s63, s63, s3
    s_add_u32 m0, s34, s37
    s_nop 0
    buffer_load_dwordx4 v32, s[8:11], s35 offen offset:0 sc1 lds
    v_mfma_f32_32x32x16_bf16 v[80:95], v[96:99], v[232:235], v[2:17]
    buffer_load_dwordx4 v32, s[8:11], s35 offen offset:1024 sc1 lds
    ds_read_b128 v[96:99], v148 offset:0
    v_exp_f32 v64, v64
    v_exp_f32 v65, v65
    v_exp_f32 v66, v66
    v_mfma_f32_32x32x16_bf16 v[80:95], v[100:103], v[236:239], v[80:95]
    buffer_load_dwordx4 v32, s[8:11], s35 offen offset:2048 sc1 lds
    ds_read_b128 v[100:103], v148 offset:1024
    v_exp_f32 v67, v67
    v_exp_f32 v68, v68
    v_exp_f32 v69, v69
    v_smfmac_f32_16x16x64_bf16 v[244:247], v[144:147], v[120:127], v149
    buffer_load_dwordx4 v32, s[8:11], s35 offen offset:3072 sc1 lds
    v_exp_f32 v70, v70
    v_exp_f32 v71, v71
    v_mfma_f32_32x32x16_bf16 v[208:223], v[116:119], v[124:127], v[208:223]
    s_add_u32 m0, m0, 4096
    s_nop 0
    buffer_load_dwordx4 v36, s[8:11], s35 offen offset:0 sc1 lds
    v_cvt_pk_bf16_f32 v120, v64, v65
    v_cvt_pk_bf16_f32 v121, v66, v67
    v_cvt_pk_bf16_f32 v122, v68, v69
    v_cvt_pk_bf16_f32 v123, v70, v71
    v_exp_f32 v72, v72
    v_exp_f32 v73, v73
    v_exp_f32 v74, v74
    v_exp_f32 v75, v75
    s_waitcnt lgkmcnt(0)
    v_mfma_f32_32x32x16_bf16 v[192:207], v[104:107], v[120:123], v[192:207]
    buffer_load_dwordx4 v36, s[8:11], s35 offen offset:1024 sc1 lds
    buffer_load_dwordx4 v36, s[8:11], s35 offen offset:2048 sc1 lds
    v_exp_f32 v76, v76
    v_exp_f32 v77, v77
    v_exp_f32 v78, v78
    v_exp_f32 v79, v79
    v_cvt_pk_bf16_f32 v124, v72, v73
    v_cvt_pk_bf16_f32 v125, v74, v75
    v_cvt_pk_bf16_f32 v126, v76, v77
    v_cvt_pk_bf16_f32 v127, v78, v79
    v_mfma_f32_32x32x16_bf16 v[64:79], v[96:99], v[224:227], v[48:63]
    buffer_load_dwordx4 v36, s[8:11], s35 offen offset:3072 sc1 lds
    ds_read_b128 v[108:111], v148 offset:2048
    v_exp_f32 v80, v80
    v_exp_f32 v81, v81
    v_exp_f32 v82, v82
    v_mfma_f32_32x32x16_bf16 v[64:79], v[100:103], v[228:231], v[64:79]
    s_add_u32 m0, s34, s38
    s_nop 0
    buffer_load_dwordx4 v40, s[12:15], s36 offen offset:0  lds
    ds_read_b128 v[116:119], v148 offset:3072
    v_exp_f32 v83, v83
    v_exp_f32 v84, v84
    v_exp_f32 v85, v85
    v_smfmac_f32_16x16x64_bf16 v[240:243], v[144:147], v[120:127], v149
    buffer_load_dwordx4 v41, s[12:15], s36 offen offset:1024  lds
    v_exp_f32 v86, v86
    v_exp_f32 v87, v87
    v_mfma_f32_32x32x16_bf16 v[192:207], v[112:115], v[124:127], v[192:207]
    buffer_load_dwordx4 v42, s[12:15], s36 offen offset:2048  lds
    v_cvt_pk_bf16_f32 v120, v80, v81
    v_cvt_pk_bf16_f32 v121, v82, v83
    v_cvt_pk_bf16_f32 v122, v84, v85
    v_cvt_pk_bf16_f32 v123, v86, v87
    v_exp_f32 v88, v88
    v_exp_f32 v89, v89
    v_exp_f32 v90, v90
    v_exp_f32 v91, v91
    v_mfma_f32_32x32x16_bf16 v[208:223], v[104:107], v[120:123], v[208:223]
    buffer_load_dwordx4 v43, s[12:15], s36 offen offset:3072  lds
    s_add_u32 s35, s35, 4096
    s_add_u32 s36, s36, 262144
    s_add_u32 s34, s34, 49152
    s_cmp_eq_u32 s34, 147456
    s_cselect_b32 s34, 0, s34
    s_add_u32 s32, s32, 49152
    s_cmp_eq_u32 s32, 147456
    s_cselect_b32 s33, s39, 49152
    s_cselect_b32 s32, 0, s32
    v_exp_f32 v92, v92
    v_exp_f32 v93, v93
    v_exp_f32 v94, v94
    v_exp_f32 v95, v95
    v_cvt_pk_bf16_f32 v124, v88, v89
    v_cvt_pk_bf16_f32 v125, v90, v91
    v_cvt_pk_bf16_f32 v126, v92, v93
    v_cvt_pk_bf16_f32 v127, v94, v95
    s_waitcnt vmcnt(13) lgkmcnt(0)
    s_barrier
    s_sub_u32 s31, s31, 1
    s_cmp_lg_u32 s31, 0
    s_cbranch_scc1 gated_mix__softmax_full_mha__mixer_s_mlp__prompt_kernel_hl17
    s_lshl_b32 s3, s51, 18
    s_add_u32 s3, s3, 4194304
    s_add_u32 s8, s86, s3
    s_addc_u32 s9, s87, 0
    s_mov_b32 s10, 0x40000
    s_mov_b32 s11, 0x20000
    s_lshl_b32 s37, s25, 12
    s_add_u32 s35, s37, 98304
    s_lshl_b32 s101, s41, 15
    s_add_u32 s101, s101, s37
    s_sub_u32 s3, s35, 32768
    s_cmp_ge_u32 s3, s101
    s_cselect_b32 s35, s35, s3
    s_lshr_b32 s3, s32, 3
    s_add_u32 s3, s3, 147456
    v_add_u32 v148, s3, v1
    v_lshrrev_b32 v128, 3, v0
    v_and_b32 v129, 7, v0
    s_lshl_b32 s3, s54, 7
    s_lshl_b32 s4, s25, 5
    s_add_u32 s3, s3, s4
    v_lshrrev_b32 v130, 1, v128
    v_xor_b32 v130, v130, v129
    v_add_u32 v131, s3, v128
    v_lshlrev_b32 v131, 11, v131
    v_lshl_add_u32 v44, v130, 4, v131
    v_xor_b32 v130, 64, v44
    v_add_u32 v45, 16384, v130
    v_add_u32 v46, 32768, v44
    v_add_u32 v47, 49152, v130
    s_mov_b32 s20, s64
    s_mov_b32 s21, s65
    s_mov_b32 s22, 4194304
    s_mov_b32 s23, 0x20000
    s_lshl_b32 s5, s55, 7
    s_lshl_b32 s4, s25, 12
    s_add_u32 s4, s4, s34
    s_add_u32 m0, s4, 32768
    s_nop 0
    buffer_load_dwordx4 v44, s[20:23], s5 offen lds
    s_add_u32 m0, m0, 1024
    s_nop 0
    buffer_load_dwordx4 v45, s[20:23], s5 offen lds
    s_add_u32 m0, m0, 1024
    v_mfma_f32_32x32x16_bf16 v[80:95], v[96:99], v[232:235], v[2:17]
    buffer_load_dwordx4 v46, s[20:23], s5 offen lds
    s_add_u32 m0, m0, 1024
    ds_read_b128 v[96:99], v148 offset:0
    v_exp_f32 v64, v64
    v_exp_f32 v65, v65
    v_exp_f32 v66, v66
    v_mfma_f32_32x32x16_bf16 v[80:95], v[100:103], v[236:239], v[80:95]
    buffer_load_dwordx4 v47, s[20:23], s5 offen lds
    ds_read_b128 v[100:103], v148 offset:1024
    v_exp_f32 v67, v67
    v_exp_f32 v68, v68
    v_exp_f32 v69, v69
    v_smfmac_f32_16x16x64_bf16 v[244:247], v[144:147], v[120:127], v149
    s_add_u32 m0, s34, s37
    s_nop 0
    buffer_load_dwordx4 v1, s[8:11], s35 offen offset:0 sc1 lds
    v_exp_f32 v70, v70
    v_exp_f32 v71, v71
    v_mfma_f32_32x32x16_bf16 v[208:223], v[112:115], v[124:127], v[208:223]
    buffer_load_dwordx4 v1, s[8:11], s35 offen offset:1024 sc1 lds
    v_cvt_pk_bf16_f32 v120, v64, v65
    v_cvt_pk_bf16_f32 v121, v66, v67
    v_cvt_pk_bf16_f32 v122, v68, v69
    v_cvt_pk_bf16_f32 v123, v70, v71
    v_exp_f32 v72, v72
    v_exp_f32 v73, v73
    v_exp_f32 v74, v74
    v_exp_f32 v75, v75
    s_waitcnt lgkmcnt(0)
    v_mfma_f32_32x32x16_bf16 v[192:207], v[108:111], v[120:123], v[192:207]
    buffer_load_dwordx4 v1, s[8:11], s35 offen offset:2048 sc1 lds
    v_exp_f32 v76, v76
    v_exp_f32 v77, v77
    v_exp_f32 v78, v78
    v_exp_f32 v79, v79
    v_cvt_pk_bf16_f32 v124, v72, v73
    v_cvt_pk_bf16_f32 v125, v74, v75
    v_cvt_pk_bf16_f32 v126, v76, v77
    v_cvt_pk_bf16_f32 v127, v78, v79
    v_mfma_f32_32x32x16_bf16 v[64:79], v[96:99], v[224:227], v[48:63]
    buffer_load_dwordx4 v1, s[8:11], s35 offen offset:3072 sc1 lds
    s_add_u32 s35, s35, 16384
    s_cmp_eq_u32 s35, s101
    s_cselect_b32 s3, 32768, 0
    s_add_u32 s35, s35, s3
    ds_read_b128 v[104:107], v148 offset:2048
    v_exp_f32 v80, v80
    v_exp_f32 v81, v81
    v_exp_f32 v82, v82
    v_mfma_f32_32x32x16_bf16 v[64:79], v[100:103], v[228:231], v[64:79]
    s_add_u32 m0, m0, 16384
    s_nop 0
    buffer_load_dwordx4 v1, s[8:11], s35 offen offset:0 sc1 lds
    ds_read_b128 v[112:115], v148 offset:3072
    v_exp_f32 v83, v83
    v_exp_f32 v84, v84
    v_exp_f32 v85, v85
    v_smfmac_f32_16x16x64_bf16 v[240:243], v[144:147], v[120:127], v149
    buffer_load_dwordx4 v1, s[8:11], s35 offen offset:1024 sc1 lds
    v_exp_f32 v86, v86
    v_exp_f32 v87, v87
    v_mfma_f32_32x32x16_bf16 v[192:207], v[116:119], v[124:127], v[192:207]
    buffer_load_dwordx4 v1, s[8:11], s35 offen offset:2048 sc1 lds
    v_cvt_pk_bf16_f32 v120, v80, v81
    v_cvt_pk_bf16_f32 v121, v82, v83
    v_cvt_pk_bf16_f32 v122, v84, v85
    v_cvt_pk_bf16_f32 v123, v86, v87
    v_exp_f32 v88, v88
    v_exp_f32 v89, v89
    v_exp_f32 v90, v90
    v_exp_f32 v91, v91
    v_mfma_f32_32x32x16_bf16 v[208:223], v[108:111], v[120:123], v[208:223]
    buffer_load_dwordx4 v1, s[8:11], s35 offen offset:3072 sc1 lds
    s_add_u32 s35, s35, 16384
    s_cmp_eq_u32 s35, s101
    s_cselect_b32 s3, 32768, 0
    s_add_u32 s35, s35, s3
    s_add_u32 s34, s34, 49152
    s_cmp_eq_u32 s34, 147456
    s_cselect_b32 s34, 0, s34
    s_add_u32 s32, s32, 49152
    s_cmp_eq_u32 s32, 147456
    s_cselect_b32 s33, s39, 49152
    s_cselect_b32 s32, 0, s32
    v_exp_f32 v92, v92
    v_exp_f32 v93, v93
    v_exp_f32 v94, v94
    v_exp_f32 v95, v95
    v_cvt_pk_bf16_f32 v124, v88, v89
    v_cvt_pk_bf16_f32 v125, v90, v91
    v_cvt_pk_bf16_f32 v126, v92, v93
    v_cvt_pk_bf16_f32 v127, v94, v95
    s_waitcnt vmcnt(12) lgkmcnt(0)
    s_barrier
    s_lshr_b32 s3, s32, 3
    s_add_u32 s3, s3, 147456
    v_add_u32 v148, s3, v1
    s_add_u32 m0, s34, s37
    s_nop 0
    buffer_load_dwordx4 v1, s[8:11], s35 offen offset:0 sc1 lds
    buffer_load_dwordx4 v1, s[8:11], s35 offen offset:1024 sc1 lds
    v_mfma_f32_32x32x16_bf16 v[80:95], v[96:99], v[232:235], v[2:17]
    ds_read_b128 v[96:99], v148 offset:0
    v_exp_f32 v64, v64
    v_exp_f32 v65, v65
    v_exp_f32 v66, v66
    v_mfma_f32_32x32x16_bf16 v[80:95], v[100:103], v[236:239], v[80:95]
    buffer_load_dwordx4 v1, s[8:11], s35 offen offset:2048 sc1 lds
    ds_read_b128 v[100:103], v148 offset:1024
    v_exp_f32 v67, v67
    v_exp_f32 v68, v68
    v_exp_f32 v69, v69
    v_smfmac_f32_16x16x64_bf16 v[244:247], v[144:147], v[120:127], v149
    buffer_load_dwordx4 v1, s[8:11], s35 offen offset:3072 sc1 lds
    s_add_u32 s35, s35, 16384
    s_cmp_eq_u32 s35, s101
    s_cselect_b32 s3, 32768, 0
    s_add_u32 s35, s35, s3
    v_exp_f32 v70, v70
    v_exp_f32 v71, v71
    v_mfma_f32_32x32x16_bf16 v[208:223], v[116:119], v[124:127], v[208:223]
    v_cvt_pk_bf16_f32 v120, v64, v65
    v_cvt_pk_bf16_f32 v121, v66, v67
    v_cvt_pk_bf16_f32 v122, v68, v69
    v_cvt_pk_bf16_f32 v123, v70, v71
    v_exp_f32 v72, v72
    v_exp_f32 v73, v73
    v_exp_f32 v74, v74
    v_exp_f32 v75, v75
    s_waitcnt lgkmcnt(0)
    v_mfma_f32_32x32x16_bf16 v[192:207], v[104:107], v[120:123], v[192:207]
    s_add_u32 m0, m0, 16384
    s_nop 0
    buffer_load_dwordx4 v1, s[8:11], s35 offen offset:0 sc1 lds
    v_exp_f32 v76, v76
    v_exp_f32 v77, v77
    v_exp_f32 v78, v78
    v_exp_f32 v79, v79
    v_cvt_pk_bf16_f32 v124, v72, v73
    v_cvt_pk_bf16_f32 v125, v74, v75
    v_cvt_pk_bf16_f32 v126, v76, v77
    v_cvt_pk_bf16_f32 v127, v78, v79
    v_mfma_f32_32x32x16_bf16 v[64:79], v[96:99], v[224:227], v[48:63]
    buffer_load_dwordx4 v1, s[8:11], s35 offen offset:1024 sc1 lds
    ds_read_b128 v[108:111], v148 offset:2048
    v_exp_f32 v80, v80
    v_exp_f32 v81, v81
    v_exp_f32 v82, v82
    v_mfma_f32_32x32x16_bf16 v[64:79], v[100:103], v[228:231], v[64:79]
    ds_read_b128 v[116:119], v148 offset:3072
    v_exp_f32 v83, v83
    v_exp_f32 v84, v84
    v_exp_f32 v85, v85
    v_smfmac_f32_16x16x64_bf16 v[240:243], v[144:147], v[120:127], v149
    buffer_load_dwordx4 v1, s[8:11], s35 offen offset:2048 sc1 lds
    v_exp_f32 v86, v86
    v_exp_f32 v87, v87
    v_mfma_f32_32x32x16_bf16 v[192:207], v[112:115], v[124:127], v[192:207]
    buffer_load_dwordx4 v1, s[8:11], s35 offen offset:3072 sc1 lds
    s_add_u32 s35, s35, 16384
    s_cmp_eq_u32 s35, s101
    s_cselect_b32 s3, 32768, 0
    s_add_u32 s35, s35, s3
    s_add_u32 s34, s34, 49152
    s_cmp_eq_u32 s34, 147456
    s_cselect_b32 s34, 0, s34
    v_cvt_pk_bf16_f32 v120, v80, v81
    v_cvt_pk_bf16_f32 v121, v82, v83
    v_cvt_pk_bf16_f32 v122, v84, v85
    v_cvt_pk_bf16_f32 v123, v86, v87
    v_exp_f32 v88, v88
    v_exp_f32 v89, v89
    v_exp_f32 v90, v90
    v_exp_f32 v91, v91
    v_mfma_f32_32x32x16_bf16 v[208:223], v[104:107], v[120:123], v[208:223]
    s_add_u32 s32, s32, 49152
    s_cmp_eq_u32 s32, 147456
    s_cselect_b32 s33, s39, 49152
    s_cselect_b32 s32, 0, s32
    v_exp_f32 v92, v92
    v_exp_f32 v93, v93
    v_exp_f32 v94, v94
    v_exp_f32 v95, v95
    v_cvt_pk_bf16_f32 v124, v88, v89
    v_cvt_pk_bf16_f32 v125, v90, v91
    v_cvt_pk_bf16_f32 v126, v92, v93
    v_cvt_pk_bf16_f32 v127, v94, v95
    s_setprio 0
    s_add_u32 s8, s86, 16777216
    s_addc_u32 s9, s87, 0
    s_mov_b32 s10, 4194304
    s_mov_b32 s11, 0x20000
    s_mov_b32 s12, s76
    s_mov_b32 s13, s77
    s_mov_b32 s14, 7340032
    s_mov_b32 s15, 0x20000
    s_lshl_b32 s3, s29, 3
    s_lshl_b32 s4, s25, 1
    s_add_u32 s3, s3, s4
    s_lshl_b32 s3, s3, 15
    v_add_u32 v32, s3, v1
    v_add_u32 v34, 30720, v32
    s_mul_i32 s4, s30, 448
    s_and_b32 s4, s4, 4294967168
    s_mul_i32 s3, s25, 114688
    s_add_u32 s4, s4, s3
    v_lshrrev_b32 v128, 5, v0
    v_and_b32 v129, 31, v0
    v_mul_u32_u24 v130, 7168, v128
    v_add_u32 v130, s4, v130
    s_bitcmp1_b32 s30, 0
    s_cselect_b32 s5, 0, 7
    v_mov_b32 v133, 0x40000000
    v_lshlrev_b32 v128, 1, v128
    v_xor_b32 v129, v129, v128
    v_xor_b32 v131, 0, v129
    v_lshrrev_b32 v132, 2, v131
    v_lshl_add_u32 v131, v131, 4, v130
    v_cmp_eq_u32 vcc, s5, v132
    s_nop 1
    v_cndmask_b32 v131, v131, v133, vcc
    v_add_u32 v36, 0, v131
    v_add_u32 v40, 57344, v131
    v_xor_b32 v131, 4, v129
    v_lshrrev_b32 v132, 2, v131
    v_lshl_add_u32 v131, v131, 4, v130
    v_cmp_eq_u32 vcc, s5, v132
    s_nop 1
    v_cndmask_b32 v131, v131, v133, vcc
    v_add_u32 v37, 13312, v131
    v_add_u32 v41, 70656, v131
    v_xor_b32 v131, 8, v129
    v_lshrrev_b32 v132, 2, v131
    v_lshl_add_u32 v131, v131, 4, v130
    v_cmp_eq_u32 vcc, s5, v132
    s_nop 1
    v_cndmask_b32 v131, v131, v133, vcc
    v_add_u32 v38, 26624, v131
    v_add_u32 v42, 83968, v131
    v_xor_b32 v131, 12, v129
    v_lshrrev_b32 v132, 2, v131
    v_lshl_add_u32 v131, v131, 4, v130
    v_cmp_eq_u32 vcc, s5, v132
    s_nop 1
    v_cndmask_b32 v131, v131, v133, vcc
    v_add_u32 v39, 39936, v131
    v_add_u32 v43, 97280, v131
    s_lshl_b32 s37, s25, 12
    s_lshl_b32 s38, s25, 13
    s_add_u32 s38, s38, 16384
    s_mov_b32 s35, 0
    s_mov_b32 s36, 0
    s_add_u32 s35, s35, 4096
    s_add_u32 s36, s36, 917504
    s_waitcnt vmcnt(8) lgkmcnt(0)
    s_barrier
    s_setprio 1
    s_add_u32 s32, s34, 49152
    s_cmp_eq_u32 s32, 147456
    s_cselect_b32 s32, 0, s32
    v_add_u32 v148, s32, v1
    s_mov_b32 s31, 5
    .p2align 5
gated_mix__softmax_full_mha__mixer_s_mlp__prompt_kernel_al18:
    v_mfma_f32_32x32x16_bf16 v[80:95], v[96:99], v[232:235], v[2:17]
    ds_read_b128 v[96:99], v148 offset:0
    v_exp_f32 v64, v64
    v_exp_f32 v65, v65
    v_exp_f32 v66, v66
    v_mfma_f32_32x32x16_bf16 v[80:95], v[100:103], v[236:239], v[80:95]
    ds_read_b128 v[100:103], v148 offset:1024
    v_exp_f32 v67, v67
    v_exp_f32 v68, v68
    v_exp_f32 v69, v69
    v_smfmac_f32_16x16x64_bf16 v[244:247], v[144:147], v[120:127], v149
    v_exp_f32 v70, v70
    v_exp_f32 v71, v71
    v_mfma_f32_32x32x16_bf16 v[208:223], v[112:115], v[124:127], v[208:223]
    v_cvt_pk_bf16_f32 v120, v64, v65
    v_cvt_pk_bf16_f32 v121, v66, v67
    v_cvt_pk_bf16_f32 v122, v68, v69
    v_cvt_pk_bf16_f32 v123, v70, v71
    v_exp_f32 v72, v72
    v_exp_f32 v73, v73
    v_exp_f32 v74, v74
    v_exp_f32 v75, v75
    s_waitcnt lgkmcnt(0)
    v_mfma_f32_32x32x16_bf16 v[192:207], v[108:111], v[120:123], v[192:207]
    v_exp_f32 v76, v76
    v_exp_f32 v77, v77
    v_exp_f32 v78, v78
    v_exp_f32 v79, v79
    v_cvt_pk_bf16_f32 v124, v72, v73
    v_cvt_pk_bf16_f32 v125, v74, v75
    v_cvt_pk_bf16_f32 v126, v76, v77
    v_cvt_pk_bf16_f32 v127, v78, v79
    v_mfma_f32_32x32x16_bf16 v[64:79], v[96:99], v[224:227], v[48:63]
    ds_read_b128 v[104:107], v148 offset:2048
    v_exp_f32 v80, v80
    v_exp_f32 v81, v81
    v_exp_f32 v82, v82
    v_mfma_f32_32x32x16_bf16 v[64:79], v[100:103], v[228:231], v[64:79]
    ds_read_b128 v[112:115], v148 offset:3072
    v_exp_f32 v83, v83
    v_exp_f32 v84, v84
    v_exp_f32 v85, v85
    v_smfmac_f32_16x16x64_bf16 v[240:243], v[144:147], v[120:127], v149
    v_exp_f32 v86, v86
    v_exp_f32 v87, v87
    v_mfma_f32_32x32x16_bf16 v[192:207], v[116:119], v[124:127], v[192:207]
    v_cvt_pk_bf16_f32 v120, v80, v81
    v_cvt_pk_bf16_f32 v121, v82, v83
    v_cvt_pk_bf16_f32 v122, v84, v85
    v_cvt_pk_bf16_f32 v123, v86, v87
    v_exp_f32 v88, v88
    v_exp_f32 v89, v89
    v_exp_f32 v90, v90
    v_exp_f32 v91, v91
    v_mfma_f32_32x32x16_bf16 v[208:223], v[108:111], v[120:123], v[208:223]
    s_sub_u32 s31, s31, 1
    s_cmp_eq_u32 s31, 0
    v_exp_f32 v92, v92
    v_exp_f32 v93, v93
    v_exp_f32 v94, v94
    v_exp_f32 v95, v95
    v_cvt_pk_bf16_f32 v124, v88, v89
    v_cvt_pk_bf16_f32 v125, v90, v91
    v_cvt_pk_bf16_f32 v126, v92, v93
    v_cvt_pk_bf16_f32 v127, v94, v95
    s_cbranch_scc1 gated_mix__softmax_full_mha__mixer_s_mlp__prompt_kernel_ax20
gated_mix__softmax_full_mha__mixer_s_mlp__prompt_kernel_am19:
    v_mfma_f32_32x32x16_bf16 v[80:95], v[96:99], v[232:235], v[2:17]
    ds_read_b128 v[96:99], v148 offset:4096
    v_exp_f32 v64, v64
    v_exp_f32 v65, v65
    v_exp_f32 v66, v66
    v_mfma_f32_32x32x16_bf16 v[80:95], v[100:103], v[236:239], v[80:95]
    ds_read_b128 v[100:103], v148 offset:5120
    v_exp_f32 v67, v67
    v_exp_f32 v68, v68
    v_exp_f32 v69, v69
    v_smfmac_f32_16x16x64_bf16 v[244:247], v[144:147], v[120:127], v149
    v_exp_f32 v70, v70
    v_exp_f32 v71, v71
    v_mfma_f32_32x32x16_bf16 v[208:223], v[116:119], v[124:127], v[208:223]
    v_cvt_pk_bf16_f32 v120, v64, v65
    v_cvt_pk_bf16_f32 v121, v66, v67
    v_cvt_pk_bf16_f32 v122, v68, v69
    v_cvt_pk_bf16_f32 v123, v70, v71
    v_exp_f32 v72, v72
    v_exp_f32 v73, v73
    v_exp_f32 v74, v74
    v_exp_f32 v75, v75
    s_waitcnt lgkmcnt(0)
    v_mfma_f32_32x32x16_bf16 v[192:207], v[104:107], v[120:123], v[192:207]
    v_exp_f32 v76, v76
    v_exp_f32 v77, v77
    v_exp_f32 v78, v78
    v_exp_f32 v79, v79
    v_cvt_pk_bf16_f32 v124, v72, v73
    v_cvt_pk_bf16_f32 v125, v74, v75
    v_cvt_pk_bf16_f32 v126, v76, v77
    v_cvt_pk_bf16_f32 v127, v78, v79
    v_mfma_f32_32x32x16_bf16 v[64:79], v[96:99], v[224:227], v[48:63]
    ds_read_b128 v[108:111], v148 offset:6144
    v_exp_f32 v80, v80
    v_exp_f32 v81, v81
    v_exp_f32 v82, v82
    v_mfma_f32_32x32x16_bf16 v[64:79], v[100:103], v[228:231], v[64:79]
    ds_read_b128 v[116:119], v148 offset:7168
    v_exp_f32 v83, v83
    v_exp_f32 v84, v84
    v_exp_f32 v85, v85
    v_smfmac_f32_16x16x64_bf16 v[240:243], v[144:147], v[120:127], v149
    v_exp_f32 v86, v86
    v_exp_f32 v87, v87
    v_mfma_f32_32x32x16_bf16 v[192:207], v[112:115], v[124:127], v[192:207]
    v_cvt_pk_bf16_f32 v120, v80, v81
    v_cvt_pk_bf16_f32 v121, v82, v83
    v_cvt_pk_bf16_f32 v122, v84, v85
    v_cvt_pk_bf16_f32 v123, v86, v87
    v_exp_f32 v88, v88
    v_exp_f32 v89, v89
    v_exp_f32 v90, v90
    v_exp_f32 v91, v91
    v_mfma_f32_32x32x16_bf16 v[208:223], v[104:107], v[120:123], v[208:223]
    v_exp_f32 v92, v92
    v_exp_f32 v93, v93
    v_exp_f32 v94, v94
    v_exp_f32 v95, v95
    v_cvt_pk_bf16_f32 v124, v88, v89
    v_cvt_pk_bf16_f32 v125, v90, v91
    v_cvt_pk_bf16_f32 v126, v92, v93
    v_cvt_pk_bf16_f32 v127, v94, v95
    v_mfma_f32_32x32x16_bf16 v[80:95], v[96:99], v[232:235], v[2:17]
    ds_read_b128 v[96:99], v148 offset:8192
    v_exp_f32 v64, v64
    v_exp_f32 v65, v65
    v_exp_f32 v66, v66
    v_mfma_f32_32x32x16_bf16 v[80:95], v[100:103], v[236:239], v[80:95]
    ds_read_b128 v[100:103], v148 offset:9216
    v_exp_f32 v67, v67
    v_exp_f32 v68, v68
    v_exp_f32 v69, v69
    v_smfmac_f32_16x16x64_bf16 v[244:247], v[144:147], v[120:127], v149
    v_exp_f32 v70, v70
    v_exp_f32 v71, v71
    v_mfma_f32_32x32x16_bf16 v[208:223], v[112:115], v[124:127], v[208:223]
    v_cvt_pk_bf16_f32 v120, v64, v65
    v_cvt_pk_bf16_f32 v121, v66, v67
    v_cvt_pk_bf16_f32 v122, v68, v69
    v_cvt_pk_bf16_f32 v123, v70, v71
    v_exp_f32 v72, v72
    v_exp_f32 v73, v73
    v_exp_f32 v74, v74
    v_exp_f32 v75, v75
    s_waitcnt lgkmcnt(0)
    v_mfma_f32_32x32x16_bf16 v[192:207], v[108:111], v[120:123], v[192:207]
    v_exp_f32 v76, v76
    v_exp_f32 v77, v77
    v_exp_f32 v78, v78
    v_exp_f32 v79, v79
    v_cvt_pk_bf16_f32 v124, v72, v73
    v_cvt_pk_bf16_f32 v125, v74, v75
    v_cvt_pk_bf16_f32 v126, v76, v77
    v_cvt_pk_bf16_f32 v127, v78, v79
    v_mfma_f32_32x32x16_bf16 v[64:79], v[96:99], v[224:227], v[48:63]
    ds_read_b128 v[104:107], v148 offset:10240
    v_exp_f32 v80, v80
    v_exp_f32 v81, v81
    v_exp_f32 v82, v82
    v_mfma_f32_32x32x16_bf16 v[64:79], v[100:103], v[228:231], v[64:79]
    ds_read_b128 v[112:115], v148 offset:11264
    v_exp_f32 v83, v83
    v_exp_f32 v84, v84
    v_exp_f32 v85, v85
    v_smfmac_f32_16x16x64_bf16 v[240:243], v[144:147], v[120:127], v149
    v_exp_f32 v86, v86
    v_exp_f32 v87, v87
    v_mfma_f32_32x32x16_bf16 v[192:207], v[116:119], v[124:127], v[192:207]
    v_cvt_pk_bf16_f32 v120, v80, v81
    v_cvt_pk_bf16_f32 v121, v82, v83
    v_cvt_pk_bf16_f32 v122, v84, v85
    v_cvt_pk_bf16_f32 v123, v86, v87
    v_exp_f32 v88, v88
    v_exp_f32 v89, v89
    v_exp_f32 v90, v90
    v_exp_f32 v91, v91
    v_mfma_f32_32x32x16_bf16 v[208:223], v[108:111], v[120:123], v[208:223]
    v_exp_f32 v92, v92
    v_exp_f32 v93, v93
    v_exp_f32 v94, v94
    v_exp_f32 v95, v95
    v_cvt_pk_bf16_f32 v124, v88, v89
    v_cvt_pk_bf16_f32 v125, v90, v91
    v_cvt_pk_bf16_f32 v126, v92, v93
    v_cvt_pk_bf16_f32 v127, v94, v95
    v_mfma_f32_32x32x16_bf16 v[80:95], v[96:99], v[232:235], v[2:17]
    ds_read_b128 v[96:99], v148 offset:12288
    v_exp_f32 v64, v64
    v_exp_f32 v65, v65
    v_exp_f32 v66, v66
    v_mfma_f32_32x32x16_bf16 v[80:95], v[100:103], v[236:239], v[80:95]
    ds_read_b128 v[100:103], v148 offset:13312
    v_exp_f32 v67, v67
    v_exp_f32 v68, v68
    v_exp_f32 v69, v69
    v_smfmac_f32_16x16x64_bf16 v[244:247], v[144:147], v[120:127], v149
    v_exp_f32 v70, v70
    v_exp_f32 v71, v71
    v_mfma_f32_32x32x16_bf16 v[208:223], v[116:119], v[124:127], v[208:223]
    v_cvt_pk_bf16_f32 v120, v64, v65
    v_cvt_pk_bf16_f32 v121, v66, v67
    v_cvt_pk_bf16_f32 v122, v68, v69
    v_cvt_pk_bf16_f32 v123, v70, v71
    v_exp_f32 v72, v72
    v_exp_f32 v73, v73
    v_exp_f32 v74, v74
    v_exp_f32 v75, v75
    s_waitcnt lgkmcnt(0)
    v_mfma_f32_32x32x16_bf16 v[192:207], v[104:107], v[120:123], v[192:207]
    v_exp_f32 v76, v76
    v_exp_f32 v77, v77
    v_exp_f32 v78, v78
    v_exp_f32 v79, v79
    v_cvt_pk_bf16_f32 v124, v72, v73
    v_cvt_pk_bf16_f32 v125, v74, v75
    v_cvt_pk_bf16_f32 v126, v76, v77
    v_cvt_pk_bf16_f32 v127, v78, v79
    v_mfma_f32_32x32x16_bf16 v[64:79], v[96:99], v[224:227], v[48:63]
    ds_read_b128 v[108:111], v148 offset:14336
    v_exp_f32 v80, v80
    v_exp_f32 v81, v81
    v_exp_f32 v82, v82
    v_mfma_f32_32x32x16_bf16 v[64:79], v[100:103], v[228:231], v[64:79]
    ds_read_b128 v[116:119], v148 offset:15360
    v_exp_f32 v83, v83
    v_exp_f32 v84, v84
    v_exp_f32 v85, v85
    v_smfmac_f32_16x16x64_bf16 v[240:243], v[144:147], v[120:127], v149
    v_exp_f32 v86, v86
    v_exp_f32 v87, v87
    v_mfma_f32_32x32x16_bf16 v[192:207], v[112:115], v[124:127], v[192:207]
    v_cvt_pk_bf16_f32 v120, v80, v81
    v_cvt_pk_bf16_f32 v121, v82, v83
    v_cvt_pk_bf16_f32 v122, v84, v85
    v_cvt_pk_bf16_f32 v123, v86, v87
    v_exp_f32 v88, v88
    v_exp_f32 v89, v89
    v_exp_f32 v90, v90
    v_exp_f32 v91, v91
    v_mfma_f32_32x32x16_bf16 v[208:223], v[104:107], v[120:123], v[208:223]
    s_bitcmp1_b32 0x1a, s31
    v_exp_f32 v92, v92
    v_exp_f32 v93, v93
    v_exp_f32 v94, v94
    v_exp_f32 v95, v95
    v_cvt_pk_bf16_f32 v124, v88, v89
    v_cvt_pk_bf16_f32 v125, v90, v91
    v_cvt_pk_bf16_f32 v126, v92, v93
    v_cvt_pk_bf16_f32 v127, v94, v95
    v_add_u32 v148, 16384, v148
    s_cbranch_scc0 gated_mix__softmax_full_mha__mixer_s_mlp__prompt_kernel_al18
    s_cmp_eq_u32 s31, 4
    s_cbranch_scc0 gated_mix__softmax_full_mha__mixer_s_mlp__prompt_kernel_an21
    s_waitcnt vmcnt(0)
    v_mov_b32 v18, 153356
    v_mov_b32 v19, 1
    s_mov_b64 exec, 1
    ds_add_u32 v18, v19
    s_mov_b64 exec, -1
    s_branch gated_mix__softmax_full_mha__mixer_s_mlp__prompt_kernel_al18
gated_mix__softmax_full_mha__mixer_s_mlp__prompt_kernel_an21:
    s_cmp_eq_u32 s31, 3
    s_cbranch_scc0 gated_mix__softmax_full_mha__mixer_s_mlp__prompt_kernel_an22
    v_mov_b32 v139, 153356
    s_mov_b32 s5, 1600000
gated_mix__softmax_full_mha__mixer_s_mlp__prompt_kernel_fr23:
    ds_read_b32 v137, v139
    s_sub_u32 s5, s5, 1
    s_cmp_eq_u32 s5, 0
    s_cbranch_scc1 gated_mix__softmax_full_mha__mixer_s_mlp__prompt_kernel_fre24
    s_waitcnt lgkmcnt(0)
    v_cmp_gt_u32 vcc, 4, v137
    s_nop 4
    s_cbranch_vccz gated_mix__softmax_full_mha__mixer_s_mlp__prompt_kernel_fre24
    s_sleep 2
    s_branch gated_mix__softmax_full_mha__mixer_s_mlp__prompt_kernel_fr23
gated_mix__softmax_full_mha__mixer_s_mlp__prompt_kernel_fre24:
    s_add_u32 s32, s32, 49152
    s_cmp_eq_u32 s32, 147456
    s_cselect_b32 s33, s39, 49152
    s_cselect_b32 s32, 0, s32
    v_add_u32 v148, s32, v1
    s_waitcnt lgkmcnt(0)
    v_mov_b32 v18, 153352
    v_mov_b32 v19, 1
    s_mov_b64 exec, 1
    ds_add_u32 v18, v19
    s_mov_b64 exec, -1
    s_branch gated_mix__softmax_full_mha__mixer_s_mlp__prompt_kernel_al18
gated_mix__softmax_full_mha__mixer_s_mlp__prompt_kernel_an22:
    s_mov_b32 s34, s32
    s_add_u32 s32, s32, 49152
    s_cmp_eq_u32 s32, 147456
    s_cselect_b32 s33, s39, 49152
    s_cselect_b32 s32, 0, s32
    v_add_u32 v148, s32, v1
    s_waitcnt lgkmcnt(0)
    s_barrier
    s_add_u32 m0, s34, s37
    s_nop 0
    buffer_load_dwordx4 v32, s[8:11], s35 offen offset:0 sc1 lds
    buffer_load_dwordx4 v32, s[8:11], s35 offen offset:1024 sc1 lds
    buffer_load_dwordx4 v34, s[8:11], s35 offen offset:2048 sc1 lds
    buffer_load_dwordx4 v34, s[8:11], s35 offen offset:3072 sc1 lds
    s_add_u32 m0, s34, s38
    s_nop 0
    buffer_load_dwordx4 v36, s[12:15], s36 offen offset:0  lds
    buffer_load_dwordx4 v37, s[12:15], s36 offen offset:1024  lds
    buffer_load_dwordx4 v38, s[12:15], s36 offen offset:2048  lds
    buffer_load_dwordx4 v39, s[12:15], s36 offen offset:3072  lds
    s_add_u32 m0, m0, 4096
    s_nop 0
    buffer_load_dwordx4 v40, s[12:15], s36 offen offset:0  lds
    buffer_load_dwordx4 v41, s[12:15], s36 offen offset:1024  lds
    buffer_load_dwordx4 v42, s[12:15], s36 offen offset:2048  lds
    buffer_load_dwordx4 v43, s[12:15], s36 offen offset:3072  lds
    s_add_u32 s35, s35, 2048
    s_add_u32 s36, s36, 458752
    s_add_u32 s34, s34, 49152
    s_cmp_eq_u32 s34, 147456
    s_cselect_b32 s34, 0, s34
    s_branch gated_mix__softmax_full_mha__mixer_s_mlp__prompt_kernel_al18
gated_mix__softmax_full_mha__mixer_s_mlp__prompt_kernel_ax20:
    s_waitcnt lgkmcnt(0)
    s_setprio 0
    s_waitcnt vmcnt(12)
    s_barrier
    s_mov_b32 s31, 10
gated_mix__softmax_full_mha__mixer_s_mlp__prompt_kernel_hl26:
    s_add_u32 m0, s34, s37
    s_nop 0
    buffer_load_dwordx4 v32, s[8:11], s35 offen offset:0 sc1 lds
    buffer_load_dwordx4 v32, s[8:11], s35 offen offset:1024 sc1 lds
    buffer_load_dwordx4 v34, s[8:11], s35 offen offset:2048 sc1 lds
    buffer_load_dwordx4 v34, s[8:11], s35 offen offset:3072 sc1 lds
    s_add_u32 m0, s34, s38
    s_nop 0
    buffer_load_dwordx4 v36, s[12:15], s36 offen offset:0  lds
    buffer_load_dwordx4 v37, s[12:15], s36 offen offset:1024  lds
    buffer_load_dwordx4 v38, s[12:15], s36 offen offset:2048  lds
    buffer_load_dwordx4 v39, s[12:15], s36 offen offset:3072  lds
    s_add_u32 m0, m0, 4096
    s_nop 0
    buffer_load_dwordx4 v40, s[12:15], s36 offen offset:0  lds
    buffer_load_dwordx4 v41, s[12:15], s36 offen offset:1024  lds
    buffer_load_dwordx4 v42, s[12:15], s36 offen offset:2048  lds
    buffer_load_dwordx4 v43, s[12:15], s36 offen offset:3072  lds
    s_add_u32 s35, s35, 2048
    s_add_u32 s36, s36, 458752
    s_add_u32 s34, s34, 49152
    s_cmp_eq_u32 s34, 147456
    s_cselect_b32 s34, 0, s34
    s_waitcnt vmcnt(12)
    s_barrier
    s_sub_u32 s31, s31, 1
    s_cmp_lg_u32 s31, 0
    s_cbranch_scc1 gated_mix__softmax_full_mha__mixer_s_mlp__prompt_kernel_hl26
    s_add_u32 m0, s34, s37
    s_nop 0
    buffer_load_dwordx4 v32, s[8:11], s35 offen offset:0 sc1 lds
    buffer_load_dwordx4 v32, s[8:11], s35 offen offset:1024 sc1 lds
    buffer_load_dwordx4 v34, s[8:11], s35 offen offset:2048 sc1 lds
    buffer_load_dwordx4 v34, s[8:11], s35 offen offset:3072 sc1 lds
    s_add_u32 m0, s34, s38
    s_nop 0
    buffer_load_dwordx4 v36, s[12:15], s36 offen offset:0  lds
    buffer_load_dwordx4 v37, s[12:15], s36 offen offset:1024  lds
    buffer_load_dwordx4 v38, s[12:15], s36 offen offset:2048  lds
    buffer_load_dwordx4 v39, s[12:15], s36 offen offset:3072  lds
    s_add_u32 m0, m0, 4096
    s_nop 0
    buffer_load_dwordx4 v40, s[12:15], s36 offen offset:0  lds
    buffer_load_dwordx4 v41, s[12:15], s36 offen offset:1024  lds
    buffer_load_dwordx4 v42, s[12:15], s36 offen offset:2048  lds
    buffer_load_dwordx4 v43, s[12:15], s36 offen offset:3072  lds
    s_add_u32 s35, s35, 2048
    s_add_u32 s36, s36, 458752
    s_add_u32 s34, s34, 49152
    s_cmp_eq_u32 s34, 147456
    s_cselect_b32 s34, 0, s34
    s_getpc_b64 s[4:5]
gated_mix__softmax_full_mha__mixer_s_mlp__prompt_kernel_pc27:
    s_sub_u32 s4, s4, gated_mix__softmax_full_mha__mixer_s_mlp__prompt_kernel_pc27-gated_mix__softmax_full_mha__mixer_s_mlp__prompt_kernel
    s_subb_u32 s5, s5, 0
    s_lshl_b32 s3, s28, 11
    s_and_b32 s6, s24, 3
    s_lshl_b32 s6, s6, 9
    s_add_u32 s3, s3, s6
    v_lshl_add_u32 v136, v0, 3, s3
    s_mov_b32 s3, gated_mix__softmax_full_mha__mixer_s_mlp__prompt_kernel_end-gated_mix__softmax_full_mha__mixer_s_mlp__prompt_kernel
    v_min_u32 v136, s3, v136
    v_mov_b32 v137, s5
    v_add_co_u32 v136, vcc, s4, v136
    s_nop 1
    v_addc_co_u32 v137, vcc, 0, v137, vcc
    global_load_dword v138, v[136:137], off
    s_waitcnt vmcnt(13)
    s_barrier
    s_mov_b32 s31, 2
gated_mix__softmax_full_mha__mixer_s_mlp__prompt_kernel_hl28:
    s_add_u32 m0, s34, s37
    s_nop 0
    buffer_load_dwordx4 v32, s[8:11], s35 offen offset:0 sc1 lds
    buffer_load_dwordx4 v32, s[8:11], s35 offen offset:1024 sc1 lds
    buffer_load_dwordx4 v34, s[8:11], s35 offen offset:2048 sc1 lds
    buffer_load_dwordx4 v34, s[8:11], s35 offen offset:3072 sc1 lds
    s_add_u32 m0, s34, s38
    s_nop 0
    buffer_load_dwordx4 v36, s[12:15], s36 offen offset:0  lds
    buffer_load_dwordx4 v37, s[12:15], s36 offen offset:1024  lds
    buffer_load_dwordx4 v38, s[12:15], s36 offen offset:2048  lds
    buffer_load_dwordx4 v39, s[12:15], s36 offen offset:3072  lds
    s_add_u32 m0, m0, 4096
    s_nop 0
    buffer_load_dwordx4 v40, s[12:15], s36 offen offset:0  lds
    buffer_load_dwordx4 v41, s[12:15], s36 offen offset:1024  lds
    buffer_load_dwordx4 v42, s[12:15], s36 offen offset:2048  lds
    buffer_load_dwordx4 v43, s[12:15], s36 offen offset:3072  lds
    s_add_u32 s35, s35, 2048
    s_add_u32 s36, s36, 458752
    s_add_u32 s34, s34, 49152
    s_cmp_eq_u32 s34, 147456
    s_cselect_b32 s34, 0, s34
    s_waitcnt vmcnt(12)
    s_barrier
    s_sub_u32 s31, s31, 1
    s_cmp_lg_u32 s31, 0
    s_cbranch_scc1 gated_mix__softmax_full_mha__mixer_s_mlp__prompt_kernel_hl28
    s_lshl_b32 s3, s51, 18
    s_add_u32 s3, s3, 4194304
    s_add_u32 s8, s86, s3
    s_addc_u32 s9, s87, 0
    s_mov_b32 s10, 0x40000
    s_mov_b32 s11, 0x20000
    s_lshl_b32 s37, s25, 12
    s_add_u32 s35, s37, 163840
    s_lshl_b32 s101, s41, 15
    s_add_u32 s101, s101, s37
    s_sub_u32 s3, s35, 32768
    s_cmp_ge_u32 s3, s101
    s_cselect_b32 s35, s35, s3
    s_lshl_b32 s3, s41, 10
    s_lshl_b32 s4, s25, 8
    s_add_u32 s3, s3, s4
    s_lshl_b32 s3, s3, 2
    s_add_u32 s3, s3, 42991624
    v_and_b32 v128, 31, v0
    v_lshlrev_b32 v128, 4, v128
    buffer_load_dword v250, v128, s[16:19], s3 offen sc1
    buffer_load_dword v251, v128, s[16:19], s3 offen offset:512 sc1
    s_add_u32 m0, s34, s37
    s_nop 0
    buffer_load_dwordx4 v1, s[8:11], s35 offen offset:0 sc1 lds
    buffer_load_dwordx4 v1, s[8:11], s35 offen offset:1024 sc1 lds
    buffer_load_dwordx4 v1, s[8:11], s35 offen offset:2048 sc1 lds
    buffer_load_dwordx4 v1, s[8:11], s35 offen offset:3072 sc1 lds
    s_add_u32 s35, s35, 16384
    s_cmp_eq_u32 s35, s101
    s_cselect_b32 s3, 32768, 0
    s_add_u32 s35, s35, s3
    s_add_u32 m0, m0, 16384
    s_nop 0
    buffer_load_dwordx4 v1, s[8:11], s35 offen offset:0 sc1 lds
    buffer_load_dwordx4 v1, s[8:11], s35 offen offset:1024 sc1 lds
    buffer_load_dwordx4 v1, s[8:11], s35 offen offset:2048 sc1 lds
    buffer_load_dwordx4 v1, s[8:11], s35 offen offset:3072 sc1 lds
    s_add_u32 s35, s35, 16384
    s_cmp_eq_u32 s35, s101
    s_cselect_b32 s3, 32768, 0
    s_add_u32 s35, s35, s3
    s_add_u32 s34, s34, 49152
    s_cmp_eq_u32 s34, 147456
    s_cselect_b32 s34, 0, s34
    s_lshl_b32 s3, s54, 4
    s_mov_b32 s4, s55
    s_add_u32 s3, s3, s4
    s_lshl_b32 s3, s3, 2
    s_add_u32 s3, s3, s25
    s_lshl_b32 s3, s3, 13
    s_add_u32 s3, s3, 50331648
    v_mov_b32 v132, -1
    v_mov_b32 v133, -1
    v_mov_b32 v134, -1
    v_mov_b32 v135, -1
    buffer_store_dwordx4 v[132:135], v1, s[16:19], s3 offen offset:0 sc1
    buffer_store_dwordx4 v[132:135], v1, s[16:19], s3 offen offset:1024 sc1
    buffer_store_dwordx4 v[132:135], v1, s[16:19], s3 offen offset:2048 sc1
    buffer_store_dwordx4 v[132:135], v1, s[16:19], s3 offen offset:3072 sc1
    s_waitcnt vmcnt(14)
    s_barrier
    s_add_u32 m0, s34, s37
    s_nop 0
    buffer_load_dwordx4 v1, s[8:11], s35 offen offset:0 sc1 lds
    buffer_load_dwordx4 v1, s[8:11], s35 offen offset:1024 sc1 lds
    buffer_load_dwordx4 v1, s[8:11], s35 offen offset:2048 sc1 lds
    buffer_load_dwordx4 v1, s[8:11], s35 offen offset:3072 sc1 lds
    s_add_u32 s35, s35, 16384
    s_cmp_eq_u32 s35, s101
    s_cselect_b32 s3, 32768, 0
    s_add_u32 s35, s35, s3
    s_add_u32 m0, m0, 16384
    s_nop 0
    buffer_load_dwordx4 v1, s[8:11], s35 offen offset:0 sc1 lds
    buffer_load_dwordx4 v1, s[8:11], s35 offen offset:1024 sc1 lds
    buffer_load_dwordx4 v1, s[8:11], s35 offen offset:2048 sc1 lds
    buffer_load_dwordx4 v1, s[8:11], s35 offen offset:3072 sc1 lds
    s_add_u32 s35, s35, 16384
    s_cmp_eq_u32 s35, s101
    s_cselect_b32 s3, 32768, 0
    s_add_u32 s35, s35, s3
    s_add_u32 s34, s34, 49152
    s_cmp_eq_u32 s34, 147456
    s_cselect_b32 s34, 0, s34
    s_add_u32 s8, s86, 20971520
    s_addc_u32 s9, s87, 0
    s_mov_b32 s10, 18874368
    s_mov_b32 s11, 0x20000
    s_mov_b32 s12, s78
    s_mov_b32 s13, s79
    s_mov_b32 s14, 7340032
    s_mov_b32 s15, 0x20000
    s_lshl_b32 s3, s54, 3
    s_lshl_b32 s4, s25, 1
    s_add_u32 s3, s3, s4
    s_mul_i32 s3, s3, 147456
    s_mul_i32 s37, s25, 6144
    s_add_u32 s38, s37, 24576
    v_add_u32 v32, s3, v1
    v_add_u32 v35, 144384, v32
    v_add_u32 v36, 148480, v32
    v_lshrrev_b32 v128, 4, v0
    v_and_b32 v129, 15, v0
    v_lshlrev_b32 v130, 1, v128
    v_xor_b32 v129, v129, v130
    s_mul_i32 s3, s25, 24
    v_add_u32 v128, s3, v128
    v_lshlrev_b32 v128, 11, v128
    v_lshl_add_u32 v128, v129, 4, v128
    s_lshr_b32 s4, s55, 1
    s_lshl_b32 s4, s4, 8
    v_add_u32 v38, s4, v128
    v_xor_b32 v128, 128, v38
    v_add_u32 v39, 7168, v128
    v_add_u32 v40, 14336, v38
    v_add_u32 v41, 21504, v128
    v_add_u32 v42, 32768, v38
    v_add_u32 v43, 39936, v128
    s_and_b32 s3, s55, 1
    s_mul_i32 s35, s3, 55296
    s_mul_i32 s36, s3, 3538944
    s_lshr_b32 s3, s78, 7
    s_sub_u32 s3, 3, s3
    s_and_b32 s3, s3, 7
    s_lshr_b32 s4, s55, 1
    s_lshr_b32 s5, s3, 1
    s_sub_u32 s5, s4, s5
    s_and_b32 s5, s5, 3
    s_lshr_b32 s4, s4, 2
    s_lshl_b32 s4, s4, 10
    s_lshl_b32 s3, s3, 7
    s_add_u32 s4, s4, s3
    s_sub_u32 s6, s5, 1
    s_lshl_b32 s6, s6, 2
    s_and_b32 s3, s54, 3
    s_add_u32 s6, s6, s3
    s_lshl_b32 s6, s6, 2
    s_add_u32 s6, s6, s25
    s_lshl_b32 s6, s6, 12
    s_add_u32 s4, s4, s6
    s_add_u32 s4, s4, 196608
    s_cmp_eq_u32 s5, 0
    s_cselect_b32 s3, 0, 16
    s_cselect_b32 s99, 0x40000000, s4
    s_add_u32 s35, s35, 6144
    s_add_u32 s36, s36, 393216
    s_lshl_b32 s3, s51, 18
    s_add_u32 s3, s3, 4194304
    s_add_u32 s44, s86, s3
    s_addc_u32 s45, s87, 0
    s_mov_b32 s46, 0x40000
    s_mov_b32 s47, 0x20000
    s_lshl_b32 s4, s25, 10
    s_lshl_b32 s100, s41, 15
    s_add_u32 s100, s100, s4
    s_add_u32 s63, s4, 237568
    s_sub_u32 s3, s63, 32768
    s_cmp_ge_u32 s3, s100
    s_cselect_b32 s63, s63, s3
    s_add_u32 s48, s4, 147456
    s_waitcnt vmcnt(8)
    s_barrier
    s_setprio 1
    s_add_u32 s32, s34, 49152
    s_cmp_eq_u32 s32, 147456
    s_cselect_b32 s32, 0, s32
    v_add_u32 v148, s32, v1
    ds_read_b128 v[96:99], v148
    ds_read_b128 v[100:103], v148 offset:1024
    ds_read_b128 v[104:107], v148 offset:2048
    ds_read_b128 v[112:115], v148 offset:3072
    s_waitcnt lgkmcnt(3)
    v_mfma_f32_32x32x16_bf16 v[64:79], v[96:99], v[224:227], v[48:63]
    s_waitcnt lgkmcnt(2)
    v_mfma_f32_32x32x16_bf16 v[64:79], v[100:103], v[228:231], v[64:79]
    s_nop 9
    s_waitcnt lgkmcnt(0)
    s_mov_b32 s31, 4
    s_branch gated_mix__softmax_full_mha__mixer_s_mlp__prompt_kernel_am30
    .p2align 5
gated_mix__softmax_full_mha__mixer_s_mlp__prompt_kernel_al29:
    v_mfma_f32_32x32x16_bf16 v[80:95], v[96:99], v[232:235], v[2:17]
    ds_read_b128 v[96:99], v148 offset:0
    v_exp_f32 v64, v64
    v_exp_f32 v65, v65
    v_exp_f32 v66, v66
    v_mfma_f32_32x32x16_bf16 v[80:95], v[100:103], v[236:239], v[80:95]
    ds_read_b128 v[100:103], v148 offset:1024
    v_exp_f32 v67, v67
    v_exp_f32 v68, v68
    v_exp_f32 v69, v69
    v_smfmac_f32_16x16x64_bf16 v[244:247], v[144:147], v[120:127], v149
    v_exp_f32 v70, v70
    v_exp_f32 v71, v71
    v_mfma_f32_32x32x16_bf16 v[208:223], v[112:115], v[124:127], v[208:223]
    v_cvt_pk_bf16_f32 v120, v64, v65
    v_cvt_pk_bf16_f32 v121, v66, v67
    v_cvt_pk_bf16_f32 v122, v68, v69
    v_cvt_pk_bf16_f32 v123, v70, v71
    v_exp_f32 v72, v72
    v_exp_f32 v73, v73
    v_exp_f32 v74, v74
    v_exp_f32 v75, v75
    s_waitcnt lgkmcnt(0)
    v_mfma_f32_32x32x16_bf16 v[192:207], v[108:111], v[120:123], v[192:207]
    v_exp_f32 v76, v76
    v_exp_f32 v77, v77
    v_exp_f32 v78, v78
    v_exp_f32 v79, v79
    v_cvt_pk_bf16_f32 v124, v72, v73
    v_cvt_pk_bf16_f32 v125, v74, v75
    v_cvt_pk_bf16_f32 v126, v76, v77
    v_cvt_pk_bf16_f32 v127, v78, v79
    v_mfma_f32_32x32x16_bf16 v[64:79], v[96:99], v[224:227], v[48:63]
    ds_read_b128 v[104:107], v148 offset:2048
    v_exp_f32 v80, v80
    v_exp_f32 v81, v81
    v_exp_f32 v82, v82
    v_mfma_f32_32x32x16_bf16 v[64:79], v[100:103], v[228:231], v[64:79]
    ds_read_b128 v[112:115], v148 offset:3072
    v_exp_f32 v83, v83
    v_exp_f32 v84, v84
    v_exp_f32 v85, v85
    v_smfmac_f32_16x16x64_bf16 v[240:243], v[144:147], v[120:127], v149
    v_exp_f32 v86, v86
    v_exp_f32 v87, v87
    v_mfma_f32_32x32x16_bf16 v[192:207], v[116:119], v[124:127], v[192:207]
    v_cvt_pk_bf16_f32 v120, v80, v81
    v_cvt_pk_bf16_f32 v121, v82, v83
    v_cvt_pk_bf16_f32 v122, v84, v85
    v_cvt_pk_bf16_f32 v123, v86, v87
    v_exp_f32 v88, v88
    v_exp_f32 v89, v89
    v_exp_f32 v90, v90
    v_exp_f32 v91, v91
    v_mfma_f32_32x32x16_bf16 v[208:223], v[108:111], v[120:123], v[208:223]
    s_sub_u32 s31, s31, 1
    v_exp_f32 v92, v92
    v_exp_f32 v93, v93
    v_exp_f32 v94, v94
    v_exp_f32 v95, v95
    v_cvt_pk_bf16_f32 v124, v88, v89
    v_cvt_pk_bf16_f32 v125, v90, v91
    v_cvt_pk_bf16_f32 v126, v92, v93
    v_cvt_pk_bf16_f32 v127, v94, v95
gated_mix__softmax_full_mha__mixer_s_mlp__prompt_kernel_am30:
    v_mfma_f32_32x32x16_bf16 v[80:95], v[96:99], v[232:235], v[2:17]
    ds_read_b128 v[96:99], v148 offset:4096
    v_exp_f32 v64, v64
    v_exp_f32 v65, v65
    v_exp_f32 v66, v66
    v_mfma_f32_32x32x16_bf16 v[80:95], v[100:103], v[236:239], v[80:95]
    ds_read_b128 v[100:103], v148 offset:5120
    v_exp_f32 v67, v67
    v_exp_f32 v68, v68
    v_exp_f32 v69, v69
    v_smfmac_f32_16x16x64_bf16 v[244:247], v[144:147], v[120:127], v149
    v_exp_f32 v70, v70
    v_exp_f32 v71, v71
    v_mfma_f32_32x32x16_bf16 v[208:223], v[116:119], v[124:127], v[208:223]
    v_cvt_pk_bf16_f32 v120, v64, v65
    v_cvt_pk_bf16_f32 v121, v66, v67
    v_cvt_pk_bf16_f32 v122, v68, v69
    v_cvt_pk_bf16_f32 v123, v70, v71
    v_exp_f32 v72, v72
    v_exp_f32 v73, v73
    v_exp_f32 v74, v74
    v_exp_f32 v75, v75
    s_waitcnt lgkmcnt(0)
    v_mfma_f32_32x32x16_bf16 v[192:207], v[104:107], v[120:123], v[192:207]
    v_exp_f32 v76, v76
    v_exp_f32 v77, v77
    v_exp_f32 v78, v78
    v_exp_f32 v79, v79
    v_cvt_pk_bf16_f32 v124, v72, v73
    v_cvt_pk_bf16_f32 v125, v74, v75
    v_cvt_pk_bf16_f32 v126, v76, v77
    v_cvt_pk_bf16_f32 v127, v78, v79
    v_mfma_f32_32x32x16_bf16 v[64:79], v[96:99], v[224:227], v[48:63]
    ds_read_b128 v[108:111], v148 offset:6144
    v_exp_f32 v80, v80
    v_exp_f32 v81, v81
    v_exp_f32 v82, v82
    v_mfma_f32_32x32x16_bf16 v[64:79], v[100:103], v[228:231], v[64:79]
    ds_read_b128 v[116:119], v148 offset:7168
    v_exp_f32 v83, v83
    v_exp_f32 v84, v84
    v_exp_f32 v85, v85
    v_smfmac_f32_16x16x64_bf16 v[240:243], v[144:147], v[120:127], v149
    v_exp_f32 v86, v86
    v_exp_f32 v87, v87
    v_mfma_f32_32x32x16_bf16 v[192:207], v[112:115], v[124:127], v[192:207]
    v_cvt_pk_bf16_f32 v120, v80, v81
    v_cvt_pk_bf16_f32 v121, v82, v83
    v_cvt_pk_bf16_f32 v122, v84, v85
    v_cvt_pk_bf16_f32 v123, v86, v87
    v_exp_f32 v88, v88
    v_exp_f32 v89, v89
    v_exp_f32 v90, v90
    v_exp_f32 v91, v91
    v_mfma_f32_32x32x16_bf16 v[208:223], v[104:107], v[120:123], v[208:223]
    v_exp_f32 v92, v92
    v_exp_f32 v93, v93
    v_exp_f32 v94, v94
    v_exp_f32 v95, v95
    v_cvt_pk_bf16_f32 v124, v88, v89
    v_cvt_pk_bf16_f32 v125, v90, v91
    v_cvt_pk_bf16_f32 v126, v92, v93
    v_cvt_pk_bf16_f32 v127, v94, v95
    v_mfma_f32_32x32x16_bf16 v[80:95], v[96:99], v[232:235], v[2:17]
    ds_read_b128 v[96:99], v148 offset:8192
    v_exp_f32 v64, v64
    v_exp_f32 v65, v65
    v_exp_f32 v66, v66
    v_mfma_f32_32x32x16_bf16 v[80:95], v[100:103], v[236:239], v[80:95]
    ds_read_b128 v[100:103], v148 offset:9216
    v_exp_f32 v67, v67
    v_exp_f32 v68, v68
    v_exp_f32 v69, v69
    v_smfmac_f32_16x16x64_bf16 v[244:247], v[144:147], v[120:127], v149
    v_exp_f32 v70, v70
    v_exp_f32 v71, v71
    v_mfma_f32_32x32x16_bf16 v[208:223], v[112:115], v[124:127], v[208:223]
    v_cvt_pk_bf16_f32 v120, v64, v65
    v_cvt_pk_bf16_f32 v121, v66, v67
    v_cvt_pk_bf16_f32 v122, v68, v69
    v_cvt_pk_bf16_f32 v123, v70, v71
    v_exp_f32 v72, v72
    v_exp_f32 v73, v73
    v_exp_f32 v74, v74
    v_exp_f32 v75, v75
    s_waitcnt lgkmcnt(0)
    v_mfma_f32_32x32x16_bf16 v[192:207], v[108:111], v[120:123], v[192:207]
    v_exp_f32 v76, v76
    v_exp_f32 v77, v77
    v_exp_f32 v78, v78
    v_exp_f32 v79, v79
    v_cvt_pk_bf16_f32 v124, v72, v73
    v_cvt_pk_bf16_f32 v125, v74, v75
    v_cvt_pk_bf16_f32 v126, v76, v77
    v_cvt_pk_bf16_f32 v127, v78, v79
    v_mfma_f32_32x32x16_bf16 v[64:79], v[96:99], v[224:227], v[48:63]
    ds_read_b128 v[104:107], v148 offset:10240
    v_exp_f32 v80, v80
    v_exp_f32 v81, v81
    v_exp_f32 v82, v82
    v_mfma_f32_32x32x16_bf16 v[64:79], v[100:103], v[228:231], v[64:79]
    ds_read_b128 v[112:115], v148 offset:11264
    v_exp_f32 v83, v83
    v_exp_f32 v84, v84
    v_exp_f32 v85, v85
    v_smfmac_f32_16x16x64_bf16 v[240:243], v[144:147], v[120:127], v149
    v_exp_f32 v86, v86
    v_exp_f32 v87, v87
    v_mfma_f32_32x32x16_bf16 v[192:207], v[116:119], v[124:127], v[192:207]
    v_cvt_pk_bf16_f32 v120, v80, v81
    v_cvt_pk_bf16_f32 v121, v82, v83
    v_cvt_pk_bf16_f32 v122, v84, v85
    v_cvt_pk_bf16_f32 v123, v86, v87
    v_exp_f32 v88, v88
    v_exp_f32 v89, v89
    v_exp_f32 v90, v90
    v_exp_f32 v91, v91
    v_mfma_f32_32x32x16_bf16 v[208:223], v[108:111], v[120:123], v[208:223]
    v_exp_f32 v92, v92
    v_exp_f32 v93, v93
    v_exp_f32 v94, v94
    v_exp_f32 v95, v95
    v_cvt_pk_bf16_f32 v124, v88, v89
    v_cvt_pk_bf16_f32 v125, v90, v91
    v_cvt_pk_bf16_f32 v126, v92, v93
    v_cvt_pk_bf16_f32 v127, v94, v95
    v_mfma_f32_32x32x16_bf16 v[80:95], v[96:99], v[232:235], v[2:17]
    ds_read_b128 v[96:99], v148 offset:12288
    v_exp_f32 v64, v64
    v_exp_f32 v65, v65
    v_exp_f32 v66, v66
    v_mfma_f32_32x32x16_bf16 v[80:95], v[100:103], v[236:239], v[80:95]
    ds_read_b128 v[100:103], v148 offset:13312
    v_exp_f32 v67, v67
    v_exp_f32 v68, v68
    v_exp_f32 v69, v69
    v_smfmac_f32_16x16x64_bf16 v[244:247], v[144:147], v[120:127], v149
    v_exp_f32 v70, v70
    v_exp_f32 v71, v71
    v_mfma_f32_32x32x16_bf16 v[208:223], v[116:119], v[124:127], v[208:223]
    v_cvt_pk_bf16_f32 v120, v64, v65
    v_cvt_pk_bf16_f32 v121, v66, v67
    v_cvt_pk_bf16_f32 v122, v68, v69
    v_cvt_pk_bf16_f32 v123, v70, v71
    v_exp_f32 v72, v72
    v_exp_f32 v73, v73
    v_exp_f32 v74, v74
    v_exp_f32 v75, v75
    s_waitcnt lgkmcnt(0)
    v_mfma_f32_32x32x16_bf16 v[192:207], v[104:107], v[120:123], v[192:207]
    v_exp_f32 v76, v76
    v_exp_f32 v77, v77
    v_exp_f32 v78, v78
    v_exp_f32 v79, v79
    v_cvt_pk_bf16_f32 v124, v72, v73
    v_cvt_pk_bf16_f32 v125, v74, v75
    v_cvt_pk_bf16_f32 v126, v76, v77
    v_cvt_pk_bf16_f32 v127, v78, v79
    v_mfma_f32_32x32x16_bf16 v[64:79], v[96:99], v[224:227], v[48:63]
    ds_read_b128 v[108:111], v148 offset:14336
    v_exp_f32 v80, v80
    v_exp_f32 v81, v81
    v_exp_f32 v82, v82
    v_mfma_f32_32x32x16_bf16 v[64:79], v[100:103], v[228:231], v[64:79]
    ds_read_b128 v[116:119], v148 offset:15360
    v_exp_f32 v83, v83
    v_exp_f32 v84, v84
    v_exp_f32 v85, v85
    v_smfmac_f32_16x16x64_bf16 v[240:243], v[144:147], v[120:127], v149
    v_exp_f32 v86, v86
    v_exp_f32 v87, v87
    v_mfma_f32_32x32x16_bf16 v[192:207], v[112:115], v[124:127], v[192:207]
    v_cvt_pk_bf16_f32 v120, v80, v81
    v_cvt_pk_bf16_f32 v121, v82, v83
    v_cvt_pk_bf16_f32 v122, v84, v85
    v_cvt_pk_bf16_f32 v123, v86, v87
    v_exp_f32 v88, v88
    v_exp_f32 v89, v89
    v_exp_f32 v90, v90
    v_exp_f32 v91, v91
    v_mfma_f32_32x32x16_bf16 v[208:223], v[104:107], v[120:123], v[208:223]
    s_bitcmp1_b32 0x1a, s31
    v_exp_f32 v92, v92
    v_exp_f32 v93, v93
    v_exp_f32 v94, v94
    v_exp_f32 v95, v95
    v_cvt_pk_bf16_f32 v124, v88, v89
    v_cvt_pk_bf16_f32 v125, v90, v91
    v_cvt_pk_bf16_f32 v126, v92, v93
    v_cvt_pk_bf16_f32 v127, v94, v95
    v_add_u32 v148, 16384, v148
    s_cbranch_scc0 gated_mix__softmax_full_mha__mixer_s_mlp__prompt_kernel_al29
    s_cmp_eq_u32 s31, 4
    s_cbranch_scc0 gated_mix__softmax_full_mha__mixer_s_mlp__prompt_kernel_an32
    s_waitcnt vmcnt(0)
    v_mov_b32 v18, 153356
    v_mov_b32 v19, 1
    s_mov_b64 exec, 1
    ds_add_u32 v18, v19
    s_mov_b64 exec, -1
    s_branch gated_mix__softmax_full_mha__mixer_s_mlp__prompt_kernel_al29
gated_mix__softmax_full_mha__mixer_s_mlp__prompt_kernel_an32:
    s_cmp_eq_u32 s31, 3
    s_cbranch_scc0 gated_mix__softmax_full_mha__mixer_s_mlp__prompt_kernel_an33
    v_mov_b32 v139, 153356
    s_mov_b32 s5, 1600000
gated_mix__softmax_full_mha__mixer_s_mlp__prompt_kernel_fr34:
    ds_read_b32 v137, v139
    s_sub_u32 s5, s5, 1
    s_cmp_eq_u32 s5, 0
    s_cbranch_scc1 gated_mix__softmax_full_mha__mixer_s_mlp__prompt_kernel_fre35
    s_waitcnt lgkmcnt(0)
    v_cmp_gt_u32 vcc, 8, v137
    s_nop 4
    s_cbranch_vccz gated_mix__softmax_full_mha__mixer_s_mlp__prompt_kernel_fre35
    s_sleep 2
    s_branch gated_mix__softmax_full_mha__mixer_s_mlp__prompt_kernel_fr34
gated_mix__softmax_full_mha__mixer_s_mlp__prompt_kernel_fre35:
    s_add_u32 s32, s32, 49152
    s_cmp_eq_u32 s32, 147456
    s_cselect_b32 s33, s39, 49152
    s_cselect_b32 s32, 0, s32
    v_add_u32 v148, s32, v1
    s_waitcnt lgkmcnt(0)
    v_mov_b32 v18, 153352
    v_mov_b32 v19, 1
    s_mov_b64 exec, 1
    ds_add_u32 v18, v19
    s_mov_b64 exec, -1
    s_branch gated_mix__softmax_full_mha__mixer_s_mlp__prompt_kernel_al29
gated_mix__softmax_full_mha__mixer_s_mlp__prompt_kernel_an33:
    s_mov_b32 s34, s32
    s_add_u32 s32, s32, 49152
    s_cmp_eq_u32 s32, 147456
    s_cselect_b32 s33, s39, 49152
    s_cselect_b32 s32, 0, s32
    v_add_u32 v148, s32, v1
    s_waitcnt lgkmcnt(0)
    s_barrier
    s_mov_b32 s31, 4
gated_mix__softmax_full_mha__mixer_s_mlp__prompt_kernel_hl37:
    s_lshr_b32 s3, s32, 3
    s_add_u32 s3, s3, 147456
    v_add_u32 v148, s3, v1
    s_lshr_b32 s3, s34, 3
    s_add_u32 m0, s3, s48
    s_nop 0
    buffer_load_dwordx4 v1, s[44:47], s63 offen sc1 lds
    s_add_u32 s63, s63, 4096
    s_cmp_eq_u32 s63, s100
    s_cselect_b32 s3, 32768, 0
    s_add_u32 s63, s63, s3
    s_add_u32 m0, s34, s37
    s_nop 0
    buffer_load_dwordx4 v32, s[8:11], s35 offen offset:0 sc1 lds
    v_mfma_f32_32x32x16_bf16 v[80:95], v[96:99], v[232:235], v[2:17]
    buffer_load_dwordx4 v32, s[8:11], s35 offen offset:1024 sc1 lds
    ds_read_b128 v[96:99], v148 offset:0
    v_exp_f32 v64, v64
    v_exp_f32 v65, v65
    v_exp_f32 v66, v66
    v_mfma_f32_32x32x16_bf16 v[80:95], v[100:103], v[236:239], v[80:95]
    buffer_load_dwordx4 v32, s[8:11], s35 offen offset:2048 sc1 lds
    ds_read_b128 v[100:103], v148 offset:1024
    v_exp_f32 v67, v67
    v_exp_f32 v68, v68
    v_exp_f32 v69, v69
    v_smfmac_f32_16x16x64_bf16 v[244:247], v[144:147], v[120:127], v149
    buffer_load_dwordx4 v35, s[8:11], s35 offen offset:3072 sc1 lds
    v_exp_f32 v70, v70
    v_exp_f32 v71, v71
    v_mfma_f32_32x32x16_bf16 v[208:223], v[112:115], v[124:127], v[208:223]
    s_add_u32 m0, m0, 4096
    s_nop 0
    buffer_load_dwordx4 v36, s[8:11], s35 offen offset:0 sc1 lds
    v_cvt_pk_bf16_f32 v120, v64, v65
    v_cvt_pk_bf16_f32 v121, v66, v67
    v_cvt_pk_bf16_f32 v122, v68, v69
    v_cvt_pk_bf16_f32 v123, v70, v71
    v_exp_f32 v72, v72
    v_exp_f32 v73, v73
    v_exp_f32 v74, v74
    v_exp_f32 v75, v75
    s_waitcnt lgkmcnt(0)
    v_mfma_f32_32x32x16_bf16 v[192:207], v[108:111], v[120:123], v[192:207]
    buffer_load_dwordx4 v36, s[8:11], s35 offen offset:1024 sc1 lds
    s_add_u32 m0, s34, s38
    s_nop 0
    buffer_load_dwordx4 v38, s[12:15], s36 offen offset:0  lds
    v_exp_f32 v76, v76
    v_exp_f32 v77, v77
    v_exp_f32 v78, v78
    v_exp_f32 v79, v79
    v_cvt_pk_bf16_f32 v124, v72, v73
    v_cvt_pk_bf16_f32 v125, v74, v75
    v_cvt_pk_bf16_f32 v126, v76, v77
    v_cvt_pk_bf16_f32 v127, v78, v79
    v_mfma_f32_32x32x16_bf16 v[64:79], v[96:99], v[224:227], v[48:63]
    buffer_load_dwordx4 v39, s[12:15], s36 offen offset:1024  lds
    ds_read_b128 v[104:107], v148 offset:2048
    v_exp_f32 v80, v80
    v_exp_f32 v81, v81
    v_exp_f32 v82, v82
    v_mfma_f32_32x32x16_bf16 v[64:79], v[100:103], v[228:231], v[64:79]
    buffer_load_dwordx4 v40, s[12:15], s36 offen offset:2048  lds
    ds_read_b128 v[112:115], v148 offset:3072
    v_exp_f32 v83, v83
    v_exp_f32 v84, v84
    v_exp_f32 v85, v85
    v_smfmac_f32_16x16x64_bf16 v[240:243], v[144:147], v[120:127], v149
    buffer_load_dwordx4 v41, s[12:15], s36 offen offset:3072  lds
    v_exp_f32 v86, v86
    v_exp_f32 v87, v87
    v_mfma_f32_32x32x16_bf16 v[192:207], v[116:119], v[124:127], v[192:207]
    s_add_u32 m0, m0, 4096
    s_nop 0
    buffer_load_dwordx4 v42, s[12:15], s36 offen offset:0  lds
    v_cvt_pk_bf16_f32 v120, v80, v81
    v_cvt_pk_bf16_f32 v121, v82, v83
    v_cvt_pk_bf16_f32 v122, v84, v85
    v_cvt_pk_bf16_f32 v123, v86, v87
    v_exp_f32 v88, v88
    v_exp_f32 v89, v89
    v_exp_f32 v90, v90
    v_exp_f32 v91, v91
    v_mfma_f32_32x32x16_bf16 v[208:223], v[108:111], v[120:123], v[208:223]
    buffer_load_dwordx4 v43, s[12:15], s36 offen offset:1024  lds
    s_add_u32 s35, s35, 3072
    s_add_u32 s36, s36, 196608
    s_add_u32 s34, s34, 49152
    s_cmp_eq_u32 s34, 147456
    s_cselect_b32 s34, 0, s34
    s_add_u32 s32, s32, 49152
    s_cmp_eq_u32 s32, 147456
    s_cselect_b32 s33, s39, 49152
    s_cselect_b32 s32, 0, s32
    v_exp_f32 v92, v92
    v_exp_f32 v93, v93
    v_exp_f32 v94, v94
    v_exp_f32 v95, v95
    v_cvt_pk_bf16_f32 v124, v88, v89
    v_cvt_pk_bf16_f32 v125, v90, v91
    v_cvt_pk_bf16_f32 v126, v92, v93
    v_cvt_pk_bf16_f32 v127, v94, v95
    s_waitcnt vmcnt(13) lgkmcnt(0)
    s_barrier
    s_lshr_b32 s3, s32, 3
    s_add_u32 s3, s3, 147456
    v_add_u32 v148, s3, v1
    s_lshr_b32 s3, s34, 3
    s_add_u32 m0, s3, s48
    s_nop 0
    buffer_load_dwordx4 v1, s[44:47], s63 offen sc1 lds
    s_add_u32 s63, s63, 4096
    s_cmp_eq_u32 s63, s100
    s_cselect_b32 s3, 32768, 0
    s_add_u32 s63, s63, s3
    s_add_u32 m0, s34, s37
    s_nop 0
    buffer_load_dwordx4 v32, s[8:11], s35 offen offset:0 sc1 lds
    v_mfma_f32_32x32x16_bf16 v[80:95], v[96:99], v[232:235], v[2:17]
    buffer_load_dwordx4 v32, s[8:11], s35 offen offset:1024 sc1 lds
    ds_read_b128 v[96:99], v148 offset:0
    v_exp_f32 v64, v64
    v_exp_f32 v65, v65
    v_exp_f32 v66, v66
    v_mfma_f32_32x32x16_bf16 v[80:95], v[100:103], v[236:239], v[80:95]
    buffer_load_dwordx4 v32, s[8:11], s35 offen offset:2048 sc1 lds
    ds_read_b128 v[100:103], v148 offset:1024
    v_exp_f32 v67, v67
    v_exp_f32 v68, v68
    v_exp_f32 v69, v69
    v_smfmac_f32_16x16x64_bf16 v[244:247], v[144:147], v[120:127], v149
    buffer_load_dwordx4 v35, s[8:11], s35 offen offset:3072 sc1 lds
    v_exp_f32 v70, v70
    v_exp_f32 v71, v71
    v_mfma_f32_32x32x16_bf16 v[208:223], v[116:119], v[124:127], v[208:223]
    s_add_u32 m0, m0, 4096
    s_nop 0
    buffer_load_dwordx4 v36, s[8:11], s35 offen offset:0 sc1 lds
    v_cvt_pk_bf16_f32 v120, v64, v65
    v_cvt_pk_bf16_f32 v121, v66, v67
    v_cvt_pk_bf16_f32 v122, v68, v69
    v_cvt_pk_bf16_f32 v123, v70, v71
    v_exp_f32 v72, v72
    v_exp_f32 v73, v73
    v_exp_f32 v74, v74
    v_exp_f32 v75, v75
    s_waitcnt lgkmcnt(0)
    v_mfma_f32_32x32x16_bf16 v[192:207], v[104:107], v[120:123], v[192:207]
    buffer_load_dwordx4 v36, s[8:11], s35 offen offset:1024 sc1 lds
    s_add_u32 m0, s34, s38
    s_nop 0
    buffer_load_dwordx4 v38, s[12:15], s36 offen offset:0  lds
    v_exp_f32 v76, v76
    v_exp_f32 v77, v77
    v_exp_f32 v78, v78
    v_exp_f32 v79, v79
    v_cvt_pk_bf16_f32 v124, v72, v73
    v_cvt_pk_bf16_f32 v125, v74, v75
    v_cvt_pk_bf16_f32 v126, v76, v77
    v_cvt_pk_bf16_f32 v127, v78, v79
    v_mfma_f32_32x32x16_bf16 v[64:79], v[96:99], v[224:227], v[48:63]
    buffer_load_dwordx4 v39, s[12:15], s36 offen offset:1024  lds
    ds_read_b128 v[108:111], v148 offset:2048
    v_exp_f32 v80, v80
    v_exp_f32 v81, v81
    v_exp_f32 v82, v82
    v_mfma_f32_32x32x16_bf16 v[64:79], v[100:103], v[228:231], v[64:79]
    buffer_load_dwordx4 v40, s[12:15], s36 offen offset:2048  lds
    ds_read_b128 v[116:119], v148 offset:3072
    v_exp_f32 v83, v83
    v_exp_f32 v84, v84
    v_exp_f32 v85, v85
    v_smfmac_f32_16x16x64_bf16 v[240:243], v[144:147], v[120:127], v149
    buffer_load_dwordx4 v41, s[12:15], s36 offen offset:3072  lds
    v_exp_f32 v86, v86
    v_exp_f32 v87, v87
    v_mfma_f32_32x32x16_bf16 v[192:207], v[112:115], v[124:127], v[192:207]
    s_add_u32 m0, m0, 4096
    s_nop 0
    buffer_load_dwordx4 v42, s[12:15], s36 offen offset:0  lds
    v_cvt_pk_bf16_f32 v120, v80, v81
    v_cvt_pk_bf16_f32 v121, v82, v83
    v_cvt_pk_bf16_f32 v122, v84, v85
    v_cvt_pk_bf16_f32 v123, v86, v87
    v_exp_f32 v88, v88
    v_exp_f32 v89, v89
    v_exp_f32 v90, v90
    v_exp_f32 v91, v91
    v_mfma_f32_32x32x16_bf16 v[208:223], v[104:107], v[120:123], v[208:223]
    buffer_load_dwordx4 v43, s[12:15], s36 offen offset:1024  lds
    s_add_u32 s35, s35, 3072
    s_add_u32 s36, s36, 196608
    s_add_u32 s34, s34, 49152
    s_cmp_eq_u32 s34, 147456
    s_cselect_b32 s34, 0, s34
    s_add_u32 s32, s32, 49152
    s_cmp_eq_u32 s32, 147456
    s_cselect_b32 s33, s39, 49152
    s_cselect_b32 s32, 0, s32
    v_exp_f32 v92, v92
    v_exp_f32 v93, v93
    v_exp_f32 v94, v94
    v_exp_f32 v95, v95
    v_cvt_pk_bf16_f32 v124, v88, v89
    v_cvt_pk_bf16_f32 v125, v90, v91
    v_cvt_pk_bf16_f32 v126, v92, v93
    v_cvt_pk_bf16_f32 v127, v94, v95
    s_waitcnt vmcnt(13) lgkmcnt(0)
    s_barrier
    s_sub_u32 s31, s31, 1
    s_cmp_lg_u32 s31, 0
    s_cbranch_scc1 gated_mix__softmax_full_mha__mixer_s_mlp__prompt_kernel_hl37
    s_lshr_b32 s3, s32, 3
    s_add_u32 s3, s3, 147456
    v_add_u32 v148, s3, v1
    s_add_u32 m0, s34, s37
    s_nop 0
    buffer_load_dwordx4 v32, s[8:11], s35 offen offset:0 sc1 lds
    buffer_load_dwordx4 v32, s[8:11], s35 offen offset:1024 sc1 lds
    v_mfma_f32_32x32x16_bf16 v[80:95], v[96:99], v[232:235], v[2:17]
    buffer_load_dwordx4 v32, s[8:11], s35 offen offset:2048 sc1 lds
    ds_read_b128 v[96:99], v148 offset:0
    v_exp_f32 v64, v64
    v_exp_f32 v65, v65
    v_exp_f32 v66, v66
    v_mfma_f32_32x32x16_bf16 v[80:95], v[100:103], v[236:239], v[80:95]
    buffer_load_dwordx4 v35, s[8:11], s35 offen offset:3072 sc1 lds
    ds_read_b128 v[100:103], v148 offset:1024
    v_exp_f32 v67, v67
    v_exp_f32 v68, v68
    v_exp_f32 v69, v69
    v_smfmac_f32_16x16x64_bf16 v[244:247], v[144:147], v[120:127], v149
    s_add_u32 m0, m0, 4096
    s_nop 0
    buffer_load_dwordx4 v36, s[8:11], s35 offen offset:0 sc1 lds
    v_exp_f32 v70, v70
    v_exp_f32 v71, v71
    v_mfma_f32_32x32x16_bf16 v[208:223], v[112:115], v[124:127], v[208:223]
    buffer_load_dwordx4 v36, s[8:11], s35 offen offset:1024 sc1 lds
    v_cvt_pk_bf16_f32 v120, v64, v65
    v_cvt_pk_bf16_f32 v121, v66, v67
    v_cvt_pk_bf16_f32 v122, v68, v69
    v_cvt_pk_bf16_f32 v123, v70, v71
    v_exp_f32 v72, v72
    v_exp_f32 v73, v73
    v_exp_f32 v74, v74
    v_exp_f32 v75, v75
    s_waitcnt lgkmcnt(0)
    v_mfma_f32_32x32x16_bf16 v[192:207], v[108:111], v[120:123], v[192:207]
    s_add_u32 m0, s34, s38
    s_nop 0
    buffer_load_dwordx4 v38, s[12:15], s36 offen offset:0  lds
    v_exp_f32 v76, v76
    v_exp_f32 v77, v77
    v_exp_f32 v78, v78
    v_exp_f32 v79, v79
    v_cvt_pk_bf16_f32 v124, v72, v73
    v_cvt_pk_bf16_f32 v125, v74, v75
    v_cvt_pk_bf16_f32 v126, v76, v77
    v_cvt_pk_bf16_f32 v127, v78, v79
    v_mfma_f32_32x32x16_bf16 v[64:79], v[96:99], v[224:227], v[48:63]
    buffer_load_dwordx4 v39, s[12:15], s36 offen offset:1024  lds
    ds_read_b128 v[104:107], v148 offset:2048
    v_exp_f32 v80, v80
    v_exp_f32 v81, v81
    v_exp_f32 v82, v82
    v_mfma_f32_32x32x16_bf16 v[64:79], v[100:103], v[228:231], v[64:79]
    buffer_load_dwordx4 v40, s[12:15], s36 offen offset:2048  lds
    ds_read_b128 v[112:115], v148 offset:3072
    v_exp_f32 v83, v83
    v_exp_f32 v84, v84
    v_exp_f32 v85, v85
    v_smfmac_f32_16x16x64_bf16 v[240:243], v[144:147], v[120:127], v149
    buffer_load_dwordx4 v41, s[12:15], s36 offen offset:3072  lds
    v_exp_f32 v86, v86
    v_exp_f32 v87, v87
    v_mfma_f32_32x32x16_bf16 v[192:207], v[116:119], v[124:127], v[192:207]
    s_add_u32 m0, m0, 4096
    s_nop 0
    buffer_load_dwordx4 v42, s[12:15], s36 offen offset:0  lds
    v_cvt_pk_bf16_f32 v120, v80, v81
    v_cvt_pk_bf16_f32 v121, v82, v83
    v_cvt_pk_bf16_f32 v122, v84, v85
    v_cvt_pk_bf16_f32 v123, v86, v87
    v_exp_f32 v88, v88
    v_exp_f32 v89, v89
    v_exp_f32 v90, v90
    v_exp_f32 v91, v91
    v_mfma_f32_32x32x16_bf16 v[208:223], v[108:111], v[120:123], v[208:223]
    buffer_load_dwordx4 v43, s[12:15], s36 offen offset:1024  lds
    s_add_u32 s35, s35, 3072
    s_add_u32 s36, s36, 196608
    s_add_u32 s34, s34, 49152
    s_cmp_eq_u32 s34, 147456
    s_cselect_b32 s34, 0, s34
    s_add_u32 s32, s32, 49152
    s_cmp_eq_u32 s32, 147456
    s_cselect_b32 s33, s39, 49152
    s_cselect_b32 s32, 0, s32
    v_exp_f32 v92, v92
    v_exp_f32 v93, v93
    v_exp_f32 v94, v94
    v_exp_f32 v95, v95
    v_cvt_pk_bf16_f32 v124, v88, v89
    v_cvt_pk_bf16_f32 v125, v90, v91
    v_cvt_pk_bf16_f32 v126, v92, v93
    v_cvt_pk_bf16_f32 v127, v94, v95
    s_nop 1
    v_mfma_f32_32x32x16_bf16 v[208:223], v[116:119], v[124:127], v[208:223]
    v_smfmac_f32_16x16x64_bf16 v[244:247], v[144:147], v[120:127], v149
    s_waitcnt lgkmcnt(0)
    s_setprio 0
    s_waitcnt vmcnt(12) lgkmcnt(0)
    s_barrier
    s_add_u32 m0, s34, s37
    s_nop 0
    buffer_load_dwordx4 v32, s[8:11], s35 offen offset:0 sc1 lds
    v_add_f32 v18, v240, v241
    s_nop 3
    v_add_f32 v19, v244, v245
    v_fma_f32 v18, v192, 0, v18
    v_fma_f32 v19, v208, 0, v19
    v_fma_f32 v18, v193, 0, v18
    v_fma_f32 v19, v209, 0, v19
    v_fma_f32 v18, v194, 0, v18
    v_fma_f32 v19, v210, 0, v19
    buffer_load_dwordx4 v32, s[8:11], s35 offen offset:1024 sc1 lds
    v_fma_f32 v18, v195, 0, v18
    v_fma_f32 v19, v211, 0, v19
    v_fma_f32 v18, v196, 0, v18
    v_fma_f32 v19, v212, 0, v19
    v_fma_f32 v18, v197, 0, v18
    v_fma_f32 v19, v213, 0, v19
    v_fma_f32 v18, v198, 0, v18
    v_fma_f32 v19, v214, 0, v19
    v_fma_f32 v18, v199, 0, v18
    buffer_load_dwordx4 v32, s[8:11], s35 offen offset:2048 sc1 lds
    v_fma_f32 v19, v215, 0, v19
    v_fma_f32 v18, v200, 0, v18
    v_fma_f32 v19, v216, 0, v19
    v_fma_f32 v18, v201, 0, v18
    v_fma_f32 v19, v217, 0, v19
    v_fma_f32 v18, v202, 0, v18
    v_fma_f32 v19, v218, 0, v19
    v_fma_f32 v18, v203, 0, v18
    v_fma_f32 v19, v219, 0, v19
    buffer_load_dwordx4 v35, s[8:11], s35 offen offset:3072 sc1 lds
    v_fma_f32 v18, v204, 0, v18
    v_fma_f32 v19, v220, 0, v19
    v_fma_f32 v18, v205, 0, v18
    v_fma_f32 v19, v221, 0, v19
    v_fma_f32 v18, v206, 0, v18
    v_fma_f32 v19, v222, 0, v19
    v_fma_f32 v18, v207, 0, v18
    v_fma_f32 v19, v223, 0, v19
    v_mov_b32 v20, 0x5f800000
    v_cmp_nlt_f32 vcc, v18, v20
    s_nop 4
    s_cbranch_vccnz gated_mix__softmax_full_mha__mixer_s_mlp__prompt_kernel_fbk39
gated_mix__softmax_full_mha__mixer_s_mlp__prompt_kernel_ok38:
    v_cmp_nlt_f32 vcc, v19, v20
    s_nop 4
    s_cbranch_vccnz gated_mix__softmax_full_mha__mixer_s_mlp__prompt_kernel_fbk41
gated_mix__softmax_full_mha__mixer_s_mlp__prompt_kernel_ok40:
    s_add_u32 m0, m0, 4096
    s_nop 0
    buffer_load_dwordx4 v36, s[8:11], s35 offen offset:0 sc1 lds
    v_rcp_f32 v18, v18
    v_rcp_f32 v19, v19
    v_and_b32 v20, 15, v0
    v_bfe_u32 v21, v0, 4, 1
    v_lshrrev_b32 v22, 5, v0
    v_mul_u32_u24 v21, 147456, v21
    v_lshl_add_u32 v21, v20, 4, v21
    buffer_load_dwordx4 v36, s[8:11], s35 offen offset:1024 sc1 lds
    v_lshl_add_u32 v21, v22, 8, v21
    s_lshl_b32 s3, s41, 2
    s_add_u32 s3, s3, s25
    s_mul_i32 s3, s3, 589824
    s_lshl_b32 s4, s51, 10
    s_add_u32 s3, s3, s4
    s_add_u32 s49, s3, 21086208
    s_add_u32 s50, s49, 294912
    v_mul_f32 v18, v18, v250
    v_mul_f32 v19, v19, v251
    v_mul_f32 v192, v192, v18
    v_mul_f32 v193, v193, v18
    v_mul_f32 v194, v194, v18
    s_add_u32 m0, s34, s38
    s_nop 0
    buffer_load_dwordx4 v38, s[12:15], s36 offen offset:0  lds
    v_mul_f32 v195, v195, v18
    v_mul_f32 v196, v196, v18
    v_mul_f32 v197, v197, v18
    v_mul_f32 v198, v198, v18
    v_mul_f32 v199, v199, v18
    v_mul_f32 v200, v200, v18
    v_mul_f32 v201, v201, v18
    v_mul_f32 v202, v202, v18
    buffer_load_dwordx4 v39, s[12:15], s36 offen offset:1024  lds
    v_mul_f32 v203, v203, v18
    v_mul_f32 v204, v204, v18
    v_mul_f32 v205, v205, v18
    v_mul_f32 v206, v206, v18
    v_mul_f32 v207, v207, v18
    v_cvt_pk_bf16_f32 v192, v192, v193
    v_cvt_pk_bf16_f32 v193, v194, v195
    buffer_load_dwordx4 v40, s[12:15], s36 offen offset:2048  lds
    v_cvt_pk_bf16_f32 v194, v196, v197
    v_cvt_pk_bf16_f32 v195, v198, v199
    v_cvt_pk_bf16_f32 v196, v200, v201
    v_cvt_pk_bf16_f32 v197, v202, v203
    v_cvt_pk_bf16_f32 v198, v204, v205
    v_cvt_pk_bf16_f32 v199, v206, v207
    v_mul_f32 v208, v208, v19
    buffer_load_dwordx4 v41, s[12:15], s36 offen offset:3072  lds
    v_mul_f32 v209, v209, v19
    v_mul_f32 v210, v210, v19
    v_mul_f32 v211, v211, v19
    v_mul_f32 v212, v212, v19
    v_mul_f32 v213, v213, v19
    v_mul_f32 v214, v214, v19
    v_mul_f32 v215, v215, v19
    v_mul_f32 v216, v216, v19
    s_add_u32 m0, m0, 4096
    s_nop 0
    buffer_load_dwordx4 v42, s[12:15], s36 offen offset:0  lds
    v_mul_f32 v217, v217, v19
    v_mul_f32 v218, v218, v19
    v_mul_f32 v219, v219, v19
    v_mul_f32 v220, v220, v19
    v_mul_f32 v221, v221, v19
    v_mul_f32 v222, v222, v19
    v_mul_f32 v223, v223, v19
    buffer_load_dwordx4 v43, s[12:15], s36 offen offset:1024  lds
    s_add_u32 s35, s35, 3072
    s_add_u32 s36, s36, 196608
    s_add_u32 s34, s34, 49152
    s_cmp_eq_u32 s34, 147456
    s_cselect_b32 s34, 0, s34
    v_cvt_pk_bf16_f32 v208, v208, v209
    v_cvt_pk_bf16_f32 v209, v210, v211
    v_cvt_pk_bf16_f32 v210, v212, v213
    v_cvt_pk_bf16_f32 v211, v214, v215
    v_cvt_pk_bf16_f32 v212, v216, v217
    v_cvt_pk_bf16_f32 v213, v218, v219
    v_cvt_pk_bf16_f32 v214, v220, v221
    v_cvt_pk_bf16_f32 v215, v222, v223
    buffer_store_dwordx4 v[192:195], v21, s[16:19], s49 offen offset:0 sc1
    buffer_store_dwordx4 v[196:199], v21, s[16:19], s49 offen offset:512 sc1
    buffer_store_dwordx4 v[208:211], v21, s[16:19], s50 offen offset:0 sc1
    buffer_store_dwordx4 v[212:215], v21, s[16:19], s50 offen offset:512 sc1
    s_add_u32 s3, s99, s36
    s_sub_u32 s4, s14, 4096
    s_min_u32 s3, s3, s4
    s_buffer_load_dword s98, s[12:15], s3 offset:0x0
    s_buffer_load_dword s98, s[12:15], s3 offset:0x40
    s_buffer_load_dword s98, s[12:15], s3 offset:0x800
    s_buffer_load_dword s98, s[12:15], s3 offset:0x840
    s_waitcnt vmcnt(16)
    s_barrier
    s_add_u32 m0, s34, s37
    s_nop 0
    buffer_load_dwordx4 v32, s[8:11], s35 offen offset:0 sc1 lds
    buffer_load_dwordx4 v32, s[8:11], s35 offen offset:1024 sc1 lds
    buffer_load_dwordx4 v32, s[8:11], s35 offen offset:2048 sc1 lds
    buffer_load_dwordx4 v35, s[8:11], s35 offen offset:3072 sc1 lds
    s_add_u32 m0, m0, 4096
    s_nop 0
    buffer_load_dwordx4 v36, s[8:11], s35 offen offset:0 sc1 lds
    buffer_load_dwordx4 v36, s[8:11], s35 offen offset:1024 sc1 lds
    s_add_u32 m0, s34, s38
    s_nop 0
    buffer_load_dwordx4 v38, s[12:15], s36 offen offset:0  lds
    buffer_load_dwordx4 v39, s[12:15], s36 offen offset:1024  lds
    buffer_load_dwordx4 v40, s[12:15], s36 offen offset:2048  lds
    buffer_load_dwordx4 v41, s[12:15], s36 offen offset:3072  lds
    s_add_u32 m0, m0, 4096
    s_nop 0
    buffer_load_dwordx4 v42, s[12:15], s36 offen offset:0  lds
    buffer_load_dwordx4 v43, s[12:15], s36 offen offset:1024  lds
    s_add_u32 s35, s35, 3072
    s_add_u32 s36, s36, 196608
    s_add_u32 s34, s34, 49152
    s_cmp_eq_u32 s34, 147456
    s_cselect_b32 s34, 0, s34
    s_add_u32 s3, s99, s36
    s_sub_u32 s4, s14, 4096
    s_min_u32 s3, s3, s4
    s_buffer_load_dword s98, s[12:15], s3 offset:0x0
    s_buffer_load_dword s98, s[12:15], s3 offset:0x40
    s_buffer_load_dword s98, s[12:15], s3 offset:0x800
    s_buffer_load_dword s98, s[12:15], s3 offset:0x840
    s_waitcnt vmcnt(12)
    s_barrier
    s_mov_b32 s31, 3
gated_mix__softmax_full_mha__mixer_s_mlp__prompt_kernel_hl42:
    s_add_u32 m0, s34, s37
    s_nop 0
    buffer_load_dwordx4 v32, s[8:11], s35 offen offset:0 sc1 lds
    buffer_load_dwordx4 v32, s[8:11], s35 offen offset:1024 sc1 lds
    buffer_load_dwordx4 v32, s[8:11], s35 offen offset:2048 sc1 lds
    buffer_load_dwordx4 v35, s[8:11], s35 offen offset:3072 sc1 lds
    s_add_u32 m0, m0, 4096
    s_nop 0
    buffer_load_dwordx4 v36, s[8:11], s35 offen offset:0 sc1 lds
    buffer_load_dwordx4 v36, s[8:11], s35 offen offset:1024 sc1 lds
    s_add_u32 m0, s34, s38
    s_nop 0
    buffer_load_dwordx4 v38, s[12:15], s36 offen offset:0  lds
    buffer_load_dwordx4 v39, s[12:15], s36 offen offset:1024  lds
    buffer_load_dwordx4 v40, s[12:15], s36 offen offset:2048  lds
    buffer_load_dwordx4 v41, s[12:15], s36 offen offset:3072  lds
    s_add_u32 m0, m0, 4096
    s_nop 0
    buffer_load_dwordx4 v42, s[12:15], s36 offen offset:0  lds
    buffer_load_dwordx4 v43, s[12:15], s36 offen offset:1024  lds
    s_add_u32 s35, s35, 3072
    s_add_u32 s36, s36, 196608
    s_add_u32 s34, s34, 49152
    s_cmp_eq_u32 s34, 147456
    s_cselect_b32 s34, 0, s34
    s_add_u32 s3, s99, s36
    s_sub_u32 s4, s14, 4096
    s_min_u32 s3, s3, s4
    s_buffer_load_dword s98, s[12:15], s3 offset:0x0
    s_buffer_load_dword s98, s[12:15], s3 offset:0x40
    s_buffer_load_dword s98, s[12:15], s3 offset:0x800
    s_buffer_load_dword s98, s[12:15], s3 offset:0x840
    s_waitcnt vmcnt(12)
    s_barrier
    s_sub_u32 s31, s31, 1
    s_cmp_lg_u32 s31, 0
    s_cbranch_scc1 gated_mix__softmax_full_mha__mixer_s_mlp__prompt_kernel_hl42
    s_add_u32 m0, s34, s37
    s_nop 0
    buffer_load_dwordx4 v32, s[8:11], s35 offen offset:0 sc1 lds
    buffer_load_dwordx4 v32, s[8:11], s35 offen offset:1024 sc1 lds
    buffer_load_dwordx4 v32, s[8:11], s35 offen offset:2048 sc1 lds
    buffer_load_dwordx4 v35, s[8:11], s35 offen offset:3072 sc1 lds
    s_add_u32 m0, m0, 4096
    s_nop 0
    buffer_load_dwordx4 v36, s[8:11], s35 offen offset:0 sc1 lds
    buffer_load_dwordx4 v36, s[8:11], s35 offen offset:1024 sc1 lds
    s_add_u32 m0, s34, s38
    s_nop 0
    buffer_load_dwordx4 v38, s[12:15], s36 offen offset:0  lds
    buffer_load_dwordx4 v39, s[12:15], s36 offen offset:1024  lds
    buffer_load_dwordx4 v40, s[12:15], s36 offen offset:2048  lds
    buffer_load_dwordx4 v41, s[12:15], s36 offen offset:3072  lds
    s_add_u32 m0, m0, 4096
    s_nop 0
    buffer_load_dwordx4 v42, s[12:15], s36 offen offset:0  lds
    buffer_load_dwordx4 v43, s[12:15], s36 offen offset:1024  lds
    s_add_u32 s35, s35, 3072
    s_add_u32 s36, s36, 196608
    s_add_u32 s34, s34, 49152
    s_cmp_eq_u32 s34, 147456
    s_cselect_b32 s34, 0, s34
    v_and_b32 v136, 31, v0
    s_lshr_b32 s3, s54, 1
    s_lshl_b32 s3, s3, 5
    v_add_u32 v136, s3, v136
    v_lshlrev_b32 v136, 7, v136
    s_mov_b32 s40, 45744128
    s_xor_b32 s3, s30, 8
    s_lshl_b32 s4, s29, 4
    s_add_u32 s3, s3, s4
    s_lshl_b32 s3, s3, 7
    v_add_u32 v136, 32768, v136
    v_mov_b32 v138, s3
    v_cmp_gt_u32 vcc, 32, v0
    s_nop 1
    v_cndmask_b32 v136, v138, v136, vcc
    s_mov_b32 s40, 45711360
    s_cmp_eq_u32 s25, 0
    s_cselect_b32 s40, s40, 62914560
    buffer_load_dwordx4 v[140:143], v136, s[16:19], s40 offen sc1
    s_add_u32 s3, s99, s36
    s_sub_u32 s4, s14, 4096
    s_min_u32 s3, s3, s4
    s_buffer_load_dword s98, s[12:15], s3 offset:0x0
    s_buffer_load_dword s98, s[12:15], s3 offset:0x40
    s_buffer_load_dword s98, s[12:15], s3 offset:0x800
    s_buffer_load_dword s98, s[12:15], s3 offset:0x840
    s_waitcnt vmcnt(13)
    s_barrier
    s_add_u32 m0, s34, s37
    s_nop 0
    buffer_load_dwordx4 v32, s[8:11], s35 offen offset:0 sc1 lds
    buffer_load_dwordx4 v32, s[8:11], s35 offen offset:1024 sc1 lds
    buffer_load_dwordx4 v32, s[8:11], s35 offen offset:2048 sc1 lds
    buffer_load_dwordx4 v35, s[8:11], s35 offen offset:3072 sc1 lds
    s_add_u32 m0, m0, 4096
    s_nop 0
    buffer_load_dwordx4 v36, s[8:11], s35 offen offset:0 sc1 lds
    buffer_load_dwordx4 v36, s[8:11], s35 offen offset:1024 sc1 lds
    s_add_u32 m0, s34, s38
    s_nop 0
    buffer_load_dwordx4 v38, s[12:15], s36 offen offset:0  lds
    buffer_load_dwordx4 v39, s[12:15], s36 offen offset:1024  lds
    buffer_load_dwordx4 v40, s[12:15], s36 offen offset:2048  lds
    buffer_load_dwordx4 v41, s[12:15], s36 offen offset:3072  lds
    s_add_u32 m0, m0, 4096
    s_nop 0
    buffer_load_dwordx4 v42, s[12:15], s36 offen offset:0  lds
    buffer_load_dwordx4 v43, s[12:15], s36 offen offset:1024  lds
    s_add_u32 s35, s35, 3072
    s_add_u32 s36, s36, 196608
    s_add_u32 s34, s34, 49152
    s_cmp_eq_u32 s34, 147456
    s_cselect_b32 s34, 0, s34
    s_add_u32 s3, s99, s36
    s_sub_u32 s4, s14, 4096
    s_min_u32 s3, s3, s4
    s_buffer_load_dword s98, s[12:15], s3 offset:0x0
    s_buffer_load_dword s98, s[12:15], s3 offset:0x40
    s_buffer_load_dword s98, s[12:15], s3 offset:0x800
    s_buffer_load_dword s98, s[12:15], s3 offset:0x840
    s_waitcnt vmcnt(12)
    s_cmp_eq_u32 s25, 0
    s_cbranch_scc0 gated_mix__softmax_full_mha__mixer_s_mlp__prompt_kernel_c143
    s_mov_b32 s5, 100000
gated_mix__softmax_full_mha__mixer_s_mlp__prompt_kernel_poll44:
    v_min3_u32 v137, v140, v141, v142
    v_min_u32 v137, v137, v143
    v_cmp_eq_u32 vcc, 0, v137
    s_nop 4
    s_cbranch_vccz gated_mix__softmax_full_mha__mixer_s_mlp__prompt_kernel_pollx45
    s_sub_u32 s5, s5, 1
    s_cmp_eq_u32 s5, 0
    s_cbranch_scc1 gated_mix__softmax_full_mha__mixer_s_mlp__prompt_kernel_pollx45
    s_sleep 4
    s_mov_b64 exec, vcc
    buffer_load_dwordx4 v[140:143], v136, s[16:19], s40 offen sc1
    s_mov_b64 exec, -1
    s_waitcnt vmcnt(0)
    s_branch gated_mix__softmax_full_mha__mixer_s_mlp__prompt_kernel_poll44
gated_mix__softmax_full_mha__mixer_s_mlp__prompt_kernel_pollx45:
gated_mix__softmax_full_mha__mixer_s_mlp__prompt_kernel_c143:
    s_barrier
    s_mov_b32 s12, s68
    s_mov_b32 s13, s69
    s_mov_b32 s14, 2097152
    s_mov_b32 s15, 0x20000
    s_and_b32 s3, s55, 1
    s_mul_i32 s35, s3, 15360
    s_add_u32 s35, s35, 114688
    s_mul_i32 s36, s3, 983040
    s_add_u32 m0, s34, s37
    s_nop 0
    buffer_load_dwordx4 v32, s[8:11], s35 offen offset:0 sc1 lds
    buffer_load_dwordx4 v32, s[8:11], s35 offen offset:1024 sc1 lds
    buffer_load_dwordx4 v32, s[8:11], s35 offen offset:2048 sc1 lds
    buffer_load_dwordx4 v35, s[8:11], s35 offen offset:3072 sc1 lds
    s_add_u32 m0, m0, 4096
    s_nop 0
    buffer_load_dwordx4 v36, s[8:11], s35 offen offset:0 sc1 lds
    buffer_load_dwordx4 v36, s[8:11], s35 offen offset:1024 sc1 lds
    s_add_u32 m0, s34, s38
    s_nop 0
    buffer_load_dwordx4 v38, s[12:15], s36 offen offset:0  lds
    buffer_load_dwordx4 v39, s[12:15], s36 offen offset:1024  lds
    buffer_load_dwordx4 v40, s[12:15], s36 offen offset:2048  lds
    buffer_load_dwordx4 v41, s[12:15], s36 offen offset:3072  lds
    s_add_u32 m0, m0, 4096
    s_nop 0
    buffer_load_dwordx4 v42, s[12:15], s36 offen offset:0  lds
    buffer_load_dwordx4 v43, s[12:15], s36 offen offset:1024  lds
    s_add_u32 s35, s35, 3072
    s_add_u32 s36, s36, 196608
    s_add_u32 s34, s34, 49152
    s_cmp_eq_u32 s34, 147456
    s_cselect_b32 s34, 0, s34
    s_add_u32 s3, s99, s36
    s_sub_u32 s4, s14, 4096
    s_min_u32 s3, s3, s4
    s_buffer_load_dword s98, s[12:15], s3 offset:0x0
    s_buffer_load_dword s98, s[12:15], s3 offset:0x40
    s_buffer_load_dword s98, s[12:15], s3 offset:0x800
    s_buffer_load_dword s98, s[12:15], s3 offset:0x840
    s_waitcnt vmcnt(12)
    s_barrier
    s_add_u32 m0, s34, s37
    s_nop 0
    buffer_load_dwordx4 v32, s[8:11], s35 offen offset:0 sc1 lds
    buffer_load_dwordx4 v32, s[8:11], s35 offen offset:1024 sc1 lds
    buffer_load_dwordx4 v32, s[8:11], s35 offen offset:2048 sc1 lds
    buffer_load_dwordx4 v35, s[8:11], s35 offen offset:3072 sc1 lds
    s_add_u32 m0, m0, 4096
    s_nop 0
    buffer_load_dwordx4 v36, s[8:11], s35 offen offset:0 sc1 lds
    buffer_load_dwordx4 v36, s[8:11], s35 offen offset:1024 sc1 lds
    s_add_u32 m0, s34, s38
    s_nop 0
    buffer_load_dwordx4 v38, s[12:15], s36 offen offset:0  lds
    buffer_load_dwordx4 v39, s[12:15], s36 offen offset:1024  lds
    buffer_load_dwordx4 v40, s[12:15], s36 offen offset:2048  lds
    buffer_load_dwordx4 v41, s[12:15], s36 offen offset:3072  lds
    s_add_u32 m0, m0, 4096
    s_nop 0
    buffer_load_dwordx4 v42, s[12:15], s36 offen offset:0  lds
    buffer_load_dwordx4 v43, s[12:15], s36 offen offset:1024  lds
    s_add_u32 s35, s35, 3072
    s_add_u32 s36, s36, 196608
    s_add_u32 s34, s34, 49152
    s_cmp_eq_u32 s34, 147456
    s_cselect_b32 s34, 0, s34
    s_add_u32 s3, s99, s36
    s_sub_u32 s4, s14, 4096
    s_min_u32 s3, s3, s4
    s_buffer_load_dword s98, s[12:15], s3 offset:0x0
    s_buffer_load_dword s98, s[12:15], s3 offset:0x40
    s_buffer_load_dword s98, s[12:15], s3 offset:0x800
    s_buffer_load_dword s98, s[12:15], s3 offset:0x840
    s_waitcnt vmcnt(12)
    s_barrier
    s_add_u32 m0, s34, s37
    s_nop 0
    buffer_load_dwordx4 v32, s[8:11], s35 offen offset:0 sc1 lds
    buffer_load_dwordx4 v32, s[8:11], s35 offen offset:1024 sc1 lds
    buffer_load_dwordx4 v32, s[8:11], s35 offen offset:2048 sc1 lds
    buffer_load_dwordx4 v35, s[8:11], s35 offen offset:3072 sc1 lds
    s_add_u32 m0, m0, 4096
    s_nop 0
    buffer_load_dwordx4 v36, s[8:11], s35 offen offset:0 sc1 lds
    buffer_load_dwordx4 v36, s[8:11], s35 offen offset:1024 sc1 lds
    s_add_u32 m0, s34, s38
    s_nop 0
    buffer_load_dwordx4 v38, s[12:15], s36 offen offset:0  lds
    buffer_load_dwordx4 v39, s[12:15], s36 offen offset:1024  lds
    buffer_load_dwordx4 v40, s[12:15], s36 offen offset:2048  lds
    buffer_load_dwordx4 v41, s[12:15], s36 offen offset:3072  lds
    s_add_u32 m0, m0, 4096
    s_nop 0
    buffer_load_dwordx4 v42, s[12:15], s36 offen offset:0  lds
    buffer_load_dwordx4 v43, s[12:15], s36 offen offset:1024  lds
    s_add_u32 s35, s35, 3072
    s_add_u32 s36, s36, 196608
    s_add_u32 s34, s34, 49152
    s_cmp_eq_u32 s34, 147456
    s_cselect_b32 s34, 0, s34
    s_getpc_b64 s[4:5]
gated_mix__softmax_full_mha__mixer_s_mlp__prompt_kernel_pc46:
    s_sub_u32 s4, s4, gated_mix__softmax_full_mha__mixer_s_mlp__prompt_kernel_pc46-gated_mix__softmax_full_mha__mixer_s_mlp__prompt_kernel
    s_subb_u32 s5, s5, 0
    s_lshl_b32 s3, s28, 11
    s_and_b32 s6, s24, 3
    s_lshl_b32 s6, s6, 9
    s_add_u32 s3, s3, s6
    v_lshl_add_u32 v136, v0, 3, s3
    s_mov_b32 s3, gated_mix__softmax_full_mha__mixer_s_mlp__prompt_kernel_end-gated_mix__softmax_full_mha__mixer_s_mlp__prompt_kernel
    v_min_u32 v136, s3, v136
    v_mov_b32 v137, s5
    v_add_co_u32 v136, vcc, s4, v136
    s_nop 1
    v_addc_co_u32 v137, vcc, 0, v137, vcc
    global_load_dword v138, v[136:137], off
    s_add_u32 s3, s99, s36
    s_sub_u32 s4, s14, 4096
    s_min_u32 s3, s3, s4
    s_buffer_load_dword s98, s[12:15], s3 offset:0x0
    s_buffer_load_dword s98, s[12:15], s3 offset:0x40
    s_buffer_load_dword s98, s[12:15], s3 offset:0x800
    s_buffer_load_dword s98, s[12:15], s3 offset:0x840
    s_waitcnt vmcnt(13)
    s_barrier
    s_mov_b32 s31, 2
gated_mix__softmax_full_mha__mixer_s_mlp__prompt_kernel_hl47:
    s_add_u32 m0, s34, s37
    s_nop 0
    buffer_load_dwordx4 v32, s[8:11], s35 offen offset:0 sc1 lds
    buffer_load_dwordx4 v32, s[8:11], s35 offen offset:1024 sc1 lds
    buffer_load_dwordx4 v32, s[8:11], s35 offen offset:2048 sc1 lds
    buffer_load_dwordx4 v35, s[8:11], s35 offen offset:3072 sc1 lds
    s_add_u32 m0, m0, 4096
    s_nop 0
    buffer_load_dwordx4 v36, s[8:11], s35 offen offset:0 sc1 lds
    buffer_load_dwordx4 v36, s[8:11], s35 offen offset:1024 sc1 lds
    s_add_u32 m0, s34, s38
    s_nop 0
    buffer_load_dwordx4 v38, s[12:15], s36 offen offset:0  lds
    buffer_load_dwordx4 v39, s[12:15], s36 offen offset:1024  lds
    buffer_load_dwordx4 v40, s[12:15], s36 offen offset:2048  lds
    buffer_load_dwordx4 v41, s[12:15], s36 offen offset:3072  lds
    s_add_u32 m0, m0, 4096
    s_nop 0
    buffer_load_dwordx4 v42, s[12:15], s36 offen offset:0  lds
    buffer_load_dwordx4 v43, s[12:15], s36 offen offset:1024  lds
    s_add_u32 s35, s35, 3072
    s_add_u32 s36, s36, 196608
    s_add_u32 s34, s34, 49152
    s_cmp_eq_u32 s34, 147456
    s_cselect_b32 s34, 0, s34
    s_add_u32 s3, s99, s36
    s_sub_u32 s4, s14, 4096
    s_min_u32 s3, s3, s4
    s_buffer_load_dword s98, s[12:15], s3 offset:0x0
    s_buffer_load_dword s98, s[12:15], s3 offset:0x40
    s_buffer_load_dword s98, s[12:15], s3 offset:0x800
    s_buffer_load_dword s98, s[12:15], s3 offset:0x840
    s_waitcnt vmcnt(12)
    s_barrier
    s_sub_u32 s31, s31, 1
    s_cmp_lg_u32 s31, 0
    s_cbranch_scc1 gated_mix__softmax_full_mha__mixer_s_mlp__prompt_kernel_hl47
    s_lshl_b32 s37, s25, 13
    s_lshl_b32 s38, s25, 12
    s_add_u32 s38, s38, 32768
    s_mov_b32 s36, 7077888
    s_add_u32 s8, s86, 20971520
    s_addc_u32 s9, s87, 0
    s_mov_b32 s10, 18874368
    s_mov_b32 s11, 0x20000
    s_lshl_b32 s3, s54, 3
    s_lshl_b32 s4, s25, 1
    s_add_u32 s3, s3, s4
    s_mul_i32 s3, s3, 147456
    v_add_u32 v32, s3, v1
    v_add_u32 v36, 147456, v32
    s_mov_b32 s35, 110592
    s_mov_b32 s12, s78
    s_mov_b32 s13, s79
    s_mov_b32 s14, 7340032
    s_mov_b32 s15, 0x20000
    v_lshrrev_b32 v128, 3, v0
    v_and_b32 v129, 7, v0
    v_and_b32 v130, 6, v128
    v_xor_b32 v129, v129, v130
    s_lshl_b32 s3, s25, 5
    v_add_u32 v128, s3, v128
    v_lshlrev_b32 v128, 11, v128
    v_lshl_add_u32 v128, v129, 4, v128
    s_lshl_b32 s4, s55, 7
    v_add_u32 v40, s4, v128
    v_add_u32 v41, 15360, v40
    v_add_u32 v42, 30720, v40
    v_add_u32 v43, 46080, v40
    s_add_u32 m0, s34, s37
    s_nop 0
    buffer_load_dwordx4 v32, s[8:11], s35 offen offset:0 sc1 lds
    buffer_load_dwordx4 v32, s[8:11], s35 offen offset:1024 sc1 lds
    buffer_load_dwordx4 v32, s[8:11], s35 offen offset:2048 sc1 lds
    buffer_load_dwordx4 v32, s[8:11], s35 offen offset:3072 sc1 lds
    s_add_u32 m0, m0, 4096
    s_nop 0
    buffer_load_dwordx4 v36, s[8:11], s35 offen offset:0 sc1 lds
    buffer_load_dwordx4 v36, s[8:11], s35 offen offset:1024 sc1 lds
    buffer_load_dwordx4 v36, s[8:11], s35 offen offset:2048 sc1 lds
    buffer_load_dwordx4 v36, s[8:11], s35 offen offset:3072 sc1 lds
    s_add_u32 m0, s34, s38
    s_nop 0
    buffer_load_dwordx4 v40, s[12:15], s36 offen offset:0  lds
    buffer_load_dwordx4 v41, s[12:15], s36 offen offset:1024  lds
    buffer_load_dwordx4 v42, s[12:15], s36 offen offset:2048  lds
    buffer_load_dwordx4 v43, s[12:15], s36 offen offset:3072  lds
    s_add_u32 s35, s35, 4096
    s_add_u32 s36, s36, 262144
    s_add_u32 s34, s34, 49152
    s_cmp_eq_u32 s34, 147456
    s_cselect_b32 s34, 0, s34
    s_mov_b32 s12, s68
    s_mov_b32 s13, s69
    s_mov_b32 s14, 2097152
    s_mov_b32 s15, 0x20000
    s_mov_b32 s35, 145408
    s_mov_b32 s36, 1966080
    s_mov_b32 s35, 143360
    s_mov_b32 s3, 1835008
    s_cmp_lt_u32 s25, 2
    s_cselect_b32 s36, 0x40000000, s3
    s_waitcnt vmcnt(12)
    s_barrier
    s_add_u32 m0, s34, s37
    s_nop 0
    buffer_load_dwordx4 v32, s[8:11], s35 offen offset:2048 sc1 lds
    buffer_load_dwordx4 v32, s[8:11], s35 offen offset:3072 sc1 lds
    s_add_u32 m0, m0, 4096
    s_nop 0
    buffer_load_dwordx4 v36, s[8:11], s35 offen offset:2048 sc1 lds
    buffer_load_dwordx4 v36, s[8:11], s35 offen offset:3072 sc1 lds
    s_add_u32 m0, s34, s38
    s_nop 0
    buffer_load_dwordx4 v40, s[12:15], s36 offen offset:0  lds
    buffer_load_dwordx4 v41, s[12:15], s36 offen offset:1024  lds
    buffer_load_dwordx4 v42, s[12:15], s36 offen offset:2048  lds
    buffer_load_dwordx4 v43, s[12:15], s36 offen offset:3072  lds
    s_add_u32 s35, s35, 4096
    s_add_u32 s36, s36, 262144
    s_add_u32 s34, s34, 49152
    s_cmp_eq_u32 s34, 147456
    s_cselect_b32 s34, 0, s34
    s_waitcnt vmcnt(8)
    s_barrier
    s_lshl_b32 s3, s54, 4
    s_xor_b32 s4, s55, 1
    s_add_u32 s3, s3, s4
    s_lshl_b32 s3, s3, 2
    s_add_u32 s3, s3, s25
    s_lshl_b32 s3, s3, 13
    s_add_u32 s49, s3, 50331648
    s_lshl_b32 s3, s55, 1
    s_lshr_b32 s4, s25, 1
    s_add_u32 s3, s3, s4
    s_lshl_b32 s3, s3, 10
    s_lshl_b32 s4, s54, 1
    s_and_b32 s5, s25, 1
    s_add_u32 s4, s4, s5
    s_lshl_b32 s4, s4, 17
    s_add_u32 s3, s3, s4
    s_add_u32 s50, s3, 16777216
    s_mul_i32 s4, s25, 12288
    s_add_u32 m0, s4, s34
    s_nop 0
    buffer_load_dwordx4 v1, s[16:19], s50 offen sc1 lds
    s_add_u32 s50, s50, 32768
    s_add_u32 m0, m0, 1024
    s_nop 0
    buffer_load_dwordx4 v1, s[16:19], s50 offen sc1 lds
    s_add_u32 s50, s50, 32768
    s_add_u32 m0, m0, 1024
    s_nop 0
    buffer_load_dwordx4 v1, s[16:19], s50 offen sc1 lds
    s_add_u32 s50, s50, 32768
    s_add_u32 m0, m0, 1024
    s_nop 0
    buffer_load_dwordx4 v1, s[16:19], s50 offen sc1 lds
    s_add_u32 s50, s50, 32768
    s_add_u32 m0, m0, 1024
    s_waitcnt vmcnt(4)
    s_barrier
    s_waitcnt vmcnt(0)
    s_barrier
    s_endpgm
gated_mix__softmax_full_mha__mixer_s_mlp__prompt_kernel_G:
    v_mov_b32 v2, 153344
    v_mov_b32 v3, 0
    ds_write_b32 v2, v3
    ds_write_b32 v2, v3 offset:4
    ds_write_b32 v2, v3 offset:8
    ds_write_b32 v2, v3 offset:12
    ds_write_b32 v2, v3 offset:16
    ds_write_b32 v2, v3 offset:20
    s_waitcnt lgkmcnt(0)
    s_mov_b32 s16, s86
    s_mov_b32 s17, s87
    s_mov_b32 s18, 62914560
    s_mov_b32 s19, 0x20000
    s_cmp_lt_u32 s2, 8
    s_cbranch_scc0 gated_mix__softmax_full_mha__mixer_s_mlp__prompt_kernel_zf48
    s_lshl_b32 s4, s2, 2
    s_add_u32 s4, s4, s24
    s_lshl_b32 s3, s4, 13
    s_add_u32 s3, s3, 45613056
    v_lshlrev_b32 v136, 7, v0
    v_mov_b32 v137, 0
    v_mov_b32 v140, 0
    v_mov_b32 v141, 0
    v_mov_b32 v142, 0
    v_mov_b32 v143, 0
    buffer_store_dwordx4 v[140:143], v136, s[16:19], s3 offen sc1
    s_lshl_b32 s4, s4, 2
    s_waitcnt vmcnt(1)
    v_mov_b32 v138, 1
    s_mov_b32 s20, s84
    s_mov_b32 s21, s85
    s_mov_b32 s22, 256
    s_mov_b32 s23, 0x20000
    s_waitcnt vmcnt(0)
    s_mov_b64 exec, 1
    buffer_store_dword v138, v137, s[20:23], s4 offen sc1
    s_mov_b64 exec, -1
gated_mix__softmax_full_mha__mixer_s_mlp__prompt_kernel_zf48:
    s_mov_b32 s8, s64
    s_mov_b32 s9, s65
    s_mov_b32 s10, 4194304
    s_mov_b32 s11, 0x20000
    s_mov_b32 s12, s80
    s_mov_b32 s13, s81
    s_mov_b32 s14, 2048
    s_mov_b32 s15, 0x20000
    s_lshl_b32 s48, s29, 4
    s_add_u32 s48, s48, s30
    s_lshl_b32 s48, s48, 3
    s_lshl_b32 s3, s24, 1
    s_add_u32 s48, s48, s3
    s_lshl_b32 s3, s48, 11
    buffer_load_dwordx4 v[64:67], v1, s[8:11], s3 offen
    buffer_load_dwordx4 v[68:71], v1, s[8:11], s3 offen offset:1024
    buffer_load_dwordx4 v[72:75], v1, s[8:11], s3 offen offset:2048
    buffer_load_dwordx4 v[76:79], v1, s[8:11], s3 offen offset:3072
    buffer_load_dwordx4 v[80:83], v1, s[12:15], 0 offen
    buffer_load_dwordx4 v[84:87], v1, s[12:15], 0 offen offset:1024
    s_mov_b32 s12, s72
    s_mov_b32 s13, s73
    s_mov_b32 s14, 2097152
    s_mov_b32 s15, 0x20000
    v_lshrrev_b32 v128, 3, v0
    v_and_b32 v129, 7, v0
    v_lshlrev_b32 v128, 11, v128
    v_lshl_add_u32 v128, v129, 4, v128
    s_lshl_b32 s3, s29, 2
    s_add_u32 s3, s3, s24
    s_lshl_b32 s3, s3, 15
    s_lshl_b32 s4, s30, 7
    s_add_u32 s3, s3, s4
    s_add_u32 s4, s3, 16384
    buffer_load_dwordx4 v[88:91], v128, s[12:15], s3 offen
    buffer_load_dwordx4 v[92:95], v128, s[12:15], s4 offen
    s_lshl_b32 s3, s2, 2
    s_and_b32 s4, s24, 3
    s_add_u32 s3, s3, s4
    s_mov_b32 m0, 158720
    s_mov_b32 s20, s66
    s_mov_b32 s21, s67
    s_mov_b32 s22, 6291456
    s_mov_b32 s23, 0x20000
    s_mul_i32 s5, s3, 1024
    buffer_load_dwordx4 v1, s[20:23], s5 offen  lds
    s_lshl_b32 s3, s2, 2
    s_and_b32 s4, s24, 3
    s_add_u32 s3, s3, s4
    s_mul_i32 s3, s3, 512
    s_add_u32 s3, s3, 1048576
    s_add_u32 s6, s66, s3
    s_addc_u32 s7, s67, 0
    s_load_dword s98, s[6:7], 0
    s_load_dword s98, s[6:7], 64
    s_load_dword s98, s[6:7], 128
    s_load_dword s98, s[6:7], 192
    s_load_dword s98, s[6:7], 256
    s_load_dword s98, s[6:7], 320
    s_load_dword s98, s[6:7], 384
    s_load_dword s98, s[6:7], 448
    s_and_b32 s25, s24, 1
    s_lshr_b32 s26, s24, 1
    s_lshl_b32 s3, s51, 3
    s_add_u32 s3, s3, s41
    s_lshl_b32 s3, s3, 7
    s_add_u32 s88, s3, 45613056
    s_lshl_b32 s3, s41, 5
    s_add_u32 s3, s3, s51
    s_lshl_b32 s3, s3, 7
    s_add_u32 s89, s3, 45645824
    s_lshl_b32 s3, s54, 4
    s_add_u32 s3, s3, s55
    s_lshl_b32 s3, s3, 7
    s_add_u32 s90, s3, 45678592
    s_lshl_b32 s3, s29, 4
    s_add_u32 s3, s3, s30
    s_lshl_b32 s3, s3, 7
    s_add_u32 s91, s3, 45711360
    s_lshl_b32 s3, s41, 5
    s_add_u32 s3, s3, s51
    s_lshl_b32 s3, s3, 7
    s_add_u32 s92, s3, 45744128
    s_lshl_b32 s3, s54, 4
    s_add_u32 s3, s3, s55
    s_lshl_b32 s3, s3, 7
    s_add_u32 s93, s3, 45776896
    s_lshl_b32 s3, s29, 4
    s_add_u32 s3, s3, s30
    s_lshl_b32 s3, s3, 7
    s_add_u32 s94, s3, 45809664
    s_lshl_b32 s3, s30, 4
    s_add_u32 s3, s3, s29
    s_lshl_b32 s3, s3, 7
    s_add_u32 s95, s3, 45842432
    v_and_b32 v16, 15, v0
    v_lshrrev_b32 v17, 4, v0
    v_bfe_u32 v18, v0, 2, 2
    v_and_b32 v19, 3, v0
    v_lshrrev_b32 v20, 1, v16
    v_xor_b32 v20, v20, v17
    v_lshlrev_b32 v20, 4, v20
    v_lshl_or_b32 v20, v16, 7, v20
    s_lshl_b32 s3, s24, 13
    v_add_u32 v8, s3, v20
    v_xor_b32 v9, 64, v8
    v_and_b32 v21, 1, v17
    v_lshlrev_b32 v21, 5, v21
    v_lshl_add_u32 v21, v19, 3, v21
    v_lshl_add_u32 v20, v17, 3, v18
    v_mul_u32_u24 v22, 192, v20
    v_add_u32 v22, v22, v21
    v_add_u32 v10, 32768, v22
    v_xor_b32 v11, 32, v10
    v_lshl_add_u32 v22, v20, 6, v21
    v_add_u32 v12, 45056, v22
    v_xor_b32 v13, 32, v12
    v_mov_b32 v128, 0
    v_mov_b32 v129, 0
    v_mov_b32 v130, 0
    v_mov_b32 v131, 0
    v_mov_b32 v132, 0
    v_mov_b32 v133, 0
    v_mov_b32 v134, 0
    v_mov_b32 v135, 0
    v_mov_b32 v136, 0
    v_mov_b32 v137, 0
    s_waitcnt vmcnt(9)
    v_mov_b32 v138, 0
    v_mov_b32 v139, 0
    v_mov_b32 v140, 0
    v_mov_b32 v141, 0
    v_mov_b32 v142, 0
    v_mov_b32 v143, 0
    v_mov_b32 v144, 0
    v_mov_b32 v145, 0
    v_mov_b32 v146, 0
    v_mov_b32 v147, 0
    v_mov_b32 v148, 0
    v_mov_b32 v149, 0
    v_mov_b32 v150, 0
    v_mov_b32 v151, 0
    v_mov_b32 v152, 0
    v_mov_b32 v153, 0
    v_mov_b32 v154, 0
    v_mov_b32 v155, 0
    v_mov_b32 v156, 0
    v_mov_b32 v157, 0
    v_mov_b32 v158, 0
    v_mov_b32 v159, 0
    v_mov_b32 v160, 0
    v_mov_b32 v161, 0
    v_mov_b32 v162, 0
    v_mov_b32 v163, 0
    v_mov_b32 v164, 0
    v_mov_b32 v165, 0
    v_mov_b32 v166, 0
    v_mov_b32 v167, 0
    v_mov_b32 v168, 0
    v_mov_b32 v169, 0
    v_mov_b32 v170, 0
    v_mov_b32 v171, 0
    v_mov_b32 v172, 0
    v_mov_b32 v173, 0
    v_mov_b32 v174, 0
    v_mov_b32 v175, 0
    v_mov_b32 v176, 0
    v_mov_b32 v177, 0
    v_mov_b32 v178, 0
    v_mov_b32 v179, 0
    v_mov_b32 v180, 0
    v_mov_b32 v181, 0
    v_mov_b32 v182, 0
    v_mov_b32 v183, 0
    v_mov_b32 v184, 0
    v_mov_b32 v185, 0
    v_mov_b32 v186, 0
    v_mov_b32 v187, 0
    v_mov_b32 v188, 0
    v_mov_b32 v189, 0
    v_mov_b32 v190, 0
    v_mov_b32 v191, 0
    v_mov_b32 v192, 0
    v_mov_b32 v193, 0
    v_mov_b32 v194, 0
    v_mov_b32 v195, 0
    v_mov_b32 v196, 0
    v_mov_b32 v197, 0
    v_mov_b32 v198, 0
    v_mov_b32 v199, 0
    v_mov_b32 v200, 0
    v_mov_b32 v201, 0
    v_mov_b32 v202, 0
    v_mov_b32 v203, 0
    v_mov_b32 v204, 0
    v_mov_b32 v205, 0
    v_mov_b32 v206, 0
    v_mov_b32 v207, 0
    v_mov_b32 v208, 0
    v_mov_b32 v209, 0
    v_mov_b32 v210, 0
    v_mov_b32 v211, 0
    v_mov_b32 v212, 0
    v_mov_b32 v213, 0
    v_mov_b32 v214, 0
    v_mov_b32 v215, 0
    v_mov_b32 v216, 0
    v_mov_b32 v217, 0
    v_mov_b32 v218, 0
    v_mov_b32 v219, 0
    v_mov_b32 v220, 0
    v_mov_b32 v221, 0
    v_mov_b32 v222, 0
    v_mov_b32 v223, 0
    v_mov_b32 v224, 0
    v_mov_b32 v225, 0
    v_mov_b32 v226, 0
    v_mov_b32 v227, 0
    v_mov_b32 v228, 0
    v_mov_b32 v229, 0
    v_mov_b32 v230, 0
    v_mov_b32 v231, 0
    v_mov_b32 v232, 0
    v_mov_b32 v233, 0
    v_mov_b32 v234, 0
    v_mov_b32 v235, 0
    v_mov_b32 v236, 0
    v_mov_b32 v237, 0
    v_mov_b32 v238, 0
    v_mov_b32 v239, 0
    v_mov_b32 v240, 0
    v_mov_b32 v241, 0
    v_mov_b32 v242, 0
    v_mov_b32 v243, 0
    v_mov_b32 v244, 0
    v_mov_b32 v245, 0
    v_mov_b32 v246, 0
    v_mov_b32 v247, 0
    v_mov_b32 v248, 0
    v_mov_b32 v249, 0
    v_mov_b32 v250, 0
    v_mov_b32 v251, 0
    v_mov_b32 v252, 0
    v_mov_b32 v253, 0
    v_mov_b32 v254, 0
    v_mov_b32 v255, 0
    v_mov_b32 v48, 0
    v_mov_b32 v49, 0
    v_mov_b32 v50, 0
    v_mov_b32 v51, 0
    v_mov_b32 v52, 0
    v_mov_b32 v53, 0
    s_waitcnt vmcnt(4)
    v_lshlrev_b32 v58, 16, v80
    v_and_b32 v59, 0xffff0000, v80
    v_lshlrev_b32 v56, 16, v64
    v_and_b32 v57, 0xffff0000, v64
    v_add_f32 v50, v50, v56
    v_fmac_f32 v52, v56, v56
    v_add_f32 v50, v50, v57
    v_fmac_f32 v52, v57, v57
    v_mul_f32 v56, v56, v58
    v_mul_f32 v57, v57, v59
    v_cvt_pk_bf16_f32 v56, v56, v57
    v_lshlrev_b32 v57, 16, v56
    v_and_b32 v56, 0xffff0000, v56
    v_add_f32 v48, v48, v57
    v_add_f32 v48, v48, v56
    v_lshlrev_b32 v56, 16, v72
    v_and_b32 v57, 0xffff0000, v72
    v_add_f32 v51, v51, v56
    v_fmac_f32 v53, v56, v56
    v_add_f32 v51, v51, v57
    v_fmac_f32 v53, v57, v57
    v_mul_f32 v56, v56, v58
    v_mul_f32 v57, v57, v59
    v_cvt_pk_bf16_f32 v56, v56, v57
    v_lshlrev_b32 v57, 16, v56
    v_and_b32 v56, 0xffff0000, v56
    v_add_f32 v49, v49, v57
    v_add_f32 v49, v49, v56
    v_lshlrev_b32 v58, 16, v81
    v_and_b32 v59, 0xffff0000, v81
    v_lshlrev_b32 v56, 16, v65
    v_and_b32 v57, 0xffff0000, v65
    v_add_f32 v50, v50, v56
    v_fmac_f32 v52, v56, v56
    v_add_f32 v50, v50, v57
    v_fmac_f32 v52, v57, v57
    v_mul_f32 v56, v56, v58
    v_mul_f32 v57, v57, v59
    v_cvt_pk_bf16_f32 v56, v56, v57
    v_lshlrev_b32 v57, 16, v56
    v_and_b32 v56, 0xffff0000, v56
    v_add_f32 v48, v48, v57
    v_add_f32 v48, v48, v56
    v_lshlrev_b32 v56, 16, v73
    v_and_b32 v57, 0xffff0000, v73
    v_add_f32 v51, v51, v56
    v_fmac_f32 v53, v56, v56
    v_add_f32 v51, v51, v57
    v_fmac_f32 v53, v57, v57
    v_mul_f32 v56, v56, v58
    v_mul_f32 v57, v57, v59
    v_cvt_pk_bf16_f32 v56, v56, v57
    v_lshlrev_b32 v57, 16, v56
    v_and_b32 v56, 0xffff0000, v56
    v_add_f32 v49, v49, v57
    v_add_f32 v49, v49, v56
    v_lshlrev_b32 v58, 16, v82
    v_and_b32 v59, 0xffff0000, v82
    v_lshlrev_b32 v56, 16, v66
    v_and_b32 v57, 0xffff0000, v66
    v_add_f32 v50, v50, v56
    v_fmac_f32 v52, v56, v56
    v_add_f32 v50, v50, v57
    v_fmac_f32 v52, v57, v57
    v_mul_f32 v56, v56, v58
    v_mul_f32 v57, v57, v59
    v_cvt_pk_bf16_f32 v56, v56, v57
    v_lshlrev_b32 v57, 16, v56
    v_and_b32 v56, 0xffff0000, v56
    v_add_f32 v48, v48, v57
    v_add_f32 v48, v48, v56
    v_lshlrev_b32 v56, 16, v74
    v_and_b32 v57, 0xffff0000, v74
    v_add_f32 v51, v51, v56
    v_fmac_f32 v53, v56, v56
    v_add_f32 v51, v51, v57
    v_fmac_f32 v53, v57, v57
    v_mul_f32 v56, v56, v58
    v_mul_f32 v57, v57, v59
    v_cvt_pk_bf16_f32 v56, v56, v57
    v_lshlrev_b32 v57, 16, v56
    v_and_b32 v56, 0xffff0000, v56
    v_add_f32 v49, v49, v57
    v_add_f32 v49, v49, v56
    v_lshlrev_b32 v58, 16, v83
    v_and_b32 v59, 0xffff0000, v83
    v_lshlrev_b32 v56, 16, v67
    v_and_b32 v57, 0xffff0000, v67
    v_add_f32 v50, v50, v56
    v_fmac_f32 v52, v56, v56
    v_add_f32 v50, v50, v57
    v_fmac_f32 v52, v57, v57
    v_mul_f32 v56, v56, v58
    v_mul_f32 v57, v57, v59
    v_cvt_pk_bf16_f32 v56, v56, v57
    v_lshlrev_b32 v57, 16, v56
    v_and_b32 v56, 0xffff0000, v56
    v_add_f32 v48, v48, v57
    v_add_f32 v48, v48, v56
    v_lshlrev_b32 v56, 16, v75
    v_and_b32 v57, 0xffff0000, v75
    v_add_f32 v51, v51, v56
    v_fmac_f32 v53, v56, v56
    v_add_f32 v51, v51, v57
    v_fmac_f32 v53, v57, v57
    v_mul_f32 v56, v56, v58
    v_mul_f32 v57, v57, v59
    v_cvt_pk_bf16_f32 v56, v56, v57
    v_lshlrev_b32 v57, 16, v56
    v_and_b32 v56, 0xffff0000, v56
    v_add_f32 v49, v49, v57
    v_add_f32 v49, v49, v56
    s_waitcnt vmcnt(3)
    v_lshlrev_b32 v58, 16, v84
    v_and_b32 v59, 0xffff0000, v84
    v_lshlrev_b32 v56, 16, v68
    v_and_b32 v57, 0xffff0000, v68
    v_add_f32 v50, v50, v56
    v_fmac_f32 v52, v56, v56
    v_add_f32 v50, v50, v57
    v_fmac_f32 v52, v57, v57
    v_mul_f32 v56, v56, v58
    v_mul_f32 v57, v57, v59
    v_cvt_pk_bf16_f32 v56, v56, v57
    v_lshlrev_b32 v57, 16, v56
    v_and_b32 v56, 0xffff0000, v56
    v_add_f32 v48, v48, v57
    v_add_f32 v48, v48, v56
    v_lshlrev_b32 v56, 16, v76
    v_and_b32 v57, 0xffff0000, v76
    v_add_f32 v51, v51, v56
    v_fmac_f32 v53, v56, v56
    v_add_f32 v51, v51, v57
    v_fmac_f32 v53, v57, v57
    v_mul_f32 v56, v56, v58
    v_mul_f32 v57, v57, v59
    v_cvt_pk_bf16_f32 v56, v56, v57
    v_lshlrev_b32 v57, 16, v56
    v_and_b32 v56, 0xffff0000, v56
    v_add_f32 v49, v49, v57
    v_add_f32 v49, v49, v56
    v_lshlrev_b32 v58, 16, v85
    v_and_b32 v59, 0xffff0000, v85
    v_lshlrev_b32 v56, 16, v69
    v_and_b32 v57, 0xffff0000, v69
    v_add_f32 v50, v50, v56
    v_fmac_f32 v52, v56, v56
    v_add_f32 v50, v50, v57
    v_fmac_f32 v52, v57, v57
    v_mul_f32 v56, v56, v58
    v_mul_f32 v57, v57, v59
    v_cvt_pk_bf16_f32 v56, v56, v57
    v_lshlrev_b32 v57, 16, v56
    v_and_b32 v56, 0xffff0000, v56
    v_add_f32 v48, v48, v57
    v_add_f32 v48, v48, v56
    v_lshlrev_b32 v56, 16, v77
    v_and_b32 v57, 0xffff0000, v77
    v_add_f32 v51, v51, v56
    v_fmac_f32 v53, v56, v56
    v_add_f32 v51, v51, v57
    v_fmac_f32 v53, v57, v57
    v_mul_f32 v56, v56, v58
    v_mul_f32 v57, v57, v59
    v_cvt_pk_bf16_f32 v56, v56, v57
    v_lshlrev_b32 v57, 16, v56
    v_and_b32 v56, 0xffff0000, v56
    v_add_f32 v49, v49, v57
    v_add_f32 v49, v49, v56
    v_lshlrev_b32 v58, 16, v86
    v_and_b32 v59, 0xffff0000, v86
    v_lshlrev_b32 v56, 16, v70
    v_and_b32 v57, 0xffff0000, v70
    v_add_f32 v50, v50, v56
    v_fmac_f32 v52, v56, v56
    v_add_f32 v50, v50, v57
    v_fmac_f32 v52, v57, v57
    v_mul_f32 v56, v56, v58
    v_mul_f32 v57, v57, v59
    v_cvt_pk_bf16_f32 v56, v56, v57
    v_lshlrev_b32 v57, 16, v56
    v_and_b32 v56, 0xffff0000, v56
    v_add_f32 v48, v48, v57
    v_add_f32 v48, v48, v56
    v_lshlrev_b32 v56, 16, v78
    v_and_b32 v57, 0xffff0000, v78
    v_add_f32 v51, v51, v56
    v_fmac_f32 v53, v56, v56
    v_add_f32 v51, v51, v57
    v_fmac_f32 v53, v57, v57
    v_mul_f32 v56, v56, v58
    v_mul_f32 v57, v57, v59
    v_cvt_pk_bf16_f32 v56, v56, v57
    v_lshlrev_b32 v57, 16, v56
    v_and_b32 v56, 0xffff0000, v56
    v_add_f32 v49, v49, v57
    v_add_f32 v49, v49, v56
    v_lshlrev_b32 v58, 16, v87
    v_and_b32 v59, 0xffff0000, v87
    v_lshlrev_b32 v56, 16, v71
    v_and_b32 v57, 0xffff0000, v71
    v_add_f32 v50, v50, v56
    v_fmac_f32 v52, v56, v56
    v_add_f32 v50, v50, v57
    v_fmac_f32 v52, v57, v57
    v_mul_f32 v56, v56, v58
    v_mul_f32 v57, v57, v59
    v_cvt_pk_bf16_f32 v56, v56, v57
    v_lshlrev_b32 v57, 16, v56
    v_and_b32 v56, 0xffff0000, v56
    v_add_f32 v48, v48, v57
    v_add_f32 v48, v48, v56
    v_lshlrev_b32 v56, 16, v79
    v_and_b32 v57, 0xffff0000, v79
    v_add_f32 v51, v51, v56
    v_fmac_f32 v53, v56, v56
    v_add_f32 v51, v51, v57
    v_fmac_f32 v53, v57, v57
    v_mul_f32 v56, v56, v58
    v_mul_f32 v57, v57, v59
    v_cvt_pk_bf16_f32 v56, v56, v57
    v_lshlrev_b32 v57, 16, v56
    v_and_b32 v56, 0xffff0000, v56
    v_add_f32 v49, v49, v57
    v_add_f32 v49, v49, v56
    s_nop 1
    v_permlane32_swap_b32 v48, v49
    v_permlane32_swap_b32 v50, v51
    v_permlane32_swap_b32 v52, v53
    v_add_f32 v48, v48, v49
    v_add_f32 v50, v50, v51
    v_add_f32 v52, v52, v53
    v_mov_b32 v49, v48
    v_mov_b32 v51, v50
    v_mov_b32 v53, v52
    v_permlane16_swap_b32 v48, v49
    v_permlane16_swap_b32 v50, v51
    v_permlane16_swap_b32 v52, v53
    v_add_f32 v48, v48, v49
    v_add_f32 v50, v50, v51
    v_add_f32 v52, v52, v53
    v_add_f32_dpp v48, v48, v48 row_ror:8 row_mask:0xf bank_mask:0xf
    v_add_f32_dpp v50, v50, v50 row_ror:8 row_mask:0xf bank_mask:0xf
    v_add_f32_dpp v52, v52, v52 row_ror:8 row_mask:0xf bank_mask:0xf
    v_add_f32_dpp v48, v48, v48 row_ror:4 row_mask:0xf bank_mask:0xf
    v_add_f32_dpp v50, v50, v50 row_ror:4 row_mask:0xf bank_mask:0xf
    v_add_f32_dpp v52, v52, v52 row_ror:4 row_mask:0xf bank_mask:0xf
    v_add_f32_dpp v48, v48, v48 row_ror:2 row_mask:0xf bank_mask:0xf
    v_add_f32_dpp v50, v50, v50 row_ror:2 row_mask:0xf bank_mask:0xf
    v_add_f32_dpp v52, v52, v52 row_ror:2 row_mask:0xf bank_mask:0xf
    v_add_f32_dpp v48, v48, v48 row_ror:1 row_mask:0xf bank_mask:0xf
    v_add_f32_dpp v50, v50, v50 row_ror:1 row_mask:0xf bank_mask:0xf
    v_add_f32_dpp v52, v52, v52 row_ror:1 row_mask:0xf bank_mask:0xf
    v_mul_f32 v50, 0x3a800000, v50
    v_mul_f32 v52, 0x3a800000, v52
    v_fma_f32 v52, -v50, v50, v52
    v_max_f32 v52, 0, v52
    v_add_f32 v52, 0x3727c5ac, v52
    v_rsq_f32 v52, v52
    v_cvt_pk_bf16_f32 v48, v48, v48
    v_and_b32 v48, 0xffff0000, v48
    v_mul_f32 v48, 0xbfb8aa3b, v48
    v_exp_f32 v48, v48
    s_nop 0
    v_add_f32 v48, 1.0, v48
    v_rcp_f32 v48, v48
    s_nop 0
    v_cvt_pk_bf16_f32 v48, v48, v48
    v_and_b32 v48, 0xffff0000, v48
    v_sub_f32 v49, 1.0, v48
    v_cvt_pk_bf16_f32 v49, v49, v49
    v_and_b32 v49, 0xffff0000, v49
    v_lshrrev_b32 v56, 5, v0
    v_add_u32 v56, s48, v56
    v_lshlrev_b32 v56, 2, v56
    v_mov_b32 v51, v52
    v_mov_b32 v52, v48
    v_mov_b32 v53, v49
    v_lshlrev_b32 v56, 2, v56
    s_mov_b32 s5, 42991616
    s_mov_b32 exec_lo, 1
    s_mov_b32 exec_hi, 1
    buffer_store_dwordx4 v[50:53], v56, s[16:19], s5 offen sc1
    s_mov_b64 exec, -1
    s_waitcnt vmcnt(3)
    v_lshlrev_b32 v96, 16, v88
    v_and_b32 v97, 0xffff0000, v88
    s_waitcnt vmcnt(2)
    v_lshlrev_b32 v104, 16, v92
    v_and_b32 v105, 0xffff0000, v92
    v_add_f32 v96, v96, v104
    v_add_f32 v97, v97, v105
    v_lshlrev_b32 v98, 16, v89
    v_and_b32 v99, 0xffff0000, v89
    v_lshlrev_b32 v104, 16, v93
    v_and_b32 v105, 0xffff0000, v93
    v_add_f32 v98, v98, v104
    v_add_f32 v99, v99, v105
    v_lshlrev_b32 v100, 16, v90
    v_and_b32 v101, 0xffff0000, v90
    v_lshlrev_b32 v104, 16, v94
    v_and_b32 v105, 0xffff0000, v94
    v_add_f32 v100, v100, v104
    v_add_f32 v101, v101, v105
    v_lshlrev_b32 v102, 16, v91
    v_and_b32 v103, 0xffff0000, v91
    v_lshlrev_b32 v104, 16, v95
    v_and_b32 v105, 0xffff0000, v95
    v_add_f32 v102, v102, v104
    v_add_f32 v103, v103, v105
    v_permlane32_swap_b32 v96, v100
    v_permlane32_swap_b32 v97, v101
    v_permlane32_swap_b32 v98, v102
    v_permlane32_swap_b32 v99, v103
    v_add_f32 v96, v96, v100
    v_add_f32 v97, v97, v101
    v_add_f32 v98, v98, v102
    v_add_f32 v99, v99, v103
    s_nop 0
    v_permlane16_swap_b32 v96, v98
    v_permlane16_swap_b32 v97, v99
    v_add_f32 v96, v96, v98
    v_add_f32 v97, v97, v99
    s_nop 0
    v_add_f32_dpp v96, v96, v96 row_ror:8 row_mask:0xf bank_mask:0xf
    v_add_f32_dpp v97, v97, v97 row_ror:8 row_mask:0xf bank_mask:0xf
    v_and_b32 v104, 7, v0
    v_lshrrev_b32 v105, 4, v0
    v_lshlrev_b32 v104, 5, v104
    v_lshl_add_u32 v104, v105, 3, v104
    s_lshl_b32 s3, s30, 4
    s_add_u32 s3, s3, s29
    s_lshl_b32 s3, s3, 2
    s_add_u32 s3, s3, s24
    s_lshl_b32 s3, s3, 8
    s_add_u32 s3, s3, 45350912
    buffer_store_dwordx2 v[96:97], v104, s[16:19], s3 offen sc1
    s_waitcnt lgkmcnt(0)
    s_barrier
    ds_read_b128 v[32:35], v8 offset:0
    ds_read_b128 v[36:39], v9 offset:0
    ds_read_b64_tr_b16 v[96:97], v10 offset:0
    ds_read_b64_tr_b16 v[98:99], v10 offset:768
    ds_read_b64_tr_b16 v[100:101], v10 offset:6144
    ds_read_b64_tr_b16 v[102:103], v10 offset:6912
    ds_read_b128 v[40:43], v8 offset:2048
    ds_read_b128 v[44:47], v9 offset:2048
    ds_read_b128 v[48:51], v8 offset:4096
    ds_read_b128 v[52:55], v9 offset:4096
    ds_read_b128 v[56:59], v8 offset:6144
    ds_read_b128 v[60:63], v9 offset:6144
    ds_read_b64_tr_b16 v[104:105], v11 offset:0
    ds_read_b64_tr_b16 v[106:107], v11 offset:768
    ds_read_b64_tr_b16 v[108:109], v11 offset:6144
    ds_read_b64_tr_b16 v[110:111], v11 offset:6912
    s_mov_b32 s31, 16
    .p2align 5
gated_mix__softmax_full_mha__mixer_s_mlp__prompt_kernel_gl49:
    s_waitcnt lgkmcnt(8)
    v_mfma_f32_16x16x32_bf16 v[128:131], v[96:99], v[32:35], v[128:131]
    ds_read_b64_tr_b16 v[112:113], v10 offset:64
    v_mfma_f32_16x16x32_bf16 v[128:131], v[100:103], v[36:39], v[128:131]
    ds_read_b64_tr_b16 v[114:115], v10 offset:832
    v_mfma_f32_16x16x32_bf16 v[132:135], v[100:103], v[44:47], v[132:135]
    ds_read_b64_tr_b16 v[116:117], v10 offset:6208
    v_mfma_f32_16x16x32_bf16 v[132:135], v[96:99], v[40:43], v[132:135]
    ds_read_b64_tr_b16 v[118:119], v10 offset:6976
    s_waitcnt lgkmcnt(11)
    v_mfma_f32_16x16x32_bf16 v[136:139], v[96:99], v[48:51], v[136:139]
    s_add_u32 s32, s32, 49152
    s_waitcnt lgkmcnt(10)
    v_mfma_f32_16x16x32_bf16 v[136:139], v[100:103], v[52:55], v[136:139]
    s_cmp_eq_u32 s32, 147456
    s_waitcnt lgkmcnt(8)
    v_mfma_f32_16x16x32_bf16 v[140:143], v[100:103], v[60:63], v[140:143]
    s_cselect_b32 s33, s39, 49152
    v_mfma_f32_16x16x32_bf16 v[140:143], v[96:99], v[56:59], v[140:143]
    s_cselect_b32 s32, 0, s32
    s_waitcnt lgkmcnt(4)
    v_mfma_f32_16x16x32_bf16 v[156:159], v[104:107], v[56:59], v[156:159]
    ds_read_b64_tr_b16 v[120:121], v11 offset:64
    v_mfma_f32_16x16x32_bf16 v[156:159], v[108:111], v[60:63], v[156:159]
    ds_read_b64_tr_b16 v[122:123], v11 offset:832
    v_mfma_f32_16x16x32_bf16 v[152:155], v[108:111], v[52:55], v[152:155]
    ds_read_b64_tr_b16 v[124:125], v11 offset:6208
    v_mfma_f32_16x16x32_bf16 v[152:155], v[104:107], v[48:51], v[152:155]
    ds_read_b64_tr_b16 v[126:127], v11 offset:6976
    v_mfma_f32_16x16x32_bf16 v[148:151], v[104:107], v[40:43], v[148:151]
    v_add_u32 v8, s33, v8
    v_mfma_f32_16x16x32_bf16 v[148:151], v[108:111], v[44:47], v[148:151]
    v_add_u32 v9, s33, v9
    v_mfma_f32_16x16x32_bf16 v[144:147], v[108:111], v[36:39], v[144:147]
    v_mfma_f32_16x16x32_bf16 v[144:147], v[104:107], v[32:35], v[144:147]
    s_waitcnt lgkmcnt(4)
    v_mfma_f32_16x16x32_bf16 v[160:163], v[112:115], v[32:35], v[160:163]
    ds_read_b64_tr_b16 v[96:97], v10 offset:128
    v_mfma_f32_16x16x32_bf16 v[160:163], v[116:119], v[36:39], v[160:163]
    ds_read_b64_tr_b16 v[98:99], v10 offset:896
    v_mfma_f32_16x16x32_bf16 v[164:167], v[116:119], v[44:47], v[164:167]
    ds_read_b64_tr_b16 v[100:101], v10 offset:6272
    v_mfma_f32_16x16x32_bf16 v[164:167], v[112:115], v[40:43], v[164:167]
    ds_read_b64_tr_b16 v[102:103], v10 offset:7040
    v_mfma_f32_16x16x32_bf16 v[168:171], v[112:115], v[48:51], v[168:171]
    v_add_u32 v10, s33, v10
    v_mfma_f32_16x16x32_bf16 v[168:171], v[116:119], v[52:55], v[168:171]
    v_mfma_f32_16x16x32_bf16 v[172:175], v[116:119], v[60:63], v[172:175]
    v_mfma_f32_16x16x32_bf16 v[172:175], v[112:115], v[56:59], v[172:175]
    s_waitcnt lgkmcnt(4)
    v_mfma_f32_16x16x32_bf16 v[188:191], v[120:123], v[56:59], v[188:191]
    ds_read_b64_tr_b16 v[104:105], v11 offset:128
    v_mfma_f32_16x16x32_bf16 v[188:191], v[124:127], v[60:63], v[188:191]
    ds_read_b64_tr_b16 v[106:107], v11 offset:896
    v_mfma_f32_16x16x32_bf16 v[184:187], v[124:127], v[52:55], v[184:187]
    ds_read_b64_tr_b16 v[108:109], v11 offset:6272
    v_mfma_f32_16x16x32_bf16 v[184:187], v[120:123], v[48:51], v[184:187]
    ds_read_b64_tr_b16 v[110:111], v11 offset:7040
    v_mfma_f32_16x16x32_bf16 v[180:183], v[120:123], v[40:43], v[180:183]
    v_add_u32 v11, s33, v11
    v_mfma_f32_16x16x32_bf16 v[180:183], v[124:127], v[44:47], v[180:183]
    v_mfma_f32_16x16x32_bf16 v[176:179], v[124:127], v[36:39], v[176:179]
    v_mfma_f32_16x16x32_bf16 v[176:179], v[120:123], v[32:35], v[176:179]
    s_waitcnt lgkmcnt(4)
    v_mfma_f32_16x16x32_bf16 v[192:195], v[32:35], v[96:99], v[192:195]
    ds_read_b64_tr_b16 v[112:113], v12 offset:0
    v_mfma_f32_16x16x32_bf16 v[192:195], v[36:39], v[100:103], v[192:195]
    ds_read_b64_tr_b16 v[114:115], v12 offset:256
    v_mfma_f32_16x16x32_bf16 v[196:199], v[44:47], v[100:103], v[196:199]
    ds_read_b64_tr_b16 v[116:117], v12 offset:2048
    v_mfma_f32_16x16x32_bf16 v[196:199], v[40:43], v[96:99], v[196:199]
    ds_read_b64_tr_b16 v[118:119], v12 offset:2304
    v_mfma_f32_16x16x32_bf16 v[200:203], v[48:51], v[96:99], v[200:203]
    v_add_u32 v12, s33, v12
    v_mfma_f32_16x16x32_bf16 v[200:203], v[52:55], v[100:103], v[200:203]
    v_mfma_f32_16x16x32_bf16 v[204:207], v[60:63], v[100:103], v[204:207]
    v_mfma_f32_16x16x32_bf16 v[204:207], v[56:59], v[96:99], v[204:207]
    s_waitcnt lgkmcnt(4)
    v_mfma_f32_16x16x32_bf16 v[220:223], v[56:59], v[104:107], v[220:223]
    ds_read_b64_tr_b16 v[120:121], v13 offset:0
    v_mfma_f32_16x16x32_bf16 v[220:223], v[60:63], v[108:111], v[220:223]
    ds_read_b64_tr_b16 v[122:123], v13 offset:256
    v_mfma_f32_16x16x32_bf16 v[216:219], v[52:55], v[108:111], v[216:219]
    ds_read_b64_tr_b16 v[124:125], v13 offset:2048
    v_mfma_f32_16x16x32_bf16 v[216:219], v[48:51], v[104:107], v[216:219]
    ds_read_b64_tr_b16 v[126:127], v13 offset:2304
    v_mfma_f32_16x16x32_bf16 v[212:215], v[40:43], v[104:107], v[212:215]
    v_add_u32 v13, s33, v13
    v_mfma_f32_16x16x32_bf16 v[212:215], v[44:47], v[108:111], v[212:215]
    v_mfma_f32_16x16x32_bf16 v[208:211], v[36:39], v[108:111], v[208:211]
    v_mfma_f32_16x16x32_bf16 v[208:211], v[32:35], v[104:107], v[208:211]
    s_waitcnt lgkmcnt(0)
    s_barrier
    v_mfma_f32_16x16x32_bf16 v[224:227], v[112:115], v[32:35], v[224:227]
    ds_read_b128 v[64:67], v8 offset:0
    v_mfma_f32_16x16x32_bf16 v[224:227], v[116:119], v[36:39], v[224:227]
    ds_read_b128 v[68:71], v9 offset:0
    v_mfma_f32_16x16x32_bf16 v[228:231], v[116:119], v[44:47], v[228:231]
    ds_read_b64_tr_b16 v[96:97], v10 offset:0
    v_mfma_f32_16x16x32_bf16 v[228:231], v[112:115], v[40:43], v[228:231]
    ds_read_b64_tr_b16 v[98:99], v10 offset:768
    v_mfma_f32_16x16x32_bf16 v[232:235], v[112:115], v[48:51], v[232:235]
    ds_read_b64_tr_b16 v[100:101], v10 offset:6144
    v_mfma_f32_16x16x32_bf16 v[232:235], v[116:119], v[52:55], v[232:235]
    ds_read_b64_tr_b16 v[102:103], v10 offset:6912
    v_mfma_f32_16x16x32_bf16 v[236:239], v[116:119], v[60:63], v[236:239]
    ds_read_b128 v[72:75], v8 offset:2048
    v_mfma_f32_16x16x32_bf16 v[236:239], v[112:115], v[56:59], v[236:239]
    ds_read_b128 v[76:79], v9 offset:2048
    v_mfma_f32_16x16x32_bf16 v[252:255], v[120:123], v[56:59], v[252:255]
    ds_read_b128 v[80:83], v8 offset:4096
    v_mfma_f32_16x16x32_bf16 v[252:255], v[124:127], v[60:63], v[252:255]
    ds_read_b128 v[84:87], v9 offset:4096
    v_mfma_f32_16x16x32_bf16 v[248:251], v[124:127], v[52:55], v[248:251]
    ds_read_b128 v[88:91], v8 offset:6144
    v_mfma_f32_16x16x32_bf16 v[248:251], v[120:123], v[48:51], v[248:251]
    ds_read_b128 v[92:95], v9 offset:6144
    v_mfma_f32_16x16x32_bf16 v[244:247], v[120:123], v[40:43], v[244:247]
    ds_read_b64_tr_b16 v[104:105], v11 offset:0
    v_mfma_f32_16x16x32_bf16 v[244:247], v[124:127], v[44:47], v[244:247]
    ds_read_b64_tr_b16 v[106:107], v11 offset:768
    v_mfma_f32_16x16x32_bf16 v[240:243], v[124:127], v[36:39], v[240:243]
    ds_read_b64_tr_b16 v[108:109], v11 offset:6144
    v_mfma_f32_16x16x32_bf16 v[240:243], v[120:123], v[32:35], v[240:243]
    ds_read_b64_tr_b16 v[110:111], v11 offset:6912
gated_mix__softmax_full_mha__mixer_s_mlp__prompt_kernel_ge50:
    s_waitcnt lgkmcnt(8)
    v_mfma_f32_16x16x32_bf16 v[128:131], v[96:99], v[64:67], v[128:131]
    ds_read_b64_tr_b16 v[112:113], v10 offset:64
    v_mfma_f32_16x16x32_bf16 v[128:131], v[100:103], v[68:71], v[128:131]
    ds_read_b64_tr_b16 v[114:115], v10 offset:832
    v_mfma_f32_16x16x32_bf16 v[132:135], v[100:103], v[76:79], v[132:135]
    ds_read_b64_tr_b16 v[116:117], v10 offset:6208
    v_mfma_f32_16x16x32_bf16 v[132:135], v[96:99], v[72:75], v[132:135]
    ds_read_b64_tr_b16 v[118:119], v10 offset:6976
    s_waitcnt lgkmcnt(11)
    v_mfma_f32_16x16x32_bf16 v[136:139], v[96:99], v[80:83], v[136:139]
    s_add_u32 s32, s32, 49152
    s_waitcnt lgkmcnt(10)
    v_mfma_f32_16x16x32_bf16 v[136:139], v[100:103], v[84:87], v[136:139]
    s_cmp_eq_u32 s32, 147456
    s_waitcnt lgkmcnt(8)
    v_mfma_f32_16x16x32_bf16 v[140:143], v[100:103], v[92:95], v[140:143]
    s_cselect_b32 s33, s39, 49152
    v_mfma_f32_16x16x32_bf16 v[140:143], v[96:99], v[88:91], v[140:143]
    s_cselect_b32 s32, 0, s32
    s_waitcnt lgkmcnt(4)
    v_mfma_f32_16x16x32_bf16 v[156:159], v[104:107], v[88:91], v[156:159]
    ds_read_b64_tr_b16 v[120:121], v11 offset:64
    v_mfma_f32_16x16x32_bf16 v[156:159], v[108:111], v[92:95], v[156:159]
    ds_read_b64_tr_b16 v[122:123], v11 offset:832
    v_mfma_f32_16x16x32_bf16 v[152:155], v[108:111], v[84:87], v[152:155]
    ds_read_b64_tr_b16 v[124:125], v11 offset:6208
    v_mfma_f32_16x16x32_bf16 v[152:155], v[104:107], v[80:83], v[152:155]
    ds_read_b64_tr_b16 v[126:127], v11 offset:6976
    v_mfma_f32_16x16x32_bf16 v[148:151], v[104:107], v[72:75], v[148:151]
    v_add_u32 v8, s33, v8
    v_mfma_f32_16x16x32_bf16 v[148:151], v[108:111], v[76:79], v[148:151]
    v_add_u32 v9, s33, v9
    v_mfma_f32_16x16x32_bf16 v[144:147], v[108:111], v[68:71], v[144:147]
    v_mfma_f32_16x16x32_bf16 v[144:147], v[104:107], v[64:67], v[144:147]
    s_waitcnt lgkmcnt(4)
    v_mfma_f32_16x16x32_bf16 v[160:163], v[112:115], v[64:67], v[160:163]
    ds_read_b64_tr_b16 v[96:97], v10 offset:128
    v_mfma_f32_16x16x32_bf16 v[160:163], v[116:119], v[68:71], v[160:163]
    ds_read_b64_tr_b16 v[98:99], v10 offset:896
    v_mfma_f32_16x16x32_bf16 v[164:167], v[116:119], v[76:79], v[164:167]
    ds_read_b64_tr_b16 v[100:101], v10 offset:6272
    v_mfma_f32_16x16x32_bf16 v[164:167], v[112:115], v[72:75], v[164:167]
    ds_read_b64_tr_b16 v[102:103], v10 offset:7040
    v_mfma_f32_16x16x32_bf16 v[168:171], v[112:115], v[80:83], v[168:171]
    v_add_u32 v10, s33, v10
    v_mfma_f32_16x16x32_bf16 v[168:171], v[116:119], v[84:87], v[168:171]
    v_mfma_f32_16x16x32_bf16 v[172:175], v[116:119], v[92:95], v[172:175]
    v_mfma_f32_16x16x32_bf16 v[172:175], v[112:115], v[88:91], v[172:175]
    s_waitcnt lgkmcnt(4)
    v_mfma_f32_16x16x32_bf16 v[188:191], v[120:123], v[88:91], v[188:191]
    ds_read_b64_tr_b16 v[104:105], v11 offset:128
    v_mfma_f32_16x16x32_bf16 v[188:191], v[124:127], v[92:95], v[188:191]
    ds_read_b64_tr_b16 v[106:107], v11 offset:896
    v_mfma_f32_16x16x32_bf16 v[184:187], v[124:127], v[84:87], v[184:187]
    ds_read_b64_tr_b16 v[108:109], v11 offset:6272
    v_mfma_f32_16x16x32_bf16 v[184:187], v[120:123], v[80:83], v[184:187]
    ds_read_b64_tr_b16 v[110:111], v11 offset:7040
    v_mfma_f32_16x16x32_bf16 v[180:183], v[120:123], v[72:75], v[180:183]
    v_add_u32 v11, s33, v11
    v_mfma_f32_16x16x32_bf16 v[180:183], v[124:127], v[76:79], v[180:183]
    v_mfma_f32_16x16x32_bf16 v[176:179], v[124:127], v[68:71], v[176:179]
    v_mfma_f32_16x16x32_bf16 v[176:179], v[120:123], v[64:67], v[176:179]
    s_waitcnt lgkmcnt(4)
    v_mfma_f32_16x16x32_bf16 v[192:195], v[64:67], v[96:99], v[192:195]
    ds_read_b64_tr_b16 v[112:113], v12 offset:0
    v_mfma_f32_16x16x32_bf16 v[192:195], v[68:71], v[100:103], v[192:195]
    ds_read_b64_tr_b16 v[114:115], v12 offset:256
    v_mfma_f32_16x16x32_bf16 v[196:199], v[76:79], v[100:103], v[196:199]
    ds_read_b64_tr_b16 v[116:117], v12 offset:2048
    v_mfma_f32_16x16x32_bf16 v[196:199], v[72:75], v[96:99], v[196:199]
    ds_read_b64_tr_b16 v[118:119], v12 offset:2304
    v_mfma_f32_16x16x32_bf16 v[200:203], v[80:83], v[96:99], v[200:203]
    v_add_u32 v12, s33, v12
    v_mfma_f32_16x16x32_bf16 v[200:203], v[84:87], v[100:103], v[200:203]
    v_mfma_f32_16x16x32_bf16 v[204:207], v[92:95], v[100:103], v[204:207]
    v_mfma_f32_16x16x32_bf16 v[204:207], v[88:91], v[96:99], v[204:207]
    s_waitcnt lgkmcnt(4)
    v_mfma_f32_16x16x32_bf16 v[220:223], v[88:91], v[104:107], v[220:223]
    ds_read_b64_tr_b16 v[120:121], v13 offset:0
    v_mfma_f32_16x16x32_bf16 v[220:223], v[92:95], v[108:111], v[220:223]
    ds_read_b64_tr_b16 v[122:123], v13 offset:256
    v_mfma_f32_16x16x32_bf16 v[216:219], v[84:87], v[108:111], v[216:219]
    ds_read_b64_tr_b16 v[124:125], v13 offset:2048
    v_mfma_f32_16x16x32_bf16 v[216:219], v[80:83], v[104:107], v[216:219]
    ds_read_b64_tr_b16 v[126:127], v13 offset:2304
    v_mfma_f32_16x16x32_bf16 v[212:215], v[72:75], v[104:107], v[212:215]
    v_add_u32 v13, s33, v13
    v_mfma_f32_16x16x32_bf16 v[212:215], v[76:79], v[108:111], v[212:215]
    v_mfma_f32_16x16x32_bf16 v[208:211], v[68:71], v[108:111], v[208:211]
    v_mfma_f32_16x16x32_bf16 v[208:211], v[64:67], v[104:107], v[208:211]
    s_waitcnt lgkmcnt(0)
    s_barrier
    v_mfma_f32_16x16x32_bf16 v[224:227], v[112:115], v[64:67], v[224:227]
    ds_read_b128 v[32:35], v8 offset:0
    v_mfma_f32_16x16x32_bf16 v[224:227], v[116:119], v[68:71], v[224:227]
    ds_read_b128 v[36:39], v9 offset:0
    v_mfma_f32_16x16x32_bf16 v[228:231], v[116:119], v[76:79], v[228:231]
    ds_read_b64_tr_b16 v[96:97], v10 offset:0
    v_mfma_f32_16x16x32_bf16 v[228:231], v[112:115], v[72:75], v[228:231]
    ds_read_b64_tr_b16 v[98:99], v10 offset:768
    v_mfma_f32_16x16x32_bf16 v[232:235], v[112:115], v[80:83], v[232:235]
    ds_read_b64_tr_b16 v[100:101], v10 offset:6144
    v_mfma_f32_16x16x32_bf16 v[232:235], v[116:119], v[84:87], v[232:235]
    ds_read_b64_tr_b16 v[102:103], v10 offset:6912
    v_mfma_f32_16x16x32_bf16 v[236:239], v[116:119], v[92:95], v[236:239]
    ds_read_b128 v[40:43], v8 offset:2048
    v_mfma_f32_16x16x32_bf16 v[236:239], v[112:115], v[88:91], v[236:239]
    ds_read_b128 v[44:47], v9 offset:2048
    ds_read_b128 v[48:51], v8 offset:4096
    v_mfma_f32_16x16x32_bf16 v[252:255], v[120:123], v[88:91], v[252:255]
    ds_read_b128 v[52:55], v9 offset:4096
    v_mfma_f32_16x16x32_bf16 v[252:255], v[124:127], v[92:95], v[252:255]
    ds_read_b128 v[56:59], v8 offset:6144
    v_mfma_f32_16x16x32_bf16 v[248:251], v[124:127], v[84:87], v[248:251]
    ds_read_b128 v[60:63], v9 offset:6144
    v_mfma_f32_16x16x32_bf16 v[248:251], v[120:123], v[80:83], v[248:251]
    ds_read_b64_tr_b16 v[104:105], v11 offset:0
    v_mfma_f32_16x16x32_bf16 v[244:247], v[120:123], v[72:75], v[244:247]
    ds_read_b64_tr_b16 v[106:107], v11 offset:768
    v_mfma_f32_16x16x32_bf16 v[244:247], v[124:127], v[76:79], v[244:247]
    ds_read_b64_tr_b16 v[108:109], v11 offset:6144
    v_mfma_f32_16x16x32_bf16 v[240:243], v[124:127], v[68:71], v[240:243]
    ds_read_b64_tr_b16 v[110:111], v11 offset:6912
    v_mfma_f32_16x16x32_bf16 v[240:243], v[120:123], v[64:67], v[240:243]
    s_sub_u32 s31, s31, 2
    s_bitcmp1_b32 0xeffe, s31
    s_cbranch_scc1 gated_mix__softmax_full_mha__mixer_s_mlp__prompt_kernel_gl49
    s_cmp_lg_u32 s31, 0
    s_cbranch_scc1 gated_mix__softmax_full_mha__mixer_s_mlp__prompt_kernel_gev51
    s_setprio 2
    s_setprio 2
    v_and_b32 v16, 15, v0
    v_lshrrev_b32 v17, 4, v0
    v_lshlrev_b32 v18, 9, v17
    v_lshl_or_b32 v8, v16, 4, v18
    v_and_b32 v19, 7, v16
    v_lshrrev_b32 v20, 3, v16
    v_lshl_or_b32 v18, v20, 8, v18
    v_lshl_or_b32 v9, v19, 4, v18
    s_add_u32 s63, s51, 2
    s_and_b32 s63, s63, 31
    s_lshl_b32 s45, s63, 10
    s_add_u32 s45, s45, 12582912
    s_lshl_b32 s43, s51, 18
    s_lshl_b32 s4, s41, 15
    s_lshl_b32 s5, s24, 13
    s_add_u32 s43, s43, s4
    s_add_u32 s43, s43, s5
    s_add_u32 s43, s43, 4194304
    s_add_u32 s44, s43, 4096
    s_add_u32 s5, s5, s32
    v_add_u32 v12, s5, v8
    v_add_u32 v13, s5, v9
    s_lshl_b32 s5, s24, 12
    s_add_u32 s5, s5, s32
    v_add_u32 v14, s5, v8
    s_mov_b32 s46, 0x3e8293ee
    s_mov_b32 s47, 0x3e8293ee
    s_and_b32 s3, s51, 1
    s_lshl_b32 s3, s3, 7
    s_add_u32 s3, s3, 157696
    v_lshl_add_u32 v10, v17, 4, s3
    s_lshl_b32 s3, s24, 8
    s_add_u32 s3, s3, 147456
    v_lshl_add_u32 v11, v16, 2, s3
    s_waitcnt lgkmcnt(15)
    v_cvt_pk_bf16_f32 v32, v160, v161
    v_cvt_pk_bf16_f32 v33, v162, v163
    v_cvt_pk_bf16_f32 v34, v176, v177
    v_cvt_pk_bf16_f32 v35, v178, v179
    buffer_store_dwordx4 v[32:35], v9, s[16:19], s43 offen offset:0 sc1
    ds_write_b128 v13, v[32:35] offset:0
    s_waitcnt lgkmcnt(15)
    v_cvt_pk_bf16_f32 v36, v164, v165
    v_cvt_pk_bf16_f32 v37, v166, v167
    v_cvt_pk_bf16_f32 v38, v180, v181
    v_cvt_pk_bf16_f32 v39, v182, v183
    buffer_store_dwordx4 v[36:39], v9, s[16:19], s43 offen offset:128 sc1
    ds_write_b128 v13, v[36:39] offset:128
    s_waitcnt lgkmcnt(11)
    v_cvt_pk_bf16_f32 v40, v168, v169
    v_cvt_pk_bf16_f32 v41, v170, v171
    v_cvt_pk_bf16_f32 v42, v184, v185
    v_cvt_pk_bf16_f32 v43, v186, v187
    buffer_store_dwordx4 v[40:43], v9, s[16:19], s44 offen offset:0 sc1
    ds_write_b128 v13, v[40:43] offset:4096
    s_waitcnt lgkmcnt(11)
    v_cvt_pk_bf16_f32 v44, v172, v173
    v_cvt_pk_bf16_f32 v45, v174, v175
    v_cvt_pk_bf16_f32 v46, v188, v189
    v_cvt_pk_bf16_f32 v47, v190, v191
    buffer_store_dwordx4 v[44:47], v9, s[16:19], s44 offen offset:128 sc1
    ds_write_b128 v13, v[44:47] offset:4224
    s_waitcnt lgkmcnt(11)
    v_cvt_pk_bf16_f32 v48, v192, v193
    v_cvt_pk_bf16_f32 v49, v194, v195
    v_cvt_pk_bf16_f32 v50, v196, v197
    v_cvt_pk_bf16_f32 v51, v198, v199
    buffer_store_dwordx4 v[48:51], v8, s[16:19], s43 offen offset:2048 sc1
    ds_write_b128 v12, v[48:51] offset:2048
    s_waitcnt lgkmcnt(11)
    v_cvt_pk_bf16_f32 v52, v208, v209
    v_cvt_pk_bf16_f32 v53, v210, v211
    v_cvt_pk_bf16_f32 v54, v212, v213
    v_cvt_pk_bf16_f32 v55, v214, v215
    buffer_store_dwordx4 v[52:55], v8, s[16:19], s43 offen offset:2304 sc1
    ds_write_b128 v12, v[52:55] offset:2304
    s_waitcnt lgkmcnt(11)
    v_cvt_pk_bf16_f32 v56, v200, v201
    v_cvt_pk_bf16_f32 v57, v202, v203
    v_cvt_pk_bf16_f32 v58, v204, v205
    v_cvt_pk_bf16_f32 v59, v206, v207
    buffer_store_dwordx4 v[56:59], v8, s[16:19], s44 offen offset:2048 sc1
    ds_write_b128 v12, v[56:59] offset:6144
    s_waitcnt lgkmcnt(11)
    v_cvt_pk_bf16_f32 v60, v216, v217
    v_cvt_pk_bf16_f32 v61, v218, v219
    v_cvt_pk_bf16_f32 v62, v220, v221
    v_cvt_pk_bf16_f32 v63, v222, v223
    buffer_store_dwordx4 v[60:63], v8, s[16:19], s44 offen offset:2304 sc1
    ds_write_b128 v12, v[60:63] offset:6400
    v_pk_mul_f32 v[128:129], v[128:129], s[46:47]
    v_pk_mul_f32 v[130:131], v[130:131], s[46:47]
    v_pk_mul_f32 v[144:145], v[144:145], s[46:47]
    v_pk_mul_f32 v[146:147], v[146:147], s[46:47]
    v_cvt_pk_bf16_f32 v64, v128, v129
    v_cvt_pk_bf16_f32 v65, v130, v131
    v_cvt_pk_bf16_f32 v66, v144, v145
    v_cvt_pk_bf16_f32 v67, v146, v147
    ds_write_b128 v14, v[64:67] offset:32768
    v_pk_mul_f32 v[132:133], v[132:133], s[46:47]
    v_pk_mul_f32 v[134:135], v[134:135], s[46:47]
    v_pk_mul_f32 v[148:149], v[148:149], s[46:47]
    v_pk_mul_f32 v[150:151], v[150:151], s[46:47]
    v_cvt_pk_bf16_f32 v68, v132, v133
    v_cvt_pk_bf16_f32 v69, v134, v135
    v_cvt_pk_bf16_f32 v70, v148, v149
    v_cvt_pk_bf16_f32 v71, v150, v151
    ds_write_b128 v14, v[68:71] offset:33024
    v_pk_mul_f32 v[136:137], v[136:137], s[46:47]
    v_pk_mul_f32 v[138:139], v[138:139], s[46:47]
    v_pk_mul_f32 v[152:153], v[152:153], s[46:47]
    v_pk_mul_f32 v[154:155], v[154:155], s[46:47]
    v_cvt_pk_bf16_f32 v72, v136, v137
    v_cvt_pk_bf16_f32 v73, v138, v139
    v_cvt_pk_bf16_f32 v74, v152, v153
    v_cvt_pk_bf16_f32 v75, v154, v155
    ds_write_b128 v14, v[72:75] offset:34816
    v_pk_mul_f32 v[140:141], v[140:141], s[46:47]
    v_pk_mul_f32 v[142:143], v[142:143], s[46:47]
    v_pk_mul_f32 v[156:157], v[156:157], s[46:47]
    v_pk_mul_f32 v[158:159], v[158:159], s[46:47]
    v_cvt_pk_bf16_f32 v76, v140, v141
    v_cvt_pk_bf16_f32 v77, v142, v143
    v_cvt_pk_bf16_f32 v78, v156, v157
    v_cvt_pk_bf16_f32 v79, v158, v159
    ds_write_b128 v14, v[76:79] offset:35072
    s_waitcnt lgkmcnt(0)
    s_barrier
    ds_read_b128 v[80:83], v10
    ds_read_b128 v[84:87], v10 offset:64
    ds_read_b32 v88, v11 offset:0
    ds_read_b32 v89, v11 offset:1024
    ds_read_b32 v96, v11 offset:64
    ds_read_b32 v97, v11 offset:1088
    ds_read_b32 v104, v11 offset:128
    ds_read_b32 v105, v11 offset:1152
    ds_read_b32 v112, v11 offset:192
    ds_read_b32 v113, v11 offset:1216
    s_waitcnt lgkmcnt(6)
    v_mul_f32 v93, v89, v89
    v_mul_f32 v92, 0xc0135761, v89
    v_mul_f32 v93, v93, v89
    v_mul_f32 v90, 0xbdd2d3e8, v93
    v_rcp_f32 v94, v89
    s_nop 0
    v_min_f32 v94, 0x7f61b1e6, v94
    s_waitcnt lgkmcnt(4)
    v_mul_f32 v101, v97, v97
    v_mul_f32 v100, 0xc0135761, v97
    v_mul_f32 v101, v101, v97
    v_mul_f32 v98, 0xbdd2d3e8, v101
    v_rcp_f32 v102, v97
    s_nop 0
    v_min_f32 v102, 0x7f61b1e6, v102
    s_waitcnt lgkmcnt(2)
    v_mul_f32 v109, v105, v105
    v_mul_f32 v108, 0xc0135761, v105
    v_mul_f32 v109, v109, v105
    v_mul_f32 v106, 0xbdd2d3e8, v109
    v_rcp_f32 v110, v105
    s_nop 0
    v_min_f32 v110, 0x7f61b1e6, v110
    s_waitcnt lgkmcnt(0)
    v_mul_f32 v117, v113, v113
    v_mul_f32 v116, 0xc0135761, v113
    v_mul_f32 v117, v117, v113
    v_mul_f32 v114, 0xbdd2d3e8, v117
    v_rcp_f32 v118, v113
    s_nop 0
    v_min_f32 v118, 0x7f61b1e6, v118
    s_lshr_b32 s5, s63, 3
    s_lshr_b32 s6, s5, 1
    s_add_u32 s6, s6, 1
    s_sub_u32 s7, 0, s6
    s_bitcmp1_b32 s5, 0
    s_cselect_b32 s6, s7, s6
    s_lshl_b32 s3, s41, 8
    s_lshl_b32 s4, s24, 6
    s_add_u32 s3, s3, s4
    s_add_u32 s6, s6, s3
    v_pk_fma_f32 v[224:225], v[80:81], v[88:89], v[224:225] op_sel_hi:[1,0,1] neg_lo:[1,0,0] neg_hi:[1,0,0]
    v_pk_fma_f32 v[226:227], v[82:83], v[88:89], v[226:227] op_sel_hi:[1,0,1] neg_lo:[1,0,0] neg_hi:[1,0,0]
    v_pk_fma_f32 v[240:241], v[84:85], v[88:89], v[240:241] op_sel_hi:[1,0,1] neg_lo:[1,0,0] neg_hi:[1,0,0]
    v_pk_fma_f32 v[242:243], v[86:87], v[88:89], v[242:243] op_sel_hi:[1,0,1] neg_lo:[1,0,0] neg_hi:[1,0,0]
    v_pk_fma_f32 v[228:229], v[80:81], v[96:97], v[228:229] op_sel_hi:[1,0,1] neg_lo:[1,0,0] neg_hi:[1,0,0]
    v_pk_fma_f32 v[230:231], v[82:83], v[96:97], v[230:231] op_sel_hi:[1,0,1] neg_lo:[1,0,0] neg_hi:[1,0,0]
    v_pk_fma_f32 v[244:245], v[84:85], v[96:97], v[244:245] op_sel_hi:[1,0,1] neg_lo:[1,0,0] neg_hi:[1,0,0]
    v_pk_fma_f32 v[246:247], v[86:87], v[96:97], v[246:247] op_sel_hi:[1,0,1] neg_lo:[1,0,0] neg_hi:[1,0,0]
    v_pk_mul_f32 v[128:129], v[224:225], v[224:225]
    v_pk_mul_f32 v[130:131], v[226:227], v[226:227]
    v_pk_mul_f32 v[132:133], v[240:241], v[240:241]
    v_pk_mul_f32 v[134:135], v[242:243], v[242:243]
    v_pk_mul_f32 v[136:137], v[228:229], v[228:229]
    v_pk_mul_f32 v[138:139], v[230:231], v[230:231]
    v_pk_mul_f32 v[140:141], v[244:245], v[244:245]
    v_pk_mul_f32 v[142:143], v[246:247], v[246:247]
    v_pk_fma_f32 v[128:129], v[128:129], v[90:91], v[92:93] op_sel_hi:[1,0,0]
    v_pk_fma_f32 v[130:131], v[130:131], v[90:91], v[92:93] op_sel_hi:[1,0,0]
    v_pk_fma_f32 v[132:133], v[132:133], v[90:91], v[92:93] op_sel_hi:[1,0,0]
    v_pk_fma_f32 v[134:135], v[134:135], v[90:91], v[92:93] op_sel_hi:[1,0,0]
    v_pk_fma_f32 v[136:137], v[136:137], v[98:99], v[100:101] op_sel_hi:[1,0,0]
    v_pk_fma_f32 v[138:139], v[138:139], v[98:99], v[100:101] op_sel_hi:[1,0,0]
    v_pk_fma_f32 v[140:141], v[140:141], v[98:99], v[100:101] op_sel_hi:[1,0,0]
    v_pk_fma_f32 v[142:143], v[142:143], v[98:99], v[100:101] op_sel_hi:[1,0,0]
    v_pk_mul_f32 v[128:129], v[128:129], v[224:225]
    v_pk_mul_f32 v[130:131], v[130:131], v[226:227]
    v_pk_mul_f32 v[132:133], v[132:133], v[240:241]
    v_pk_mul_f32 v[134:135], v[134:135], v[242:243]
    v_pk_mul_f32 v[136:137], v[136:137], v[228:229]
    v_pk_mul_f32 v[138:139], v[138:139], v[230:231]
    v_pk_mul_f32 v[140:141], v[140:141], v[244:245]
    v_pk_mul_f32 v[142:143], v[142:143], v[246:247]
    v_exp_f32 v128, v128
    v_exp_f32 v129, v129
    v_exp_f32 v130, v130
    v_exp_f32 v131, v131
    v_exp_f32 v132, v132
    v_exp_f32 v133, v133
    v_exp_f32 v134, v134
    v_exp_f32 v135, v135
    v_exp_f32 v136, v136
    v_exp_f32 v137, v137
    v_exp_f32 v138, v138
    v_exp_f32 v139, v139
    v_exp_f32 v140, v140
    v_exp_f32 v141, v141
    v_exp_f32 v142, v142
    v_exp_f32 v143, v143
    v_pk_fma_f32 v[128:129], v[128:129], v[94:95], v[94:95] op_sel_hi:[1,0,0]
    v_pk_fma_f32 v[130:131], v[130:131], v[94:95], v[94:95] op_sel_hi:[1,0,0]
    v_pk_fma_f32 v[132:133], v[132:133], v[94:95], v[94:95] op_sel_hi:[1,0,0]
    v_pk_fma_f32 v[134:135], v[134:135], v[94:95], v[94:95] op_sel_hi:[1,0,0]
    v_pk_fma_f32 v[136:137], v[136:137], v[102:103], v[102:103] op_sel_hi:[1,0,0]
    v_pk_fma_f32 v[138:139], v[138:139], v[102:103], v[102:103] op_sel_hi:[1,0,0]
    v_pk_fma_f32 v[140:141], v[140:141], v[102:103], v[102:103] op_sel_hi:[1,0,0]
    v_pk_fma_f32 v[142:143], v[142:143], v[102:103], v[102:103] op_sel_hi:[1,0,0]
    v_rcp_f32 v128, v128
    v_rcp_f32 v129, v129
    v_rcp_f32 v130, v130
    v_rcp_f32 v131, v131
    v_rcp_f32 v132, v132
    v_rcp_f32 v133, v133
    v_rcp_f32 v134, v134
    v_rcp_f32 v135, v135
    v_rcp_f32 v136, v136
    v_rcp_f32 v137, v137
    v_rcp_f32 v138, v138
    v_rcp_f32 v139, v139
    v_rcp_f32 v140, v140
    v_rcp_f32 v141, v141
    v_rcp_f32 v142, v142
    v_rcp_f32 v143, v143
    v_pk_mul_f32 v[224:225], v[224:225], v[128:129]
    v_pk_mul_f32 v[226:227], v[226:227], v[130:131]
    v_pk_mul_f32 v[240:241], v[240:241], v[132:133]
    v_pk_mul_f32 v[242:243], v[242:243], v[134:135]
    v_pk_mul_f32 v[228:229], v[228:229], v[136:137]
    v_pk_mul_f32 v[230:231], v[230:231], v[138:139]
    v_pk_mul_f32 v[244:245], v[244:245], v[140:141]
    v_pk_mul_f32 v[246:247], v[246:247], v[142:143]
    v_add_u32 v18, s6, v16
    v_and_b32 v19, 15, v18
    v_lshl_add_u32 v19, v17, 4, v19
    v_lshlrev_b32 v19, 4, v19
    v_ashrrev_i32 v20, 4, v18
    v_lshl_add_u32 v19, v20, 15, v19
    v_and_b32 v176, 0x3fffff, v19
    v_add_u32 v177, 32768, v19
    v_add_u32 v178, 65536, v19
    v_add_u32 v179, 98304, v19
    v_and_b32 v179, 0x3fffff, v179
    v_cmp_le_i32 vcc, 0, v18
    v_cvt_pk_bf16_f32 v160, v224, v225
    v_cvt_pk_bf16_f32 v161, v226, v227
    v_cvt_pk_bf16_f32 v162, v240, v241
    v_cvt_pk_bf16_f32 v163, v242, v243
    v_cndmask_b32 v160, 0, v160, vcc
    v_cndmask_b32 v161, 0, v161, vcc
    v_cndmask_b32 v162, 0, v162, vcc
    v_cndmask_b32 v163, 0, v163, vcc
    v_cvt_pk_bf16_f32 v164, v228, v229
    v_cvt_pk_bf16_f32 v165, v230, v231
    v_cvt_pk_bf16_f32 v166, v244, v245
    v_cvt_pk_bf16_f32 v167, v246, v247
    s_waitcnt vmcnt(0)
    v_mov_b32 v28, 153360
    v_mov_b32 v29, 1
    s_mov_b64 exec, 1
    ds_add_rtn_u32 v28, v28, v29
    s_mov_b64 exec, -1
    s_waitcnt lgkmcnt(0)
    v_readfirstlane_b32 s3, v28
    s_nop 1
    s_and_b32 s3, s3, 3
    s_cmp_eq_u32 s3, 3
    s_cselect_b32 s3, s88, 62914560
    v_lshlrev_b32 v28, 2, v0
    s_mov_b64 exec, 15
    buffer_store_dword v29, v28, s[16:19], s3 offen sc1
    s_mov_b64 exec, -1
    v_pk_fma_f32 v[232:233], v[80:81], v[104:105], v[232:233] op_sel_hi:[1,0,1] neg_lo:[1,0,0] neg_hi:[1,0,0]
    v_pk_fma_f32 v[234:235], v[82:83], v[104:105], v[234:235] op_sel_hi:[1,0,1] neg_lo:[1,0,0] neg_hi:[1,0,0]
    v_pk_fma_f32 v[248:249], v[84:85], v[104:105], v[248:249] op_sel_hi:[1,0,1] neg_lo:[1,0,0] neg_hi:[1,0,0]
    v_pk_fma_f32 v[250:251], v[86:87], v[104:105], v[250:251] op_sel_hi:[1,0,1] neg_lo:[1,0,0] neg_hi:[1,0,0]
    v_pk_fma_f32 v[236:237], v[80:81], v[112:113], v[236:237] op_sel_hi:[1,0,1] neg_lo:[1,0,0] neg_hi:[1,0,0]
    v_pk_fma_f32 v[238:239], v[82:83], v[112:113], v[238:239] op_sel_hi:[1,0,1] neg_lo:[1,0,0] neg_hi:[1,0,0]
    v_pk_fma_f32 v[252:253], v[84:85], v[112:113], v[252:253] op_sel_hi:[1,0,1] neg_lo:[1,0,0] neg_hi:[1,0,0]
    v_pk_fma_f32 v[254:255], v[86:87], v[112:113], v[254:255] op_sel_hi:[1,0,1] neg_lo:[1,0,0] neg_hi:[1,0,0]
    v_pk_mul_f32 v[128:129], v[232:233], v[232:233]
    v_pk_mul_f32 v[130:131], v[234:235], v[234:235]
    v_pk_mul_f32 v[132:133], v[248:249], v[248:249]
    v_pk_mul_f32 v[134:135], v[250:251], v[250:251]
    v_pk_mul_f32 v[136:137], v[236:237], v[236:237]
    v_pk_mul_f32 v[138:139], v[238:239], v[238:239]
    v_pk_mul_f32 v[140:141], v[252:253], v[252:253]
    v_pk_mul_f32 v[142:143], v[254:255], v[254:255]
    v_pk_fma_f32 v[128:129], v[128:129], v[106:107], v[108:109] op_sel_hi:[1,0,0]
    v_pk_fma_f32 v[130:131], v[130:131], v[106:107], v[108:109] op_sel_hi:[1,0,0]
    v_pk_fma_f32 v[132:133], v[132:133], v[106:107], v[108:109] op_sel_hi:[1,0,0]
    v_pk_fma_f32 v[134:135], v[134:135], v[106:107], v[108:109] op_sel_hi:[1,0,0]
    v_pk_fma_f32 v[136:137], v[136:137], v[114:115], v[116:117] op_sel_hi:[1,0,0]
    v_pk_fma_f32 v[138:139], v[138:139], v[114:115], v[116:117] op_sel_hi:[1,0,0]
    v_pk_fma_f32 v[140:141], v[140:141], v[114:115], v[116:117] op_sel_hi:[1,0,0]
    v_pk_fma_f32 v[142:143], v[142:143], v[114:115], v[116:117] op_sel_hi:[1,0,0]
    v_pk_mul_f32 v[128:129], v[128:129], v[232:233]
    v_pk_mul_f32 v[130:131], v[130:131], v[234:235]
    v_pk_mul_f32 v[132:133], v[132:133], v[248:249]
    v_pk_mul_f32 v[134:135], v[134:135], v[250:251]
    v_pk_mul_f32 v[136:137], v[136:137], v[236:237]
    v_pk_mul_f32 v[138:139], v[138:139], v[238:239]
    v_pk_mul_f32 v[140:141], v[140:141], v[252:253]
    v_pk_mul_f32 v[142:143], v[142:143], v[254:255]
    v_exp_f32 v128, v128
    v_exp_f32 v129, v129
    v_exp_f32 v130, v130
    v_exp_f32 v131, v131
    v_exp_f32 v132, v132
    v_exp_f32 v133, v133
    v_exp_f32 v134, v134
    v_exp_f32 v135, v135
    v_exp_f32 v136, v136
    v_exp_f32 v137, v137
    v_exp_f32 v138, v138
    v_exp_f32 v139, v139
    v_exp_f32 v140, v140
    v_exp_f32 v141, v141
    v_exp_f32 v142, v142
    v_exp_f32 v143, v143
    v_pk_fma_f32 v[128:129], v[128:129], v[110:111], v[110:111] op_sel_hi:[1,0,0]
    v_pk_fma_f32 v[130:131], v[130:131], v[110:111], v[110:111] op_sel_hi:[1,0,0]
    v_pk_fma_f32 v[132:133], v[132:133], v[110:111], v[110:111] op_sel_hi:[1,0,0]
    v_pk_fma_f32 v[134:135], v[134:135], v[110:111], v[110:111] op_sel_hi:[1,0,0]
    v_pk_fma_f32 v[136:137], v[136:137], v[118:119], v[118:119] op_sel_hi:[1,0,0]
    v_pk_fma_f32 v[138:139], v[138:139], v[118:119], v[118:119] op_sel_hi:[1,0,0]
    v_pk_fma_f32 v[140:141], v[140:141], v[118:119], v[118:119] op_sel_hi:[1,0,0]
    v_pk_fma_f32 v[142:143], v[142:143], v[118:119], v[118:119] op_sel_hi:[1,0,0]
    v_rcp_f32 v128, v128
    v_rcp_f32 v129, v129
    v_rcp_f32 v130, v130
    v_rcp_f32 v131, v131
    v_rcp_f32 v132, v132
    v_rcp_f32 v133, v133
    v_rcp_f32 v134, v134
    v_rcp_f32 v135, v135
    v_rcp_f32 v136, v136
    v_rcp_f32 v137, v137
    v_rcp_f32 v138, v138
    v_rcp_f32 v139, v139
    v_rcp_f32 v140, v140
    v_rcp_f32 v141, v141
    v_rcp_f32 v142, v142
    v_rcp_f32 v143, v143
    v_pk_mul_f32 v[232:233], v[232:233], v[128:129]
    v_pk_mul_f32 v[234:235], v[234:235], v[130:131]
    v_pk_mul_f32 v[248:249], v[248:249], v[132:133]
    v_pk_mul_f32 v[250:251], v[250:251], v[134:135]
    v_pk_mul_f32 v[236:237], v[236:237], v[136:137]
    v_pk_mul_f32 v[238:239], v[238:239], v[138:139]
    v_pk_mul_f32 v[252:253], v[252:253], v[140:141]
    v_pk_mul_f32 v[254:255], v[254:255], v[142:143]
    v_cvt_pk_bf16_f32 v168, v232, v233
    v_cvt_pk_bf16_f32 v169, v234, v235
    v_cvt_pk_bf16_f32 v170, v248, v249
    v_cvt_pk_bf16_f32 v171, v250, v251
    v_cmp_gt_i32 vcc, 2000, v18
    v_cvt_pk_bf16_f32 v172, v236, v237
    v_cvt_pk_bf16_f32 v173, v238, v239
    v_cvt_pk_bf16_f32 v174, v252, v253
    v_cvt_pk_bf16_f32 v175, v254, v255
    v_cndmask_b32 v172, 0, v172, vcc
    v_cndmask_b32 v173, 0, v173, vcc
    v_cndmask_b32 v174, 0, v174, vcc
    v_cndmask_b32 v175, 0, v175, vcc
    buffer_store_dwordx4 v[160:163], v176, s[16:19], s45 offen sc1
    buffer_store_dwordx4 v[164:167], v177, s[16:19], s45 offen sc1
    buffer_store_dwordx4 v[168:171], v178, s[16:19], s45 offen sc1
    buffer_store_dwordx4 v[172:175], v179, s[16:19], s45 offen sc1
    s_mov_b32 s25, s24
    s_mov_b32 s34, s32
    s_add_u32 s34, s34, 49152
    s_cmp_eq_u32 s34, 147456
    s_cselect_b32 s34, 0, s34
    s_lshl_b32 s3, s51, 18
    s_add_u32 s3, s3, 4194304
    s_add_u32 s8, s86, s3
    s_addc_u32 s9, s87, 0
    s_mov_b32 s10, 0x40000
    s_mov_b32 s11, 0x20000
    s_lshl_b32 s37, s25, 12
    s_add_u32 s35, s37, 32768
    s_lshl_b32 s101, s41, 15
    s_add_u32 s101, s101, s37
    s_sub_u32 s3, s35, 32768
    s_cmp_ge_u32 s3, s101
    s_cselect_b32 s35, s35, s3
    s_cmp_eq_u32 s25, 0
    s_cbranch_scc0 gated_mix__softmax_full_mha__mixer_s_mlp__prompt_kernel_p153
    v_and_b32 v136, 7, v0
    s_lshr_b32 s3, s51, 0
    s_lshl_b32 s3, s3, 3
    v_add_u32 v136, s3, v136
    v_lshlrev_b32 v136, 7, v136
    s_mov_b32 s40, 45613056
    buffer_load_dwordx4 v[140:143], v136, s[16:19], s40 offen sc1
gated_mix__softmax_full_mha__mixer_s_mlp__prompt_kernel_p153:
    s_waitcnt vmcnt(0)
    v_mov_b32 v28, 153364
    v_mov_b32 v29, 1
    s_mov_b64 exec, 1
    ds_add_rtn_u32 v28, v28, v29
    s_mov_b64 exec, -1
    s_waitcnt lgkmcnt(0)
    v_readfirstlane_b32 s3, v28
    s_nop 1
    s_and_b32 s3, s3, 3
    s_cmp_eq_u32 s3, 3
    s_cselect_b32 s3, s89, 62914560
    v_lshlrev_b32 v28, 2, v0
    s_mov_b64 exec, 15
    buffer_store_dword v29, v28, s[16:19], s3 offen sc1
    s_mov_b64 exec, -1
    v_mov_b32 v139, 153344
    s_cmp_eq_u32 s24, 0
    s_cbranch_scc0 gated_mix__softmax_full_mha__mixer_s_mlp__prompt_kernel_gw55
    s_mov_b32 s5, 100000
gated_mix__softmax_full_mha__mixer_s_mlp__prompt_kernel_poll58:
    v_min3_u32 v137, v140, v141, v142
    v_min_u32 v137, v137, v143
    v_cmp_eq_u32 vcc, 0, v137
    s_nop 4
    s_cbranch_vccz gated_mix__softmax_full_mha__mixer_s_mlp__prompt_kernel_pollx59
    s_sub_u32 s5, s5, 1
    s_cmp_eq_u32 s5, 0
    s_cbranch_scc1 gated_mix__softmax_full_mha__mixer_s_mlp__prompt_kernel_pollx59
    s_sleep 4
    s_mov_b64 exec, vcc
    buffer_load_dwordx4 v[140:143], v136, s[16:19], s40 offen sc1
    s_mov_b64 exec, -1
    s_waitcnt vmcnt(0)
    s_branch gated_mix__softmax_full_mha__mixer_s_mlp__prompt_kernel_poll58
gated_mix__softmax_full_mha__mixer_s_mlp__prompt_kernel_pollx59:
    v_mov_b32 v139, 153344
    v_mov_b32 v137, 1
    ds_write_b32 v139, v137
    s_branch gated_mix__softmax_full_mha__mixer_s_mlp__prompt_kernel_gwe56
gated_mix__softmax_full_mha__mixer_s_mlp__prompt_kernel_gw55:
    s_mov_b32 s5, 1600000
gated_mix__softmax_full_mha__mixer_s_mlp__prompt_kernel_gws57:
    s_sleep 1
    ds_read_b32 v137, v139
    s_sub_u32 s5, s5, 1
    s_cmp_eq_u32 s5, 0
    s_cbranch_scc1 gated_mix__softmax_full_mha__mixer_s_mlp__prompt_kernel_gwe56
    s_waitcnt lgkmcnt(0)
    v_cmp_gt_u32 vcc, 1, v137
    s_nop 4
    s_cbranch_vccnz gated_mix__softmax_full_mha__mixer_s_mlp__prompt_kernel_gws57
gated_mix__softmax_full_mha__mixer_s_mlp__prompt_kernel_gwe56:
    s_add_u32 m0, s34, s37
    s_nop 0
    buffer_load_dwordx4 v1, s[8:11], s35 offen offset:0 sc1 lds
    buffer_load_dwordx4 v1, s[8:11], s35 offen offset:1024 sc1 lds
    buffer_load_dwordx4 v1, s[8:11], s35 offen offset:2048 sc1 lds
    buffer_load_dwordx4 v1, s[8:11], s35 offen offset:3072 sc1 lds
    s_add_u32 s35, s35, 16384
    s_cmp_eq_u32 s35, s101
    s_cselect_b32 s3, 32768, 0
    s_add_u32 s35, s35, s3
    s_add_u32 m0, m0, 16384
    s_nop 0
    buffer_load_dwordx4 v1, s[8:11], s35 offen offset:0 sc1 lds
    buffer_load_dwordx4 v1, s[8:11], s35 offen offset:1024 sc1 lds
    buffer_load_dwordx4 v1, s[8:11], s35 offen offset:2048 sc1 lds
    buffer_load_dwordx4 v1, s[8:11], s35 offen offset:3072 sc1 lds
    s_add_u32 s35, s35, 16384
    s_cmp_eq_u32 s35, s101
    s_cselect_b32 s3, 32768, 0
    s_add_u32 s35, s35, s3
    s_add_u32 s34, s34, 49152
    s_cmp_eq_u32 s34, 147456
    s_cselect_b32 s34, 0, s34
    s_lshl_b32 s37, s25, 13
    s_lshl_b32 s38, s25, 12
    s_add_u32 s38, s38, 32768
    s_mov_b32 s36, 0
    s_add_u32 s8, s86, 12582912
    s_addc_u32 s9, s87, 0
    s_mov_b32 s10, 4194304
    s_mov_b32 s11, 0x20000
    s_lshl_b32 s3, s54, 3
    s_lshl_b32 s4, s25, 1
    s_add_u32 s3, s3, s4
    s_mul_i32 s3, s3, 32768
    v_add_u32 v32, s3, v1
    v_add_u32 v36, 32768, v32
    s_mov_b32 s35, 0
    s_mov_b32 s12, s74
    s_mov_b32 s13, s75
    s_mov_b32 s14, 2097152
    s_mov_b32 s15, 0x20000
    v_lshrrev_b32 v128, 3, v0
    v_and_b32 v129, 7, v0
    v_and_b32 v130, 6, v128
    v_xor_b32 v129, v129, v130
    s_lshl_b32 s3, s25, 5
    v_add_u32 v128, s3, v128
    v_lshlrev_b32 v128, 11, v128
    v_lshl_add_u32 v128, v129, 4, v128
    s_lshl_b32 s4, s55, 7
    v_add_u32 v40, s4, v128
    v_add_u32 v41, 15360, v40
    v_add_u32 v42, 30720, v40
    v_add_u32 v43, 46080, v40
    s_lshl_b32 s3, s51, 18
    s_add_u32 s3, s3, 4194304
    s_add_u32 s44, s86, s3
    s_addc_u32 s45, s87, 0
    s_mov_b32 s46, 0x40000
    s_mov_b32 s47, 0x20000
    s_lshl_b32 s4, s25, 10
    s_lshl_b32 s100, s41, 15
    s_add_u32 s100, s100, s4
    s_add_u32 s63, s4, 65536
    s_sub_u32 s3, s63, 32768
    s_cmp_ge_u32 s3, s100
    s_cselect_b32 s63, s63, s3
    s_add_u32 s48, s4, 147456
    s_mov_b32 s42, s34
    s_add_u32 s34, s34, 49152
    s_cmp_eq_u32 s34, 147456
    s_cselect_b32 s34, 0, s34
    s_mov_b32 s43, s34
    s_add_u32 m0, s42, s38
    s_nop 0
    buffer_load_dwordx4 v40, s[12:15], s36 offen offset:0  lds
    buffer_load_dwordx4 v41, s[12:15], s36 offen offset:1024  lds
    buffer_load_dwordx4 v42, s[12:15], s36 offen offset:2048  lds
    buffer_load_dwordx4 v43, s[12:15], s36 offen offset:3072  lds
    s_add_u32 s36, s36, 262144
    s_getpc_b64 s[4:5]
gated_mix__softmax_full_mha__mixer_s_mlp__prompt_kernel_pc60:
    s_sub_u32 s4, s4, gated_mix__softmax_full_mha__mixer_s_mlp__prompt_kernel_pc60-gated_mix__softmax_full_mha__mixer_s_mlp__prompt_kernel
    s_subb_u32 s5, s5, 0
    s_lshl_b32 s3, s28, 11
    s_and_b32 s6, s24, 3
    s_lshl_b32 s6, s6, 9
    s_add_u32 s3, s3, s6
    v_lshl_add_u32 v136, v0, 3, s3
    s_mov_b32 s3, gated_mix__softmax_full_mha__mixer_s_mlp__prompt_kernel_end-gated_mix__softmax_full_mha__mixer_s_mlp__prompt_kernel
    v_min_u32 v136, s3, v136
    s_waitcnt lgkmcnt(0)
    v_mov_b32 v137, s5
    v_add_co_u32 v136, vcc, s4, v136
    s_nop 1
    v_addc_co_u32 v137, vcc, 0, v137, vcc
    global_load_dword v138, v[136:137], off
    s_add_u32 s32, s32, 49152
    s_cmp_eq_u32 s32, 147456
    s_cselect_b32 s33, s39, 49152
    s_cselect_b32 s32, 0, s32
    s_waitcnt vmcnt(5)
    s_barrier
    s_add_u32 m0, s43, s38
    s_nop 0
    buffer_load_dwordx4 v40, s[12:15], s36 offen offset:0  lds
    buffer_load_dwordx4 v41, s[12:15], s36 offen offset:1024  lds
    buffer_load_dwordx4 v42, s[12:15], s36 offen offset:2048  lds
    buffer_load_dwordx4 v43, s[12:15], s36 offen offset:3072  lds
    s_add_u32 s36, s36, 262144
    s_lshr_b32 s3, s42, 3
    s_add_u32 m0, s3, s48
    s_nop 0
    buffer_load_dwordx4 v1, s[44:47], s63 offen sc1 lds
    s_add_u32 s63, s63, 4096
    s_cmp_eq_u32 s63, s100
    s_cselect_b32 s3, 32768, 0
    s_add_u32 s63, s63, s3
    s_lshr_b32 s3, s43, 3
    s_add_u32 m0, s3, s48
    s_nop 0
    buffer_load_dwordx4 v1, s[44:47], s63 offen sc1 lds
    s_add_u32 s63, s63, 4096
    s_cmp_eq_u32 s63, s100
    s_cselect_b32 s3, 32768, 0
    s_add_u32 s63, s63, s3
    s_mov_b32 s20, s76
    s_mov_b32 s21, s77
    s_mov_b32 s22, 7340032
    s_mov_b32 s23, 0x20000
    s_mul_i32 s6, s55, 448
    s_and_b32 s6, s6, 4294967168
    s_lshl_b32 s4, s25, 7
    s_add_u32 s6, s6, s4
    s_lshl_b32 s4, s54, 6
    v_lshrrev_b32 v128, 3, v0
    v_add_u32 v128, s4, v128
    v_mul_u32_u24 v128, 7168, v128
    v_and_b32 v129, 7, v0
    v_lshl_add_u32 v128, v129, 4, v128
    buffer_load_dwordx4 v[176:179], v128, s[20:23], s6 offen
    s_add_u32 s6, s6, 57344
    buffer_load_dwordx4 v[180:183], v128, s[20:23], s6 offen
    s_add_u32 s6, s6, 57344
    buffer_load_dwordx4 v[184:187], v128, s[20:23], s6 offen
    s_add_u32 s6, s6, 57344
    buffer_load_dwordx4 v[188:191], v128, s[20:23], s6 offen
    s_add_u32 s6, s6, 57344
    buffer_load_dwordx4 v[192:195], v128, s[20:23], s6 offen
    s_add_u32 s6, s6, 57344
    buffer_load_dwordx4 v[196:199], v128, s[20:23], s6 offen
    s_add_u32 s6, s6, 57344
    buffer_load_dwordx4 v[200:203], v128, s[20:23], s6 offen
    s_add_u32 s6, s6, 57344
    buffer_load_dwordx4 v[204:207], v128, s[20:23], s6 offen
    s_add_u32 s6, s6, 57344
    v_mov_b32 v139, 153344
    s_cmp_eq_u32 s24, 0
    s_cbranch_scc0 gated_mix__softmax_full_mha__mixer_s_mlp__prompt_kernel_gw61
    s_lshr_b32 s3, s54, 1
    s_and_b32 s4, s54, 1
    s_lshl_b32 s4, s4, 1
    s_add_u32 s4, s4, s3
    s_add_u32 s4, s4, 7
    s_and_b32 s4, s4, 7
    v_mov_b32 v136, s3
    s_waitcnt vmcnt(14)
    v_mov_b32 v138, s4
    v_cmp_gt_u32 vcc, 32, v0
    s_nop 1
    v_cndmask_b32 v138, v138, v136, vcc
    v_and_b32 v136, 31, v0
    v_lshl_add_u32 v136, v138, 5, v136
    v_lshlrev_b32 v136, 7, v136
    s_mov_b32 s40, 45645824
    buffer_load_dwordx4 v[140:143], v136, s[16:19], s40 offen sc1
    s_mov_b32 s5, 100000
gated_mix__softmax_full_mha__mixer_s_mlp__prompt_kernel_poll64:
    s_waitcnt vmcnt(0)
    v_min3_u32 v137, v140, v141, v142
    v_min_u32 v137, v137, v143
    v_cmp_eq_u32 vcc, 0, v137
    s_nop 4
    s_cbranch_vccz gated_mix__softmax_full_mha__mixer_s_mlp__prompt_kernel_pollx65
    s_sub_u32 s5, s5, 1
    s_cmp_eq_u32 s5, 0
    s_cbranch_scc1 gated_mix__softmax_full_mha__mixer_s_mlp__prompt_kernel_pollx65
    s_sleep 4
    s_mov_b64 exec, vcc
    buffer_load_dwordx4 v[140:143], v136, s[16:19], s40 offen sc1
    s_mov_b64 exec, -1
    s_waitcnt vmcnt(0)
    s_branch gated_mix__softmax_full_mha__mixer_s_mlp__prompt_kernel_poll64
gated_mix__softmax_full_mha__mixer_s_mlp__prompt_kernel_pollx65:
    v_mov_b32 v139, 153344
    v_mov_b32 v137, 2
    ds_write_b32 v139, v137
    s_branch gated_mix__softmax_full_mha__mixer_s_mlp__prompt_kernel_gwe62
gated_mix__softmax_full_mha__mixer_s_mlp__prompt_kernel_gw61:
    s_mov_b32 s5, 1600000
gated_mix__softmax_full_mha__mixer_s_mlp__prompt_kernel_gws63:
    s_sleep 1
    ds_read_b32 v137, v139
    s_sub_u32 s5, s5, 1
    s_cmp_eq_u32 s5, 0
    s_cbranch_scc1 gated_mix__softmax_full_mha__mixer_s_mlp__prompt_kernel_gwe62
    s_waitcnt lgkmcnt(0)
    v_cmp_gt_u32 vcc, 2, v137
    s_nop 4
    s_cbranch_vccnz gated_mix__softmax_full_mha__mixer_s_mlp__prompt_kernel_gws63
gated_mix__softmax_full_mha__mixer_s_mlp__prompt_kernel_gwe62:
    s_add_u32 m0, s42, s37
    s_nop 0
    buffer_load_dwordx4 v32, s[8:11], s35 offen offset:0 sc1 lds
    buffer_load_dwordx4 v32, s[8:11], s35 offen offset:1024 sc1 lds
    buffer_load_dwordx4 v32, s[8:11], s35 offen offset:2048 sc1 lds
    buffer_load_dwordx4 v32, s[8:11], s35 offen offset:3072 sc1 lds
    s_add_u32 m0, m0, 4096
    s_nop 0
    buffer_load_dwordx4 v36, s[8:11], s35 offen offset:0 sc1 lds
    buffer_load_dwordx4 v36, s[8:11], s35 offen offset:1024 sc1 lds
    buffer_load_dwordx4 v36, s[8:11], s35 offen offset:2048 sc1 lds
    buffer_load_dwordx4 v36, s[8:11], s35 offen offset:3072 sc1 lds
    s_add_u32 s35, s35, 4096
    s_add_u32 m0, s43, s37
    s_nop 0
    buffer_load_dwordx4 v32, s[8:11], s35 offen offset:0 sc1 lds
    buffer_load_dwordx4 v32, s[8:11], s35 offen offset:1024 sc1 lds
    buffer_load_dwordx4 v32, s[8:11], s35 offen offset:2048 sc1 lds
    buffer_load_dwordx4 v32, s[8:11], s35 offen offset:3072 sc1 lds
    s_add_u32 m0, m0, 4096
    s_nop 0
    buffer_load_dwordx4 v36, s[8:11], s35 offen offset:0 sc1 lds
    buffer_load_dwordx4 v36, s[8:11], s35 offen offset:1024 sc1 lds
    buffer_load_dwordx4 v36, s[8:11], s35 offen offset:2048 sc1 lds
    buffer_load_dwordx4 v36, s[8:11], s35 offen offset:3072 sc1 lds
    s_add_u32 s35, s35, 4096
    s_setprio 0
    s_and_b32 s25, s24, 1
    s_add_u32 s32, s32, 49152
    s_cmp_eq_u32 s32, 147456
    s_cselect_b32 s33, s39, 49152
    s_cselect_b32 s32, 0, s32
    v_and_b32 v128, 15, v0
    v_lshrrev_b32 v129, 4, v0
    v_bfe_u32 v130, v0, 2, 2
    v_and_b32 v131, 3, v0
    s_lshl_b32 s3, s25, 14
    s_add_u32 s3, s3, s32
    v_add_u32 v32, s3, v1
    v_lshl_add_u32 v132, v129, 2, v130
    v_lshlrev_b32 v132, 7, v132
    v_lshrrev_b32 v133, 1, v130
    v_and_b32 v134, 1, v129
    v_lshl_or_b32 v133, v134, 1, v133
    s_lshl_b32 s3, s26, 1
    v_xor_b32 v133, s3, v133
    v_lshl_add_u32 v132, v133, 5, v132
    v_lshl_add_u32 v132, v131, 3, v132
    s_add_u32 s3, s32, 32768
    v_add_u32 v34, s3, v132
    v_xor_b32 v35, 32, v34
    s_waitcnt vmcnt(8)
    s_barrier
    ds_read_b128 v[48:51], v32 offset:0
    ds_read_b128 v[52:55], v32 offset:1024
    ds_read_b64_tr_b16 v[80:81], v34 offset:0
    ds_read_b64_tr_b16 v[82:83], v34 offset:2048
    ds_read_b64_tr_b16 v[84:85], v34 offset:4096
    ds_read_b64_tr_b16 v[86:87], v34 offset:6144
    ds_read_b128 v[56:59], v32 offset:4096
    ds_read_b128 v[60:63], v32 offset:5120
    ds_read_b128 v[64:67], v32 offset:8192
    ds_read_b128 v[68:71], v32 offset:9216
    ds_read_b128 v[72:75], v32 offset:12288
    ds_read_b128 v[76:79], v32 offset:13312
    ds_read_b64_tr_b16 v[88:89], v35 offset:0
    ds_read_b64_tr_b16 v[90:91], v35 offset:2048
    ds_read_b64_tr_b16 v[92:93], v35 offset:4096
    ds_read_b64_tr_b16 v[94:95], v35 offset:6144
    s_mov_b32 s31, 8
    s_waitcnt lgkmcnt(12)
    v_mfma_f32_16x16x32_bf16 v[224:227], v[80:83], v[48:51], 0
    ds_read_b128 v[96:99], v32 offset:2048
    s_waitcnt lgkmcnt(11)
    v_mfma_f32_16x16x32_bf16 v[224:227], v[84:87], v[52:55], v[224:227]
    ds_read_b128 v[100:103], v32 offset:3072
    s_waitcnt lgkmcnt(10)
    v_mfma_f32_16x16x32_bf16 v[228:231], v[84:87], v[60:63], 0
    ds_read_b64_tr_b16 v[128:129], v34 offset:8192
    v_mfma_f32_16x16x32_bf16 v[228:231], v[80:83], v[56:59], v[228:231]
    ds_read_b64_tr_b16 v[130:131], v34 offset:10240
    s_waitcnt lgkmcnt(11)
    v_mfma_f32_16x16x32_bf16 v[232:235], v[80:83], v[64:67], 0
    ds_read_b64_tr_b16 v[132:133], v34 offset:12288
    s_waitcnt lgkmcnt(11)
    v_mfma_f32_16x16x32_bf16 v[232:235], v[84:87], v[68:71], v[232:235]
    ds_read_b64_tr_b16 v[134:135], v34 offset:14336
    s_waitcnt lgkmcnt(10)
    v_mfma_f32_16x16x32_bf16 v[236:239], v[84:87], v[76:79], 0
    ds_read_b128 v[104:107], v32 offset:6144
    v_mfma_f32_16x16x32_bf16 v[236:239], v[80:83], v[72:75], v[236:239]
    ds_read_b128 v[108:111], v32 offset:7168
    s_waitcnt lgkmcnt(10)
    v_mfma_f32_16x16x32_bf16 v[252:255], v[88:91], v[72:75], 0
    ds_read_b128 v[112:115], v32 offset:10240
    s_waitcnt lgkmcnt(9)
    v_mfma_f32_16x16x32_bf16 v[252:255], v[92:95], v[76:79], v[252:255]
    ds_read_b128 v[116:119], v32 offset:11264
    v_mfma_f32_16x16x32_bf16 v[248:251], v[92:95], v[68:71], 0
    ds_read_b128 v[120:123], v32 offset:14336
    v_mfma_f32_16x16x32_bf16 v[248:251], v[88:91], v[64:67], v[248:251]
    ds_read_b128 v[124:127], v32 offset:15360
    v_mfma_f32_16x16x32_bf16 v[244:247], v[88:91], v[56:59], 0
    ds_read_b64_tr_b16 v[136:137], v35 offset:8192
    v_mfma_f32_16x16x32_bf16 v[244:247], v[92:95], v[60:63], v[244:247]
    ds_read_b64_tr_b16 v[138:139], v35 offset:10240
    v_mfma_f32_16x16x32_bf16 v[240:243], v[92:95], v[52:55], 0
    ds_read_b64_tr_b16 v[140:141], v35 offset:12288
    v_mfma_f32_16x16x32_bf16 v[240:243], v[88:91], v[48:51], v[240:243]
    ds_read_b64_tr_b16 v[142:143], v35 offset:14336
    s_branch gated_mix__softmax_full_mha__mixer_s_mlp__prompt_kernel_ge67
    .p2align 5
gated_mix__softmax_full_mha__mixer_s_mlp__prompt_kernel_gl66:
    s_waitcnt lgkmcnt(12)
    v_mfma_f32_16x16x32_bf16 v[224:227], v[80:83], v[48:51], v[224:227]
    ds_read_b128 v[96:99], v32 offset:2048
    s_waitcnt lgkmcnt(11)
    v_mfma_f32_16x16x32_bf16 v[224:227], v[84:87], v[52:55], v[224:227]
    ds_read_b128 v[100:103], v32 offset:3072
    s_waitcnt lgkmcnt(10)
    v_mfma_f32_16x16x32_bf16 v[228:231], v[84:87], v[60:63], v[228:231]
    ds_read_b64_tr_b16 v[128:129], v34 offset:8192
    v_mfma_f32_16x16x32_bf16 v[228:231], v[80:83], v[56:59], v[228:231]
    ds_read_b64_tr_b16 v[130:131], v34 offset:10240
    s_waitcnt lgkmcnt(11)
    v_mfma_f32_16x16x32_bf16 v[232:235], v[80:83], v[64:67], v[232:235]
    ds_read_b64_tr_b16 v[132:133], v34 offset:12288
    s_waitcnt lgkmcnt(11)
    v_mfma_f32_16x16x32_bf16 v[232:235], v[84:87], v[68:71], v[232:235]
    ds_read_b64_tr_b16 v[134:135], v34 offset:14336
    s_waitcnt lgkmcnt(10)
    v_mfma_f32_16x16x32_bf16 v[236:239], v[84:87], v[76:79], v[236:239]
    ds_read_b128 v[104:107], v32 offset:6144
    v_mfma_f32_16x16x32_bf16 v[236:239], v[80:83], v[72:75], v[236:239]
    ds_read_b128 v[108:111], v32 offset:7168
    s_waitcnt lgkmcnt(10)
    v_mfma_f32_16x16x32_bf16 v[252:255], v[88:91], v[72:75], v[252:255]
    ds_read_b128 v[112:115], v32 offset:10240
    s_waitcnt lgkmcnt(9)
    v_mfma_f32_16x16x32_bf16 v[252:255], v[92:95], v[76:79], v[252:255]
    ds_read_b128 v[116:119], v32 offset:11264
    v_mfma_f32_16x16x32_bf16 v[248:251], v[92:95], v[68:71], v[248:251]
    ds_read_b128 v[120:123], v32 offset:14336
    v_mfma_f32_16x16x32_bf16 v[248:251], v[88:91], v[64:67], v[248:251]
    ds_read_b128 v[124:127], v32 offset:15360
    v_mfma_f32_16x16x32_bf16 v[244:247], v[88:91], v[56:59], v[244:247]
    ds_read_b64_tr_b16 v[136:137], v35 offset:8192
    v_mfma_f32_16x16x32_bf16 v[244:247], v[92:95], v[60:63], v[244:247]
    ds_read_b64_tr_b16 v[138:139], v35 offset:10240
    v_mfma_f32_16x16x32_bf16 v[240:243], v[92:95], v[52:55], v[240:243]
    ds_read_b64_tr_b16 v[140:141], v35 offset:12288
    v_mfma_f32_16x16x32_bf16 v[240:243], v[88:91], v[48:51], v[240:243]
    ds_read_b64_tr_b16 v[142:143], v35 offset:14336
gated_mix__softmax_full_mha__mixer_s_mlp__prompt_kernel_ge67:
    s_waitcnt lgkmcnt(12)
    v_mfma_f32_16x16x32_bf16 v[224:227], v[128:131], v[96:99], v[224:227]
    s_add_u32 s32, s32, 49152
    s_waitcnt lgkmcnt(10)
    v_mfma_f32_16x16x32_bf16 v[224:227], v[132:135], v[100:103], v[224:227]
    s_cmp_eq_u32 s32, 147456
    s_cselect_b32 s33, s39, 49152
    s_waitcnt lgkmcnt(8)
    v_mfma_f32_16x16x32_bf16 v[228:231], v[132:135], v[108:111], v[228:231]
    s_cselect_b32 s32, 0, s32
    v_add_u32 v32, s33, v32
    v_mfma_f32_16x16x32_bf16 v[228:231], v[128:131], v[104:107], v[228:231]
    v_add_u32 v34, s33, v34
    v_add_u32 v35, s33, v35
    s_waitcnt vmcnt(0) lgkmcnt(0)
    s_barrier
    v_mfma_f32_16x16x32_bf16 v[232:235], v[128:131], v[112:115], v[232:235]
    ds_read_b128 v[48:51], v32 offset:0
    ds_read_b128 v[52:55], v32 offset:1024
    v_mfma_f32_16x16x32_bf16 v[232:235], v[132:135], v[116:119], v[232:235]
    ds_read_b64_tr_b16 v[80:81], v34 offset:0
    ds_read_b64_tr_b16 v[82:83], v34 offset:2048
    v_mfma_f32_16x16x32_bf16 v[236:239], v[132:135], v[124:127], v[236:239]
    ds_read_b64_tr_b16 v[84:85], v34 offset:4096
    ds_read_b64_tr_b16 v[86:87], v34 offset:6144
    v_mfma_f32_16x16x32_bf16 v[236:239], v[128:131], v[120:123], v[236:239]
    ds_read_b128 v[56:59], v32 offset:4096
    ds_read_b128 v[60:63], v32 offset:5120
    v_mfma_f32_16x16x32_bf16 v[252:255], v[136:139], v[120:123], v[252:255]
    ds_read_b128 v[64:67], v32 offset:8192
    ds_read_b128 v[68:71], v32 offset:9216
    v_mfma_f32_16x16x32_bf16 v[252:255], v[140:143], v[124:127], v[252:255]
    ds_read_b128 v[72:75], v32 offset:12288
    ds_read_b128 v[76:79], v32 offset:13312
    v_mfma_f32_16x16x32_bf16 v[248:251], v[140:143], v[116:119], v[248:251]
    ds_read_b64_tr_b16 v[88:89], v35 offset:0
    ds_read_b64_tr_b16 v[90:91], v35 offset:2048
    v_mfma_f32_16x16x32_bf16 v[248:251], v[136:139], v[112:115], v[248:251]
    ds_read_b64_tr_b16 v[92:93], v35 offset:4096
    ds_read_b64_tr_b16 v[94:95], v35 offset:6144
    v_mfma_f32_16x16x32_bf16 v[244:247], v[136:139], v[104:107], v[244:247]
    s_sub_u32 s31, s31, 1
    s_bitcmp1_b32 0xfe, s31
    v_mfma_f32_16x16x32_bf16 v[244:247], v[140:143], v[108:111], v[244:247]
    v_mfma_f32_16x16x32_bf16 v[240:243], v[140:143], v[100:103], v[240:243]
    v_mfma_f32_16x16x32_bf16 v[240:243], v[136:139], v[96:99], v[240:243]
    s_cbranch_scc1 gated_mix__softmax_full_mha__mixer_s_mlp__prompt_kernel_gl66
    s_setprio 2
    v_and_b32 v8, 15, v0
    v_and_b32 v9, 1, v0
    v_lshlrev_b32 v9, 4, v9
    v_mov_b32 v10, 0x3f80
    v_lshlrev_b32 v9, v9, v10
    v_lshrrev_b32 v8, 1, v8
    v_cmp_eq_u32 vcc, 0, v8
    s_nop 1
    v_cndmask_b32 v12, 0, v9, vcc
    v_cmp_eq_u32 vcc, 1, v8
    s_nop 1
    v_cndmask_b32 v13, 0, v9, vcc
    v_cmp_eq_u32 vcc, 2, v8
    s_nop 1
    v_cndmask_b32 v14, 0, v9, vcc
    v_cmp_eq_u32 vcc, 3, v8
    s_nop 1
    v_cndmask_b32 v15, 0, v9, vcc
    s_nop 1
    v_mfma_f32_16x16x32_bf16 v[16:19], v[12:15], v[176:179], 0
    v_mfma_f32_16x16x32_bf16 v[16:19], v[12:15], v[180:183], v[16:19]
    v_mfma_f32_16x16x32_bf16 v[16:19], v[12:15], v[184:187], v[16:19]
    v_mfma_f32_16x16x32_bf16 v[16:19], v[12:15], v[188:191], v[16:19]
    v_mfma_f32_16x16x32_bf16 v[16:19], v[12:15], v[192:195], v[16:19]
    v_mfma_f32_16x16x32_bf16 v[16:19], v[12:15], v[196:199], v[16:19]
    v_mfma_f32_16x16x32_bf16 v[16:19], v[12:15], v[200:203], v[16:19]
    v_mfma_f32_16x16x32_bf16 v[16:19], v[12:15], v[204:207], v[16:19]
    s_waitcnt lgkmcnt(0)
    s_lshl_b32 s3, s55, 1
    s_add_u32 s3, s3, s26
    s_lshl_b32 s4, s54, 3
    s_lshl_b32 s5, s25, 2
    s_add_u32 s4, s4, s5
    s_lshl_b32 s42, s4, 15
    s_lshl_b32 s5, s3, 10
    s_add_u32 s42, s42, s5
    s_add_u32 s42, s42, 16777216
    s_lshl_b32 s43, s3, 14
    s_lshl_b32 s5, s4, 7
    s_add_u32 s43, s43, s5
    s_add_u32 s43, s43, 44040192
    v_and_b32 v128, 15, v0
    v_lshrrev_b32 v129, 4, v0
    v_lshrrev_b32 v130, 1, v128
    v_lshrrev_b32 v131, 1, v129
    v_xor_b32 v130, v130, v131
    s_lshl_b32 s3, s26, 2
    v_xor_b32 v130, s3, v130
    v_lshlrev_b32 v130, 4, v130
    v_lshl_or_b32 v130, v128, 7, v130
    v_and_b32 v131, 1, v129
    v_lshl_or_b32 v130, v131, 3, v130
    s_lshl_b32 s3, s25, 13
    s_add_u32 s3, s3, s32
    v_add_u32 v37, s3, v130
    v_xor_b32 v38, 32, v37
    ds_read_b64 v[160:161], v37 offset:32768
    ds_read_b64 v[162:163], v38 offset:32768
    ds_read_b64 v[164:165], v37 offset:34816
    ds_read_b64 v[166:167], v38 offset:34816
    ds_read_b64 v[168:169], v37 offset:36864
    ds_read_b64 v[170:171], v38 offset:36864
    ds_read_b64 v[172:173], v37 offset:38912
    ds_read_b64 v[174:175], v38 offset:38912
    s_waitcnt lgkmcnt(7)
    v_lshlrev_b32 v48, 16, v160
    v_and_b32 v49, 0xffff0000, v160
    v_pk_add_f32 v[224:225], v[224:225], v[48:49]
    v_lshlrev_b32 v48, 16, v161
    v_and_b32 v49, 0xffff0000, v161
    v_pk_add_f32 v[226:227], v[226:227], v[48:49]
    s_waitcnt lgkmcnt(6)
    v_lshlrev_b32 v48, 16, v162
    v_and_b32 v49, 0xffff0000, v162
    v_pk_add_f32 v[240:241], v[240:241], v[48:49]
    v_lshlrev_b32 v48, 16, v163
    v_and_b32 v49, 0xffff0000, v163
    v_pk_add_f32 v[242:243], v[242:243], v[48:49]
    v_cvt_pk_bf16_f32 v72, v224, v225
    v_cvt_pk_bf16_f32 v73, v226, v227
    v_cvt_pk_bf16_f32 v74, v240, v241
    v_cvt_pk_bf16_f32 v75, v242, v243
    buffer_store_dwordx4 v[72:75], v1, s[16:19], s42 offen sc1
    s_add_u32 s42, s42, 32768
    v_pk_add_f32 v[50:51], v[224:225], v[226:227]
    v_pk_mul_f32 v[52:53], v[224:225], v[224:225]
    v_pk_add_f32 v[50:51], v[50:51], v[240:241]
    v_pk_fma_f32 v[52:53], v[226:227], v[226:227], v[52:53]
    v_pk_add_f32 v[50:51], v[50:51], v[242:243]
    v_pk_fma_f32 v[52:53], v[240:241], v[240:241], v[52:53]
    v_pk_fma_f32 v[52:53], v[242:243], v[242:243], v[52:53]
    v_add_f32 v56, v50, v51
    v_add_f32 v57, v52, v53
    s_waitcnt lgkmcnt(5)
    v_lshlrev_b32 v48, 16, v164
    v_and_b32 v49, 0xffff0000, v164
    v_pk_add_f32 v[228:229], v[228:229], v[48:49]
    v_lshlrev_b32 v48, 16, v165
    v_and_b32 v49, 0xffff0000, v165
    v_pk_add_f32 v[230:231], v[230:231], v[48:49]
    s_waitcnt lgkmcnt(4)
    v_lshlrev_b32 v48, 16, v166
    v_and_b32 v49, 0xffff0000, v166
    v_pk_add_f32 v[244:245], v[244:245], v[48:49]
    v_lshlrev_b32 v48, 16, v167
    v_and_b32 v49, 0xffff0000, v167
    v_pk_add_f32 v[246:247], v[246:247], v[48:49]
    v_cvt_pk_bf16_f32 v76, v228, v229
    v_cvt_pk_bf16_f32 v77, v230, v231
    v_cvt_pk_bf16_f32 v78, v244, v245
    v_cvt_pk_bf16_f32 v79, v246, v247
    buffer_store_dwordx4 v[76:79], v1, s[16:19], s42 offen sc1
    s_add_u32 s42, s42, 32768
    v_pk_add_f32 v[50:51], v[228:229], v[230:231]
    v_pk_mul_f32 v[52:53], v[228:229], v[228:229]
    v_pk_add_f32 v[50:51], v[50:51], v[244:245]
    v_pk_fma_f32 v[52:53], v[230:231], v[230:231], v[52:53]
    v_pk_add_f32 v[50:51], v[50:51], v[246:247]
    v_pk_fma_f32 v[52:53], v[244:245], v[244:245], v[52:53]
    v_pk_fma_f32 v[52:53], v[246:247], v[246:247], v[52:53]
    v_add_f32 v58, v50, v51
    v_add_f32 v59, v52, v53
    s_waitcnt lgkmcnt(3)
    v_lshlrev_b32 v48, 16, v168
    v_and_b32 v49, 0xffff0000, v168
    v_pk_add_f32 v[232:233], v[232:233], v[48:49]
    v_lshlrev_b32 v48, 16, v169
    v_and_b32 v49, 0xffff0000, v169
    v_pk_add_f32 v[234:235], v[234:235], v[48:49]
    s_waitcnt lgkmcnt(2)
    v_lshlrev_b32 v48, 16, v170
    v_and_b32 v49, 0xffff0000, v170
    v_pk_add_f32 v[248:249], v[248:249], v[48:49]
    v_lshlrev_b32 v48, 16, v171
    v_and_b32 v49, 0xffff0000, v171
    v_pk_add_f32 v[250:251], v[250:251], v[48:49]
    v_cvt_pk_bf16_f32 v80, v232, v233
    v_cvt_pk_bf16_f32 v81, v234, v235
    v_cvt_pk_bf16_f32 v82, v248, v249
    v_cvt_pk_bf16_f32 v83, v250, v251
    buffer_store_dwordx4 v[80:83], v1, s[16:19], s42 offen sc1
    s_add_u32 s42, s42, 32768
    v_pk_add_f32 v[50:51], v[232:233], v[234:235]
    v_pk_mul_f32 v[52:53], v[232:233], v[232:233]
    v_pk_add_f32 v[50:51], v[50:51], v[248:249]
    v_pk_fma_f32 v[52:53], v[234:235], v[234:235], v[52:53]
    v_pk_add_f32 v[50:51], v[50:51], v[250:251]
    v_pk_fma_f32 v[52:53], v[248:249], v[248:249], v[52:53]
    v_pk_fma_f32 v[52:53], v[250:251], v[250:251], v[52:53]
    v_add_f32 v60, v50, v51
    v_add_f32 v61, v52, v53
    s_waitcnt lgkmcnt(1)
    v_lshlrev_b32 v48, 16, v172
    v_and_b32 v49, 0xffff0000, v172
    v_pk_add_f32 v[236:237], v[236:237], v[48:49]
    v_lshlrev_b32 v48, 16, v173
    v_and_b32 v49, 0xffff0000, v173
    v_pk_add_f32 v[238:239], v[238:239], v[48:49]
    s_waitcnt lgkmcnt(0)
    v_lshlrev_b32 v48, 16, v174
    v_and_b32 v49, 0xffff0000, v174
    v_pk_add_f32 v[252:253], v[252:253], v[48:49]
    v_lshlrev_b32 v48, 16, v175
    v_and_b32 v49, 0xffff0000, v175
    v_pk_add_f32 v[254:255], v[254:255], v[48:49]
    v_cvt_pk_bf16_f32 v84, v236, v237
    v_cvt_pk_bf16_f32 v85, v238, v239
    v_cvt_pk_bf16_f32 v86, v252, v253
    v_cvt_pk_bf16_f32 v87, v254, v255
    buffer_store_dwordx4 v[84:87], v1, s[16:19], s42 offen sc1
    v_pk_add_f32 v[50:51], v[236:237], v[238:239]
    v_pk_mul_f32 v[52:53], v[236:237], v[236:237]
    v_pk_add_f32 v[50:51], v[50:51], v[252:253]
    v_pk_fma_f32 v[52:53], v[238:239], v[238:239], v[52:53]
    v_pk_add_f32 v[50:51], v[50:51], v[254:255]
    v_pk_fma_f32 v[52:53], v[252:253], v[252:253], v[52:53]
    v_pk_fma_f32 v[52:53], v[254:255], v[254:255], v[52:53]
    v_add_f32 v62, v50, v51
    v_add_f32 v63, v52, v53
    v_permlane32_swap_b32 v56, v60
    v_permlane32_swap_b32 v57, v61
    v_permlane32_swap_b32 v58, v62
    v_permlane32_swap_b32 v59, v63
    v_add_f32 v56, v56, v60
    v_add_f32 v57, v57, v61
    v_add_f32 v58, v58, v62
    v_add_f32 v59, v59, v63
    s_nop 0
    v_permlane16_swap_b32 v56, v58
    v_permlane16_swap_b32 v57, v59
    v_add_f32 v56, v56, v58
    v_add_f32 v57, v57, v59
    v_lshlrev_b32 v36, 3, v0
    buffer_store_dwordx2 v[56:57], v36, s[16:19], s43 offen sc1
    v_add_f32_dpp v16, v16, v16 row_ror:8 row_mask:0xf bank_mask:0xf
    v_add_f32_dpp v17, v17, v17 row_ror:8 row_mask:0xf bank_mask:0xf
    v_add_f32_dpp v18, v18, v18 row_ror:8 row_mask:0xf bank_mask:0xf
    v_add_f32_dpp v19, v19, v19 row_ror:8 row_mask:0xf bank_mask:0xf
    v_and_b32 v8, 7, v0
    v_lshrrev_b32 v9, 4, v0
    v_lshlrev_b32 v8, 5, v8
    v_lshl_add_u32 v8, v9, 4, v8
    s_lshl_b32 s3, s55, 4
    s_add_u32 s3, s3, s54
    s_lshl_b32 s3, s3, 2
    s_add_u32 s3, s3, s24
    s_lshl_b32 s3, s3, 8
    s_add_u32 s3, s3, 45088768
    s_mov_b32 exec_lo, 0x00ff00ff
    s_mov_b32 exec_hi, 0
    buffer_store_dwordx4 v[16:19], v8, s[16:19], s3 offen sc1
    s_mov_b64 exec, -1
    s_mov_b32 s25, s24
    s_mov_b32 s43, s32
    s_waitcnt lgkmcnt(0)
    v_mov_b32 v136, 153352
    v_mov_b32 v137, 1
    s_mov_b64 exec, 1
    ds_add_u32 v136, v137
    s_mov_b64 exec, -1
    s_add_u32 s32, s32, 49152
    s_cmp_eq_u32 s32, 147456
    s_cselect_b32 s33, s39, 49152
    s_cselect_b32 s32, 0, s32
    s_mov_b32 s34, s32
    s_add_u32 s32, s32, 49152
    s_cmp_eq_u32 s32, 147456
    s_cselect_b32 s33, s39, 49152
    s_cselect_b32 s32, 0, s32
    s_mov_b32 s42, s32
    s_add_u32 s8, s86, 16777216
    s_addc_u32 s9, s87, 0
    s_mov_b32 s10, 4194304
    s_mov_b32 s11, 0x20000
    s_mov_b32 s12, s76
    s_mov_b32 s13, s77
    s_mov_b32 s14, 7340032
    s_mov_b32 s15, 0x20000
    s_lshl_b32 s3, s29, 3
    s_lshl_b32 s4, s25, 1
    s_add_u32 s3, s3, s4
    s_lshl_b32 s3, s3, 15
    v_add_u32 v32, s3, v1
    v_add_u32 v34, 30720, v32
    s_mul_i32 s4, s30, 448
    s_and_b32 s4, s4, 4294967168
    s_mul_i32 s3, s25, 114688
    s_add_u32 s4, s4, s3
    v_lshrrev_b32 v128, 5, v0
    v_and_b32 v129, 31, v0
    v_mul_u32_u24 v130, 7168, v128
    v_add_u32 v130, s4, v130
    s_bitcmp1_b32 s30, 0
    s_cselect_b32 s5, 0, 7
    v_mov_b32 v133, 0x40000000
    v_lshlrev_b32 v128, 1, v128
    v_xor_b32 v129, v129, v128
    v_xor_b32 v131, 0, v129
    v_lshrrev_b32 v132, 2, v131
    v_lshl_add_u32 v131, v131, 4, v130
    v_cmp_eq_u32 vcc, s5, v132
    s_nop 1
    v_cndmask_b32 v131, v131, v133, vcc
    v_add_u32 v36, 0, v131
    v_add_u32 v40, 57344, v131
    v_xor_b32 v131, 4, v129
    v_lshrrev_b32 v132, 2, v131
    v_lshl_add_u32 v131, v131, 4, v130
    v_cmp_eq_u32 vcc, s5, v132
    s_nop 1
    v_cndmask_b32 v131, v131, v133, vcc
    v_add_u32 v37, 13312, v131
    v_add_u32 v41, 70656, v131
    v_xor_b32 v131, 8, v129
    v_lshrrev_b32 v132, 2, v131
    v_lshl_add_u32 v131, v131, 4, v130
    v_cmp_eq_u32 vcc, s5, v132
    s_nop 1
    v_cndmask_b32 v131, v131, v133, vcc
    v_add_u32 v38, 26624, v131
    v_add_u32 v42, 83968, v131
    v_xor_b32 v131, 12, v129
    v_lshrrev_b32 v132, 2, v131
    v_lshl_add_u32 v131, v131, 4, v130
    v_cmp_eq_u32 vcc, s5, v132
    s_nop 1
    v_cndmask_b32 v131, v131, v133, vcc
    v_add_u32 v39, 39936, v131
    v_add_u32 v43, 97280, v131
    s_lshl_b32 s37, s25, 12
    s_lshl_b32 s38, s25, 13
    s_add_u32 s38, s38, 16384
    s_mov_b32 s35, 0
    s_mov_b32 s36, 0
    s_waitcnt vmcnt(0)
    v_mov_b32 v136, 153364
    v_mov_b32 v137, 1
    s_mov_b64 exec, 1
    ds_add_rtn_u32 v136, v136, v137
    s_mov_b64 exec, -1
    s_waitcnt lgkmcnt(0)
    v_readfirstlane_b32 s3, v136
    s_nop 1
    s_and_b32 s3, s3, 3
    s_cmp_eq_u32 s3, 3
    s_cselect_b32 s3, s90, 62914560
    v_lshlrev_b32 v136, 2, v0
    s_mov_b64 exec, 15
    buffer_store_dword v137, v136, s[16:19], s3 offen sc1
    s_mov_b64 exec, -1
    s_add_u32 m0, s42, s38
    s_nop 0
    buffer_load_dwordx4 v36, s[12:15], s36 offen offset:0  lds
    buffer_load_dwordx4 v37, s[12:15], s36 offen offset:1024  lds
    buffer_load_dwordx4 v38, s[12:15], s36 offen offset:2048  lds
    buffer_load_dwordx4 v39, s[12:15], s36 offen offset:3072  lds
    s_add_u32 m0, m0, 4096
    s_nop 0
    buffer_load_dwordx4 v40, s[12:15], s36 offen offset:0  lds
    buffer_load_dwordx4 v41, s[12:15], s36 offen offset:1024  lds
    buffer_load_dwordx4 v42, s[12:15], s36 offen offset:2048  lds
    buffer_load_dwordx4 v43, s[12:15], s36 offen offset:3072  lds
    s_add_u32 s36, s36, 458752
    s_lshl_b32 s3, s2, 2
    s_and_b32 s4, s24, 3
    s_add_u32 s3, s3, s4
    s_mov_b32 m0, 158720
    s_mov_b32 s20, s78
    s_mov_b32 s21, s79
    s_mov_b32 s22, 7340032
    s_mov_b32 s23, 0x20000
    s_mul_i32 s5, s3, 5120
    buffer_load_dwordx4 v1, s[20:23], s5 offen  lds
    s_add_u32 s5, s5, 1024
    buffer_load_dwordx4 v1, s[20:23], s5 offen  lds
    s_add_u32 s5, s5, 1024
    buffer_load_dwordx4 v1, s[20:23], s5 offen  lds
    s_add_u32 s5, s5, 1024
    buffer_load_dwordx4 v1, s[20:23], s5 offen  lds
    s_add_u32 s5, s5, 1024
    buffer_load_dwordx4 v1, s[20:23], s5 offen  lds
    s_getpc_b64 s[4:5]
gated_mix__softmax_full_mha__mixer_s_mlp__prompt_kernel_pc69:
    s_sub_u32 s4, s4, gated_mix__softmax_full_mha__mixer_s_mlp__prompt_kernel_pc69-gated_mix__softmax_full_mha__mixer_s_mlp__prompt_kernel
    s_subb_u32 s5, s5, 0
    s_lshl_b32 s3, s28, 11
    s_and_b32 s6, s24, 3
    s_lshl_b32 s6, s6, 9
    s_add_u32 s3, s3, s6
    v_lshl_add_u32 v136, v0, 3, s3
    s_mov_b32 s3, gated_mix__softmax_full_mha__mixer_s_mlp__prompt_kernel_end-gated_mix__softmax_full_mha__mixer_s_mlp__prompt_kernel
    v_min_u32 v136, s3, v136
    v_mov_b32 v137, s5
    v_add_co_u32 v136, vcc, s4, v136
    s_nop 1
    v_addc_co_u32 v137, vcc, 0, v137, vcc
    global_load_dword v138, v[136:137], off
    v_mov_b32 v139, 153344
    s_cmp_eq_u32 s24, 0
    s_cbranch_scc0 gated_mix__softmax_full_mha__mixer_s_mlp__prompt_kernel_gw70
    v_and_b32 v136, 15, v0
    s_waitcnt vmcnt(0)
    v_and_b32 v138, 15, v0
    v_lshl_add_u32 v138, v138, 4, s30
    s_lshr_b32 s3, s29, 0
    s_lshl_b32 s3, s3, 4
    v_add_u32 v136, s3, v136
    v_cmp_gt_u32 vcc, 32, v0
    s_nop 1
    v_cndmask_b32 v136, v138, v136, vcc
    v_lshlrev_b32 v136, 7, v136
    s_mov_b32 s40, 45678592
    buffer_load_dwordx4 v[140:143], v136, s[16:19], s40 offen sc1
    s_mov_b32 s5, 100000
gated_mix__softmax_full_mha__mixer_s_mlp__prompt_kernel_poll73:
    s_waitcnt vmcnt(0)
    v_min3_u32 v137, v140, v141, v142
    v_min_u32 v137, v137, v143
    v_cmp_eq_u32 vcc, 0, v137
    s_nop 4
    s_cbranch_vccz gated_mix__softmax_full_mha__mixer_s_mlp__prompt_kernel_pollx74
    s_sub_u32 s5, s5, 1
    s_cmp_eq_u32 s5, 0
    s_cbranch_scc1 gated_mix__softmax_full_mha__mixer_s_mlp__prompt_kernel_pollx74
    s_sleep 4
    s_mov_b64 exec, vcc
    buffer_load_dwordx4 v[140:143], v136, s[16:19], s40 offen sc1
    s_mov_b64 exec, -1
    s_waitcnt vmcnt(0)
    s_branch gated_mix__softmax_full_mha__mixer_s_mlp__prompt_kernel_poll73
gated_mix__softmax_full_mha__mixer_s_mlp__prompt_kernel_pollx74:
    v_mov_b32 v139, 153344
    v_mov_b32 v137, 3
    ds_write_b32 v139, v137
    s_branch gated_mix__softmax_full_mha__mixer_s_mlp__prompt_kernel_gwe71
gated_mix__softmax_full_mha__mixer_s_mlp__prompt_kernel_gw70:
    s_mov_b32 s5, 1600000
gated_mix__softmax_full_mha__mixer_s_mlp__prompt_kernel_gws72:
    s_sleep 1
    ds_read_b32 v137, v139
    s_sub_u32 s5, s5, 1
    s_cmp_eq_u32 s5, 0
    s_cbranch_scc1 gated_mix__softmax_full_mha__mixer_s_mlp__prompt_kernel_gwe71
    s_waitcnt lgkmcnt(0)
    v_cmp_gt_u32 vcc, 3, v137
    s_nop 4
    s_cbranch_vccnz gated_mix__softmax_full_mha__mixer_s_mlp__prompt_kernel_gws72
gated_mix__softmax_full_mha__mixer_s_mlp__prompt_kernel_gwe71:
    v_and_b32 v60, 15, v0
    v_lshrrev_b32 v61, 4, v0
    v_lshlrev_b32 v60, 4, v60
    v_lshl_add_u32 v62, v61, 10, v60
    v_lshl_add_u32 v63, v61, 17, v60
    v_lshlrev_b32 v60, 2, v0
    s_lshl_b32 s4, s25, 8
    s_lshl_b32 s53, s30, 14
    s_add_u32 s53, s53, s4
    s_add_u32 s53, s53, 45088768
    s_lshl_b32 s49, s29, 10
    s_add_u32 s50, s49, s4
    s_add_u32 s49, s49, s53
    s_lshl_b32 s3, s50, 1
    s_add_u32 s3, s3, 42991628
    s_add_u32 s50, s50, 44040192
    buffer_load_dword v96, v1, s[16:19], s3 offen sc1
    buffer_load_dwordx4 v[64:67], v63, s[16:19], s50 offen sc1
    s_add_u32 s50, s50, 16384
    buffer_load_dwordx4 v[68:71], v63, s[16:19], s50 offen sc1
    s_add_u32 s50, s50, 16384
    buffer_load_dwordx4 v[72:75], v63, s[16:19], s50 offen sc1
    s_add_u32 s50, s50, 16384
    buffer_load_dwordx4 v[76:79], v63, s[16:19], s50 offen sc1
    s_add_u32 s50, s50, 16384
    buffer_load_dwordx4 v[80:83], v63, s[16:19], s50 offen sc1
    s_add_u32 s50, s50, 16384
    buffer_load_dwordx4 v[84:87], v63, s[16:19], s50 offen sc1
    s_add_u32 s50, s50, 16384
    buffer_load_dwordx4 v[88:91], v63, s[16:19], s50 offen sc1
    s_add_u32 s50, s50, 16384
    buffer_load_dwordx4 v[92:95], v63, s[16:19], s50 offen sc1
    s_add_u32 s50, s50, 16384
    buffer_load_dwordx4 v[160:163], v62, s[16:19], s53 offen sc1
    s_add_u32 s53, s53, 4096
    buffer_load_dwordx4 v[164:167], v62, s[16:19], s53 offen sc1
    s_add_u32 s53, s53, 4096
    buffer_load_dwordx4 v[168:171], v62, s[16:19], s53 offen sc1
    s_add_u32 s53, s53, 4096
    buffer_load_dwordx4 v[172:175], v62, s[16:19], s53 offen sc1
    s_add_u32 s53, s53, 4096
    s_add_u32 m0, s42, s37
    s_nop 0
    buffer_load_dwordx4 v32, s[8:11], s35 offen offset:0 sc1 lds
    buffer_load_dwordx4 v32, s[8:11], s35 offen offset:1024 sc1 lds
    buffer_load_dwordx4 v34, s[8:11], s35 offen offset:2048 sc1 lds
    buffer_load_dwordx4 v34, s[8:11], s35 offen offset:3072 sc1 lds
    s_add_u32 s35, s35, 2048
    v_mov_b32 v139, 153352
    s_mov_b32 s5, 1600000
gated_mix__softmax_full_mha__mixer_s_mlp__prompt_kernel_fr75:
    s_waitcnt lgkmcnt(0)
    ds_read_b32 v137, v139
    s_sub_u32 s5, s5, 1
    s_cmp_eq_u32 s5, 0
    s_cbranch_scc1 gated_mix__softmax_full_mha__mixer_s_mlp__prompt_kernel_fre76
    s_waitcnt lgkmcnt(0)
    v_cmp_gt_u32 vcc, 8, v137
    s_nop 4
    s_cbranch_vccz gated_mix__softmax_full_mha__mixer_s_mlp__prompt_kernel_fre76
    s_sleep 2
    s_branch gated_mix__softmax_full_mha__mixer_s_mlp__prompt_kernel_fr75
gated_mix__softmax_full_mha__mixer_s_mlp__prompt_kernel_fre76:
    s_add_u32 m0, s43, s38
    s_nop 0
    buffer_load_dwordx4 v36, s[12:15], s36 offen offset:0  lds
    buffer_load_dwordx4 v37, s[12:15], s36 offen offset:1024  lds
    buffer_load_dwordx4 v38, s[12:15], s36 offen offset:2048  lds
    buffer_load_dwordx4 v39, s[12:15], s36 offen offset:3072  lds
    s_add_u32 m0, m0, 4096
    s_nop 0
    buffer_load_dwordx4 v40, s[12:15], s36 offen offset:0  lds
    buffer_load_dwordx4 v41, s[12:15], s36 offen offset:1024  lds
    buffer_load_dwordx4 v42, s[12:15], s36 offen offset:2048  lds
    buffer_load_dwordx4 v43, s[12:15], s36 offen offset:3072  lds
    s_add_u32 s36, s36, 458752
    s_add_u32 m0, s43, s37
    s_nop 0
    buffer_load_dwordx4 v32, s[8:11], s35 offen offset:0 sc1 lds
    buffer_load_dwordx4 v32, s[8:11], s35 offen offset:1024 sc1 lds
    buffer_load_dwordx4 v34, s[8:11], s35 offen offset:2048 sc1 lds
    buffer_load_dwordx4 v34, s[8:11], s35 offen offset:3072 sc1 lds
    s_add_u32 s35, s35, 2048
    s_lshl_b32 s3, s2, 2
    s_and_b32 s4, s24, 3
    s_add_u32 s3, s3, s4
    s_mov_b32 m0, 158720
    s_mov_b32 s20, s78
    s_mov_b32 s21, s79
    s_mov_b32 s22, 7340032
    s_mov_b32 s23, 0x20000
    s_mul_i32 s5, s3, 2048
    s_add_u32 s5, s5, 5242880
    buffer_load_dwordx4 v[4:7], v1, s[20:23], s5 offen
    s_add_u32 s5, s5, 1024
    buffer_load_dwordx4 v[8:11], v1, s[20:23], s5 offen
    s_setprio 0
    s_waitcnt vmcnt(25)
    v_add_f32 v64, v64, v80
    v_add_f32 v65, v65, v81
    v_add_f32 v66, v66, v82
    v_add_f32 v67, v67, v83
    s_waitcnt vmcnt(24)
    v_add_f32 v68, v68, v84
    v_add_f32 v69, v69, v85
    v_add_f32 v70, v70, v86
    v_add_f32 v71, v71, v87
    s_waitcnt vmcnt(23)
    v_add_f32 v72, v72, v88
    v_add_f32 v73, v73, v89
    v_add_f32 v74, v74, v90
    v_add_f32 v75, v75, v91
    s_waitcnt vmcnt(22)
    v_add_f32 v76, v76, v92
    v_add_f32 v77, v77, v93
    v_add_f32 v78, v78, v94
    v_add_f32 v79, v79, v95
    v_add_f32 v64, v64, v72
    v_add_f32 v65, v65, v73
    v_add_f32 v66, v66, v74
    v_add_f32 v67, v67, v75
    v_add_f32 v68, v68, v76
    v_add_f32 v69, v69, v77
    v_add_f32 v70, v70, v78
    v_add_f32 v71, v71, v79
    v_add_f32 v64, v64, v68
    v_add_f32 v65, v65, v69
    v_add_f32 v66, v66, v70
    v_add_f32 v67, v67, v71
    s_nop 0
    v_permlane32_swap_b32 v64, v66
    v_permlane32_swap_b32 v65, v67
    v_add_f32 v64, v64, v66
    v_add_f32 v65, v65, v67
    v_mov_b32 v66, v64
    v_mov_b32 v67, v65
    s_nop 0
    v_permlane16_swap_b32 v64, v66
    v_permlane16_swap_b32 v65, v67
    v_add_f32 v64, v64, v66
    v_add_f32 v65, v65, v67
    v_mul_f32 v64, 0x3a800000, v64
    v_mul_f32 v65, 0x3a800000, v65
    v_fma_f32 v65, -v64, v64, v65
    v_max_f32 v65, 0, v65
    v_add_f32 v65, 0x3727c5ac, v65
    v_rsq_f32 v65, v65
    v_and_b32 v57, 15, v0
    v_lshrrev_b32 v58, 5, v0
    v_lshl_add_u32 v57, v57, 1, v58
    s_lshl_b32 s3, s25, 7
    v_lshl_add_u32 v57, v57, 2, s3
    v_lshl_add_u32 v58, v0, 2, s3
    v_add_u32 v57, 151552, v57
    v_add_u32 v58, 151552, v58
    s_waitcnt vmcnt(19)
    v_add_f32 v160, v160, v168
    v_add_f32 v161, v161, v169
    v_add_f32 v162, v162, v170
    v_add_f32 v163, v163, v171
    s_waitcnt vmcnt(18)
    v_add_f32 v164, v164, v172
    v_add_f32 v165, v165, v173
    v_add_f32 v166, v166, v174
    v_add_f32 v167, v167, v175
    v_add_f32 v160, v160, v164
    v_add_f32 v161, v161, v165
    v_add_f32 v162, v162, v166
    v_add_f32 v163, v163, v167
    s_nop 0
    v_permlane32_swap_b32 v160, v162
    v_permlane32_swap_b32 v161, v163
    v_add_f32 v160, v160, v162
    v_add_f32 v161, v161, v163
    s_nop 1
    v_permlane16_swap_b32 v160, v161
    v_add_f32 v160, v160, v161
    v_and_b32 v56, 15, v0
    v_lshrrev_b32 v59, 4, v0
    v_lshl_add_u32 v56, v56, 2, v59
    s_lshl_b32 s3, s25, 8
    v_lshl_add_u32 v56, v56, 2, s3
    v_add_u32 v56, 157696, v56
    s_and_b32 s25, s24, 1
    v_lshrrev_b32 v129, 4, v0
    v_bfe_u32 v130, v0, 2, 2
    v_and_b32 v131, 3, v0
    s_lshl_b32 s3, s25, 13
    s_add_u32 s3, s3, s32
    v_add_u32 v32, s3, v1
    v_lshl_add_u32 v132, v129, 2, v130
    v_and_b32 v133, 7, v132
    v_lshlrev_b32 v132, 9, v132
    v_lshl_add_u32 v132, v131, 3, v132
    s_add_u32 s3, s32, 16384
    v_add_u32 v132, s3, v132
    s_and_b32 s3, s30, 1
    s_lshl_b32 s3, s3, 1
    s_mul_i32 s4, s26, 7
    s_add_u32 s3, s3, s4
    v_xor_b32 v134, s3, v133
    v_lshl_add_u32 v33, v134, 5, v132
    s_add_u32 s3, s3, 1
    v_xor_b32 v134, s3, v133
    v_lshl_add_u32 v34, v134, 5, v132
    s_add_u32 s3, s3, 1
    v_xor_b32 v134, s3, v133
    v_lshl_add_u32 v35, v134, 5, v132
    s_add_u32 s3, s3, 1
    v_xor_b32 v134, s3, v133
    v_lshl_add_u32 v36, v134, 5, v132
    s_add_u32 s3, s3, 1
    v_xor_b32 v134, s3, v133
    v_lshl_add_u32 v37, v134, 5, v132
    s_add_u32 s3, s3, 1
    v_xor_b32 v134, s3, v133
    v_lshl_add_u32 v38, v134, 5, v132
    s_add_u32 s3, s3, 1
    v_xor_b32 v134, s3, v133
    v_lshl_add_u32 v39, v134, 5, v132
    s_add_u32 s3, s3, 1
    s_waitcnt vmcnt(2)
    ds_write_b32 v56, v160
    ds_write_b32 v57, v64
    ds_write_b32 v57, v65 offset:512
    s_mov_b32 exec_hi, 0
    ds_write_b32 v58, v96 offset:1024
    s_mov_b32 exec_hi, -1
    s_waitcnt lgkmcnt(0)
    s_barrier
    ds_read_b128 v[48:51], v32 offset:0
    ds_read_b128 v[52:55], v32 offset:1024
    ds_read_b64_tr_b16 v[112:113], v33 offset:0
    ds_read_b64_tr_b16 v[114:115], v33 offset:8192
    ds_read_b64_tr_b16 v[116:117], v33 offset:16384
    ds_read_b64_tr_b16 v[118:119], v33 offset:24576
    ds_read_b128 v[56:59], v32 offset:2048
    ds_read_b128 v[60:63], v32 offset:3072
    ds_read_b128 v[64:67], v32 offset:4096
    ds_read_b128 v[68:71], v32 offset:5120
    ds_read_b128 v[72:75], v32 offset:6144
    ds_read_b128 v[76:79], v32 offset:7168
    ds_read_b64_tr_b16 v[120:121], v34 offset:0
    ds_read_b64_tr_b16 v[122:123], v34 offset:8192
    ds_read_b64_tr_b16 v[124:125], v34 offset:16384
    ds_read_b64_tr_b16 v[126:127], v34 offset:24576
    s_mov_b32 s31, 16
    s_waitcnt lgkmcnt(8)
    v_mfma_f32_16x16x32_bf16 v[144:147], v[112:115], v[48:51], 0
    ds_read_b64_tr_b16 v[128:129], v35 offset:0
    v_mfma_f32_16x16x32_bf16 v[144:147], v[116:119], v[52:55], v[144:147]
    ds_read_b64_tr_b16 v[130:131], v35 offset:8192
    v_mfma_f32_16x16x32_bf16 v[148:151], v[116:119], v[60:63], 0
    ds_read_b64_tr_b16 v[132:133], v35 offset:16384
    v_mfma_f32_16x16x32_bf16 v[148:151], v[112:115], v[56:59], v[148:151]
    ds_read_b64_tr_b16 v[134:135], v35 offset:24576
    s_waitcnt lgkmcnt(11)
    v_mfma_f32_16x16x32_bf16 v[152:155], v[112:115], v[64:67], 0
    s_add_u32 s32, s32, 49152
    s_waitcnt lgkmcnt(10)
    v_mfma_f32_16x16x32_bf16 v[152:155], v[116:119], v[68:71], v[152:155]
    s_cmp_eq_u32 s32, 147456
    s_waitcnt lgkmcnt(8)
    v_mfma_f32_16x16x32_bf16 v[156:159], v[116:119], v[76:79], 0
    s_cselect_b32 s33, s39, 49152
    v_mfma_f32_16x16x32_bf16 v[156:159], v[112:115], v[72:75], v[156:159]
    s_cselect_b32 s32, 0, s32
    s_waitcnt lgkmcnt(4)
    v_mfma_f32_16x16x32_bf16 v[172:175], v[120:123], v[72:75], 0
    ds_read_b64_tr_b16 v[136:137], v36 offset:0
    v_mfma_f32_16x16x32_bf16 v[172:175], v[124:127], v[76:79], v[172:175]
    ds_read_b64_tr_b16 v[138:139], v36 offset:8192
    v_mfma_f32_16x16x32_bf16 v[168:171], v[124:127], v[68:71], 0
    ds_read_b64_tr_b16 v[140:141], v36 offset:16384
    v_mfma_f32_16x16x32_bf16 v[168:171], v[120:123], v[64:67], v[168:171]
    ds_read_b64_tr_b16 v[142:143], v36 offset:24576
    v_mfma_f32_16x16x32_bf16 v[164:167], v[120:123], v[56:59], 0
    v_add_u32 v32, s33, v32
    v_mfma_f32_16x16x32_bf16 v[164:167], v[124:127], v[60:63], v[164:167]
    v_add_u32 v33, s33, v33
    v_mfma_f32_16x16x32_bf16 v[160:163], v[124:127], v[52:55], 0
    v_mfma_f32_16x16x32_bf16 v[160:163], v[120:123], v[48:51], v[160:163]
    s_waitcnt lgkmcnt(4)
    v_mfma_f32_16x16x32_bf16 v[176:179], v[128:131], v[48:51], 0
    ds_read_b64_tr_b16 v[112:113], v37 offset:0
    v_mfma_f32_16x16x32_bf16 v[176:179], v[132:135], v[52:55], v[176:179]
    ds_read_b64_tr_b16 v[114:115], v37 offset:8192
    v_mfma_f32_16x16x32_bf16 v[180:183], v[132:135], v[60:63], 0
    ds_read_b64_tr_b16 v[116:117], v37 offset:16384
    v_mfma_f32_16x16x32_bf16 v[180:183], v[128:131], v[56:59], v[180:183]
    ds_read_b64_tr_b16 v[118:119], v37 offset:24576
    v_mfma_f32_16x16x32_bf16 v[184:187], v[128:131], v[64:67], 0
    v_add_u32 v34, s33, v34
    v_mfma_f32_16x16x32_bf16 v[184:187], v[132:135], v[68:71], v[184:187]
    v_add_u32 v35, s33, v35
    v_mfma_f32_16x16x32_bf16 v[188:191], v[132:135], v[76:79], 0
    v_mfma_f32_16x16x32_bf16 v[188:191], v[128:131], v[72:75], v[188:191]
    s_waitcnt lgkmcnt(4)
    v_mfma_f32_16x16x32_bf16 v[204:207], v[136:139], v[72:75], 0
    ds_read_b64_tr_b16 v[120:121], v38 offset:0
    v_mfma_f32_16x16x32_bf16 v[204:207], v[140:143], v[76:79], v[204:207]
    ds_read_b64_tr_b16 v[122:123], v38 offset:8192
    v_mfma_f32_16x16x32_bf16 v[200:203], v[140:143], v[68:71], 0
    ds_read_b64_tr_b16 v[124:125], v38 offset:16384
    v_mfma_f32_16x16x32_bf16 v[200:203], v[136:139], v[64:67], v[200:203]
    ds_read_b64_tr_b16 v[126:127], v38 offset:24576
    v_mfma_f32_16x16x32_bf16 v[196:199], v[136:139], v[56:59], 0
    v_add_u32 v36, s33, v36
    v_mfma_f32_16x16x32_bf16 v[196:199], v[140:143], v[60:63], v[196:199]
    v_add_u32 v37, s33, v37
    v_mfma_f32_16x16x32_bf16 v[192:195], v[140:143], v[52:55], 0
    v_mfma_f32_16x16x32_bf16 v[192:195], v[136:139], v[48:51], v[192:195]
    s_waitcnt lgkmcnt(4)
    v_mfma_f32_16x16x32_bf16 v[208:211], v[112:115], v[48:51], 0
    ds_read_b64_tr_b16 v[128:129], v39 offset:0
    v_mfma_f32_16x16x32_bf16 v[208:211], v[116:119], v[52:55], v[208:211]
    ds_read_b64_tr_b16 v[130:131], v39 offset:8192
    v_mfma_f32_16x16x32_bf16 v[212:215], v[116:119], v[60:63], 0
    ds_read_b64_tr_b16 v[132:133], v39 offset:16384
    v_mfma_f32_16x16x32_bf16 v[212:215], v[112:115], v[56:59], v[212:215]
    ds_read_b64_tr_b16 v[134:135], v39 offset:24576
    v_mfma_f32_16x16x32_bf16 v[216:219], v[112:115], v[64:67], 0
    v_add_u32 v38, s33, v38
    v_mfma_f32_16x16x32_bf16 v[216:219], v[116:119], v[68:71], v[216:219]
    v_add_u32 v39, s33, v39
    v_mfma_f32_16x16x32_bf16 v[220:223], v[116:119], v[76:79], 0
    v_mfma_f32_16x16x32_bf16 v[220:223], v[112:115], v[72:75], v[220:223]
    s_waitcnt lgkmcnt(0)
    s_barrier
    v_mfma_f32_16x16x32_bf16 v[236:239], v[120:123], v[72:75], 0
    ds_read_b128 v[80:83], v32 offset:0
    v_mfma_f32_16x16x32_bf16 v[236:239], v[124:127], v[76:79], v[236:239]
    ds_read_b128 v[84:87], v32 offset:1024
    v_mfma_f32_16x16x32_bf16 v[232:235], v[124:127], v[68:71], 0
    ds_read_b64_tr_b16 v[112:113], v33 offset:0
    v_mfma_f32_16x16x32_bf16 v[232:235], v[120:123], v[64:67], v[232:235]
    ds_read_b64_tr_b16 v[114:115], v33 offset:8192
    v_mfma_f32_16x16x32_bf16 v[228:231], v[120:123], v[56:59], 0
    ds_read_b64_tr_b16 v[116:117], v33 offset:16384
    v_mfma_f32_16x16x32_bf16 v[228:231], v[124:127], v[60:63], v[228:231]
    ds_read_b64_tr_b16 v[118:119], v33 offset:24576
    v_mfma_f32_16x16x32_bf16 v[224:227], v[124:127], v[52:55], 0
    ds_read_b128 v[88:91], v32 offset:2048
    v_mfma_f32_16x16x32_bf16 v[224:227], v[120:123], v[48:51], v[224:227]
    ds_read_b128 v[92:95], v32 offset:3072
    v_mfma_f32_16x16x32_bf16 v[240:243], v[128:131], v[48:51], 0
    ds_read_b128 v[96:99], v32 offset:4096
    v_mfma_f32_16x16x32_bf16 v[240:243], v[132:135], v[52:55], v[240:243]
    ds_read_b128 v[100:103], v32 offset:5120
    v_mfma_f32_16x16x32_bf16 v[244:247], v[132:135], v[60:63], 0
    ds_read_b128 v[104:107], v32 offset:6144
    v_mfma_f32_16x16x32_bf16 v[244:247], v[128:131], v[56:59], v[244:247]
    ds_read_b128 v[108:111], v32 offset:7168
    v_mfma_f32_16x16x32_bf16 v[248:251], v[128:131], v[64:67], 0
    ds_read_b64_tr_b16 v[120:121], v34 offset:0
    v_mfma_f32_16x16x32_bf16 v[248:251], v[132:135], v[68:71], v[248:251]
    ds_read_b64_tr_b16 v[122:123], v34 offset:8192
    v_mfma_f32_16x16x32_bf16 v[252:255], v[132:135], v[76:79], 0
    ds_read_b64_tr_b16 v[124:125], v34 offset:16384
    v_mfma_f32_16x16x32_bf16 v[252:255], v[128:131], v[72:75], v[252:255]
    ds_read_b64_tr_b16 v[126:127], v34 offset:24576
    s_branch gated_mix__softmax_full_mha__mixer_s_mlp__prompt_kernel_ge78
    .p2align 5
gated_mix__softmax_full_mha__mixer_s_mlp__prompt_kernel_gl77:
    s_waitcnt lgkmcnt(8)
    v_mfma_f32_16x16x32_bf16 v[144:147], v[112:115], v[48:51], v[144:147]
    ds_read_b64_tr_b16 v[128:129], v35 offset:0
    v_mfma_f32_16x16x32_bf16 v[144:147], v[116:119], v[52:55], v[144:147]
    ds_read_b64_tr_b16 v[130:131], v35 offset:8192
    v_mfma_f32_16x16x32_bf16 v[148:151], v[116:119], v[60:63], v[148:151]
    ds_read_b64_tr_b16 v[132:133], v35 offset:16384
    v_mfma_f32_16x16x32_bf16 v[148:151], v[112:115], v[56:59], v[148:151]
    ds_read_b64_tr_b16 v[134:135], v35 offset:24576
    s_waitcnt lgkmcnt(11)
    v_mfma_f32_16x16x32_bf16 v[152:155], v[112:115], v[64:67], v[152:155]
    s_add_u32 s32, s32, 49152
    s_waitcnt lgkmcnt(10)
    v_mfma_f32_16x16x32_bf16 v[152:155], v[116:119], v[68:71], v[152:155]
    s_cmp_eq_u32 s32, 147456
    s_waitcnt lgkmcnt(8)
    v_mfma_f32_16x16x32_bf16 v[156:159], v[116:119], v[76:79], v[156:159]
    s_cselect_b32 s33, s39, 49152
    v_mfma_f32_16x16x32_bf16 v[156:159], v[112:115], v[72:75], v[156:159]
    s_cselect_b32 s32, 0, s32
    s_waitcnt lgkmcnt(4)
    v_mfma_f32_16x16x32_bf16 v[172:175], v[120:123], v[72:75], v[172:175]
    ds_read_b64_tr_b16 v[136:137], v36 offset:0
    v_mfma_f32_16x16x32_bf16 v[172:175], v[124:127], v[76:79], v[172:175]
    ds_read_b64_tr_b16 v[138:139], v36 offset:8192
    v_mfma_f32_16x16x32_bf16 v[168:171], v[124:127], v[68:71], v[168:171]
    ds_read_b64_tr_b16 v[140:141], v36 offset:16384
    v_mfma_f32_16x16x32_bf16 v[168:171], v[120:123], v[64:67], v[168:171]
    ds_read_b64_tr_b16 v[142:143], v36 offset:24576
    v_mfma_f32_16x16x32_bf16 v[164:167], v[120:123], v[56:59], v[164:167]
    v_add_u32 v32, s33, v32
    v_mfma_f32_16x16x32_bf16 v[164:167], v[124:127], v[60:63], v[164:167]
    v_add_u32 v33, s33, v33
    v_mfma_f32_16x16x32_bf16 v[160:163], v[124:127], v[52:55], v[160:163]
    v_mfma_f32_16x16x32_bf16 v[160:163], v[120:123], v[48:51], v[160:163]
    s_waitcnt lgkmcnt(4)
    v_mfma_f32_16x16x32_bf16 v[176:179], v[128:131], v[48:51], v[176:179]
    ds_read_b64_tr_b16 v[112:113], v37 offset:0
    v_mfma_f32_16x16x32_bf16 v[176:179], v[132:135], v[52:55], v[176:179]
    ds_read_b64_tr_b16 v[114:115], v37 offset:8192
    v_mfma_f32_16x16x32_bf16 v[180:183], v[132:135], v[60:63], v[180:183]
    ds_read_b64_tr_b16 v[116:117], v37 offset:16384
    v_mfma_f32_16x16x32_bf16 v[180:183], v[128:131], v[56:59], v[180:183]
    ds_read_b64_tr_b16 v[118:119], v37 offset:24576
    v_mfma_f32_16x16x32_bf16 v[184:187], v[128:131], v[64:67], v[184:187]
    v_add_u32 v34, s33, v34
    v_mfma_f32_16x16x32_bf16 v[184:187], v[132:135], v[68:71], v[184:187]
    v_add_u32 v35, s33, v35
    v_mfma_f32_16x16x32_bf16 v[188:191], v[132:135], v[76:79], v[188:191]
    v_mfma_f32_16x16x32_bf16 v[188:191], v[128:131], v[72:75], v[188:191]
    s_waitcnt lgkmcnt(4)
    v_mfma_f32_16x16x32_bf16 v[204:207], v[136:139], v[72:75], v[204:207]
    ds_read_b64_tr_b16 v[120:121], v38 offset:0
    v_mfma_f32_16x16x32_bf16 v[204:207], v[140:143], v[76:79], v[204:207]
    ds_read_b64_tr_b16 v[122:123], v38 offset:8192
    v_mfma_f32_16x16x32_bf16 v[200:203], v[140:143], v[68:71], v[200:203]
    ds_read_b64_tr_b16 v[124:125], v38 offset:16384
    v_mfma_f32_16x16x32_bf16 v[200:203], v[136:139], v[64:67], v[200:203]
    ds_read_b64_tr_b16 v[126:127], v38 offset:24576
    v_mfma_f32_16x16x32_bf16 v[196:199], v[136:139], v[56:59], v[196:199]
    v_add_u32 v36, s33, v36
    v_mfma_f32_16x16x32_bf16 v[196:199], v[140:143], v[60:63], v[196:199]
    v_add_u32 v37, s33, v37
    v_mfma_f32_16x16x32_bf16 v[192:195], v[140:143], v[52:55], v[192:195]
    v_mfma_f32_16x16x32_bf16 v[192:195], v[136:139], v[48:51], v[192:195]
    s_waitcnt lgkmcnt(4)
    v_mfma_f32_16x16x32_bf16 v[208:211], v[112:115], v[48:51], v[208:211]
    ds_read_b64_tr_b16 v[128:129], v39 offset:0
    v_mfma_f32_16x16x32_bf16 v[208:211], v[116:119], v[52:55], v[208:211]
    ds_read_b64_tr_b16 v[130:131], v39 offset:8192
    v_mfma_f32_16x16x32_bf16 v[212:215], v[116:119], v[60:63], v[212:215]
    ds_read_b64_tr_b16 v[132:133], v39 offset:16384
    v_mfma_f32_16x16x32_bf16 v[212:215], v[112:115], v[56:59], v[212:215]
    ds_read_b64_tr_b16 v[134:135], v39 offset:24576
    v_mfma_f32_16x16x32_bf16 v[216:219], v[112:115], v[64:67], v[216:219]
    v_add_u32 v38, s33, v38
    v_mfma_f32_16x16x32_bf16 v[216:219], v[116:119], v[68:71], v[216:219]
    v_add_u32 v39, s33, v39
    v_mfma_f32_16x16x32_bf16 v[220:223], v[116:119], v[76:79], v[220:223]
    v_mfma_f32_16x16x32_bf16 v[220:223], v[112:115], v[72:75], v[220:223]
    s_waitcnt lgkmcnt(0)
    s_barrier
    v_mfma_f32_16x16x32_bf16 v[236:239], v[120:123], v[72:75], v[236:239]
    ds_read_b128 v[80:83], v32 offset:0
    v_mfma_f32_16x16x32_bf16 v[236:239], v[124:127], v[76:79], v[236:239]
    ds_read_b128 v[84:87], v32 offset:1024
    v_mfma_f32_16x16x32_bf16 v[232:235], v[124:127], v[68:71], v[232:235]
    ds_read_b64_tr_b16 v[112:113], v33 offset:0
    v_mfma_f32_16x16x32_bf16 v[232:235], v[120:123], v[64:67], v[232:235]
    ds_read_b64_tr_b16 v[114:115], v33 offset:8192
    v_mfma_f32_16x16x32_bf16 v[228:231], v[120:123], v[56:59], v[228:231]
    ds_read_b64_tr_b16 v[116:117], v33 offset:16384
    v_mfma_f32_16x16x32_bf16 v[228:231], v[124:127], v[60:63], v[228:231]
    ds_read_b64_tr_b16 v[118:119], v33 offset:24576
    v_mfma_f32_16x16x32_bf16 v[224:227], v[124:127], v[52:55], v[224:227]
    ds_read_b128 v[88:91], v32 offset:2048
    v_mfma_f32_16x16x32_bf16 v[224:227], v[120:123], v[48:51], v[224:227]
    ds_read_b128 v[92:95], v32 offset:3072
    v_mfma_f32_16x16x32_bf16 v[240:243], v[128:131], v[48:51], v[240:243]
    ds_read_b128 v[96:99], v32 offset:4096
    v_mfma_f32_16x16x32_bf16 v[240:243], v[132:135], v[52:55], v[240:243]
    ds_read_b128 v[100:103], v32 offset:5120
    v_mfma_f32_16x16x32_bf16 v[244:247], v[132:135], v[60:63], v[244:247]
    ds_read_b128 v[104:107], v32 offset:6144
    v_mfma_f32_16x16x32_bf16 v[244:247], v[128:131], v[56:59], v[244:247]
    ds_read_b128 v[108:111], v32 offset:7168
    v_mfma_f32_16x16x32_bf16 v[248:251], v[128:131], v[64:67], v[248:251]
    ds_read_b64_tr_b16 v[120:121], v34 offset:0
    v_mfma_f32_16x16x32_bf16 v[248:251], v[132:135], v[68:71], v[248:251]
    ds_read_b64_tr_b16 v[122:123], v34 offset:8192
    v_mfma_f32_16x16x32_bf16 v[252:255], v[132:135], v[76:79], v[252:255]
    ds_read_b64_tr_b16 v[124:125], v34 offset:16384
    v_mfma_f32_16x16x32_bf16 v[252:255], v[128:131], v[72:75], v[252:255]
    ds_read_b64_tr_b16 v[126:127], v34 offset:24576
gated_mix__softmax_full_mha__mixer_s_mlp__prompt_kernel_ge78:
    s_waitcnt lgkmcnt(8)
    v_mfma_f32_16x16x32_bf16 v[144:147], v[112:115], v[80:83], v[144:147]
    ds_read_b64_tr_b16 v[128:129], v35 offset:0
    v_mfma_f32_16x16x32_bf16 v[144:147], v[116:119], v[84:87], v[144:147]
    ds_read_b64_tr_b16 v[130:131], v35 offset:8192
    v_mfma_f32_16x16x32_bf16 v[148:151], v[116:119], v[92:95], v[148:151]
    ds_read_b64_tr_b16 v[132:133], v35 offset:16384
    v_mfma_f32_16x16x32_bf16 v[148:151], v[112:115], v[88:91], v[148:151]
    ds_read_b64_tr_b16 v[134:135], v35 offset:24576
    s_waitcnt lgkmcnt(11)
    v_mfma_f32_16x16x32_bf16 v[152:155], v[112:115], v[96:99], v[152:155]
    s_add_u32 s32, s32, 49152
    s_waitcnt lgkmcnt(10)
    v_mfma_f32_16x16x32_bf16 v[152:155], v[116:119], v[100:103], v[152:155]
    s_cmp_eq_u32 s32, 147456
    s_waitcnt lgkmcnt(8)
    v_mfma_f32_16x16x32_bf16 v[156:159], v[116:119], v[108:111], v[156:159]
    s_cselect_b32 s33, s39, 49152
    v_mfma_f32_16x16x32_bf16 v[156:159], v[112:115], v[104:107], v[156:159]
    s_cselect_b32 s32, 0, s32
    s_waitcnt lgkmcnt(4)
    v_mfma_f32_16x16x32_bf16 v[172:175], v[120:123], v[104:107], v[172:175]
    ds_read_b64_tr_b16 v[136:137], v36 offset:0
    v_mfma_f32_16x16x32_bf16 v[172:175], v[124:127], v[108:111], v[172:175]
    ds_read_b64_tr_b16 v[138:139], v36 offset:8192
    v_mfma_f32_16x16x32_bf16 v[168:171], v[124:127], v[100:103], v[168:171]
    ds_read_b64_tr_b16 v[140:141], v36 offset:16384
    v_mfma_f32_16x16x32_bf16 v[168:171], v[120:123], v[96:99], v[168:171]
    ds_read_b64_tr_b16 v[142:143], v36 offset:24576
    v_mfma_f32_16x16x32_bf16 v[164:167], v[120:123], v[88:91], v[164:167]
    v_add_u32 v32, s33, v32
    v_mfma_f32_16x16x32_bf16 v[164:167], v[124:127], v[92:95], v[164:167]
    v_add_u32 v33, s33, v33
    v_mfma_f32_16x16x32_bf16 v[160:163], v[124:127], v[84:87], v[160:163]
    v_mfma_f32_16x16x32_bf16 v[160:163], v[120:123], v[80:83], v[160:163]
    s_waitcnt lgkmcnt(4)
    v_mfma_f32_16x16x32_bf16 v[176:179], v[128:131], v[80:83], v[176:179]
    ds_read_b64_tr_b16 v[112:113], v37 offset:0
    v_mfma_f32_16x16x32_bf16 v[176:179], v[132:135], v[84:87], v[176:179]
    ds_read_b64_tr_b16 v[114:115], v37 offset:8192
    v_mfma_f32_16x16x32_bf16 v[180:183], v[132:135], v[92:95], v[180:183]
    ds_read_b64_tr_b16 v[116:117], v37 offset:16384
    v_mfma_f32_16x16x32_bf16 v[180:183], v[128:131], v[88:91], v[180:183]
    ds_read_b64_tr_b16 v[118:119], v37 offset:24576
    v_mfma_f32_16x16x32_bf16 v[184:187], v[128:131], v[96:99], v[184:187]
    v_add_u32 v34, s33, v34
    v_mfma_f32_16x16x32_bf16 v[184:187], v[132:135], v[100:103], v[184:187]
    v_add_u32 v35, s33, v35
    v_mfma_f32_16x16x32_bf16 v[188:191], v[132:135], v[108:111], v[188:191]
    v_mfma_f32_16x16x32_bf16 v[188:191], v[128:131], v[104:107], v[188:191]
    s_waitcnt lgkmcnt(4)
    v_mfma_f32_16x16x32_bf16 v[204:207], v[136:139], v[104:107], v[204:207]
    ds_read_b64_tr_b16 v[120:121], v38 offset:0
    v_mfma_f32_16x16x32_bf16 v[204:207], v[140:143], v[108:111], v[204:207]
    ds_read_b64_tr_b16 v[122:123], v38 offset:8192
    v_mfma_f32_16x16x32_bf16 v[200:203], v[140:143], v[100:103], v[200:203]
    ds_read_b64_tr_b16 v[124:125], v38 offset:16384
    v_mfma_f32_16x16x32_bf16 v[200:203], v[136:139], v[96:99], v[200:203]
    ds_read_b64_tr_b16 v[126:127], v38 offset:24576
    v_mfma_f32_16x16x32_bf16 v[196:199], v[136:139], v[88:91], v[196:199]
    v_add_u32 v36, s33, v36
    v_mfma_f32_16x16x32_bf16 v[196:199], v[140:143], v[92:95], v[196:199]
    v_add_u32 v37, s33, v37
    v_mfma_f32_16x16x32_bf16 v[192:195], v[140:143], v[84:87], v[192:195]
    v_mfma_f32_16x16x32_bf16 v[192:195], v[136:139], v[80:83], v[192:195]
    s_waitcnt lgkmcnt(4)
    v_mfma_f32_16x16x32_bf16 v[208:211], v[112:115], v[80:83], v[208:211]
    ds_read_b64_tr_b16 v[128:129], v39 offset:0
    v_mfma_f32_16x16x32_bf16 v[208:211], v[116:119], v[84:87], v[208:211]
    ds_read_b64_tr_b16 v[130:131], v39 offset:8192
    v_mfma_f32_16x16x32_bf16 v[212:215], v[116:119], v[92:95], v[212:215]
    ds_read_b64_tr_b16 v[132:133], v39 offset:16384
    v_mfma_f32_16x16x32_bf16 v[212:215], v[112:115], v[88:91], v[212:215]
    ds_read_b64_tr_b16 v[134:135], v39 offset:24576
    v_mfma_f32_16x16x32_bf16 v[216:219], v[112:115], v[96:99], v[216:219]
    v_add_u32 v38, s33, v38
    v_mfma_f32_16x16x32_bf16 v[216:219], v[116:119], v[100:103], v[216:219]
    v_add_u32 v39, s33, v39
    v_mfma_f32_16x16x32_bf16 v[220:223], v[116:119], v[108:111], v[220:223]
    v_mfma_f32_16x16x32_bf16 v[220:223], v[112:115], v[104:107], v[220:223]
    s_waitcnt lgkmcnt(0)
    s_barrier
    v_mfma_f32_16x16x32_bf16 v[236:239], v[120:123], v[104:107], v[236:239]
    ds_read_b128 v[48:51], v32 offset:0
    v_mfma_f32_16x16x32_bf16 v[236:239], v[124:127], v[108:111], v[236:239]
    ds_read_b128 v[52:55], v32 offset:1024
    v_mfma_f32_16x16x32_bf16 v[232:235], v[124:127], v[100:103], v[232:235]
    ds_read_b64_tr_b16 v[112:113], v33 offset:0
    v_mfma_f32_16x16x32_bf16 v[232:235], v[120:123], v[96:99], v[232:235]
    ds_read_b64_tr_b16 v[114:115], v33 offset:8192
    v_mfma_f32_16x16x32_bf16 v[228:231], v[120:123], v[88:91], v[228:231]
    ds_read_b64_tr_b16 v[116:117], v33 offset:16384
    v_mfma_f32_16x16x32_bf16 v[228:231], v[124:127], v[92:95], v[228:231]
    ds_read_b64_tr_b16 v[118:119], v33 offset:24576
    v_mfma_f32_16x16x32_bf16 v[224:227], v[124:127], v[84:87], v[224:227]
    ds_read_b128 v[56:59], v32 offset:2048
    v_mfma_f32_16x16x32_bf16 v[224:227], v[120:123], v[80:83], v[224:227]
    ds_read_b128 v[60:63], v32 offset:3072
    ds_read_b128 v[64:67], v32 offset:4096
    v_mfma_f32_16x16x32_bf16 v[240:243], v[128:131], v[80:83], v[240:243]
    ds_read_b128 v[68:71], v32 offset:5120
    v_mfma_f32_16x16x32_bf16 v[240:243], v[132:135], v[84:87], v[240:243]
    ds_read_b128 v[72:75], v32 offset:6144
    v_mfma_f32_16x16x32_bf16 v[244:247], v[132:135], v[92:95], v[244:247]
    ds_read_b128 v[76:79], v32 offset:7168
    v_mfma_f32_16x16x32_bf16 v[244:247], v[128:131], v[88:91], v[244:247]
    ds_read_b64_tr_b16 v[120:121], v34 offset:0
    v_mfma_f32_16x16x32_bf16 v[248:251], v[128:131], v[96:99], v[248:251]
    ds_read_b64_tr_b16 v[122:123], v34 offset:8192
    v_mfma_f32_16x16x32_bf16 v[248:251], v[132:135], v[100:103], v[248:251]
    ds_read_b64_tr_b16 v[124:125], v34 offset:16384
    v_mfma_f32_16x16x32_bf16 v[252:255], v[132:135], v[108:111], v[252:255]
    ds_read_b64_tr_b16 v[126:127], v34 offset:24576
    v_mfma_f32_16x16x32_bf16 v[252:255], v[128:131], v[104:107], v[252:255]
    s_sub_u32 s31, s31, 2
    s_bitcmp1_b32 0xfffe, s31
    s_cbranch_scc1 gated_mix__softmax_full_mha__mixer_s_mlp__prompt_kernel_gl77
    s_setprio 2
    v_and_b32 v40, 15, v0
    v_lshrrev_b32 v41, 4, v0
    s_waitcnt lgkmcnt(0)
    s_mul_i32 s3, s26, 448
    s_and_b32 s4, s30, 1
    s_lshl_b32 s4, s4, 7
    s_add_u32 s3, s3, s4
    s_add_u32 s3, s3, 157696
    v_lshl_add_u32 v36, v41, 4, s3
    s_lshl_b32 s3, s25, 8
    s_add_u32 s3, s3, 151552
    v_lshl_add_u32 v37, v40, 2, s3
    ds_read_b32 v76, v37 offset:0
    ds_read_b32 v77, v37 offset:512
    ds_read_b32 v79, v37 offset:1024
    ds_read_b32 v84, v37 offset:64
    ds_read_b32 v85, v37 offset:576
    ds_read_b32 v87, v37 offset:1088
    ds_read_b32 v92, v37 offset:128
    ds_read_b32 v93, v37 offset:640
    ds_read_b32 v95, v37 offset:1152
    ds_read_b32 v100, v37 offset:192
    ds_read_b32 v101, v37 offset:704
    ds_read_b32 v103, v37 offset:1216
    ds_read_b128 v[48:51], v36 offset:0
    ds_read_b128 v[52:55], v36 offset:64
    ds_read_b128 v[56:59], v36 offset:128
    ds_read_b128 v[60:63], v36 offset:192
    ds_read_b128 v[64:67], v36 offset:256
    ds_read_b128 v[68:71], v36 offset:320
    ds_read_b128 v[72:75], v36 offset:384
    s_waitcnt lgkmcnt(15)
    v_mul_f32 v81, v77, v77
    v_mul_f32 v80, 0xc0135761, v77
    v_mul_f32 v81, v81, v77
    v_mul_f32 v78, 0xbdd2d3e8, v81
    v_mul_f32 v81, v79, v77
    v_rcp_f32 v82, v81
    s_nop 0
    v_min_f32 v82, 0x7f61b1e6, v82
    s_waitcnt lgkmcnt(14)
    v_mul_f32 v89, v85, v85
    v_mul_f32 v88, 0xc0135761, v85
    v_mul_f32 v89, v89, v85
    v_mul_f32 v86, 0xbdd2d3e8, v89
    s_waitcnt lgkmcnt(13)
    v_mul_f32 v89, v87, v85
    v_rcp_f32 v90, v89
    s_nop 0
    v_min_f32 v90, 0x7f61b1e6, v90
    s_waitcnt lgkmcnt(11)
    v_mul_f32 v97, v93, v93
    v_mul_f32 v96, 0xc0135761, v93
    v_mul_f32 v97, v97, v93
    v_mul_f32 v94, 0xbdd2d3e8, v97
    s_waitcnt lgkmcnt(10)
    v_mul_f32 v97, v95, v93
    v_rcp_f32 v98, v97
    s_nop 0
    v_min_f32 v98, 0x7f61b1e6, v98
    s_waitcnt lgkmcnt(8)
    v_mul_f32 v105, v101, v101
    v_mul_f32 v104, 0xc0135761, v101
    v_mul_f32 v105, v105, v101
    v_mul_f32 v102, 0xbdd2d3e8, v105
    s_waitcnt lgkmcnt(7)
    v_mul_f32 v105, v103, v101
    v_rcp_f32 v106, v105
    s_nop 0
    v_min_f32 v106, 0x7f61b1e6, v106
    v_lshrrev_b32 v38, 5, v0
    v_mul_u32_u24 v38, 147456, v38
    v_and_b32 v39, 31, v0
    v_lshl_add_u32 v38, v39, 4, v38
    s_lshl_b32 s3, s29, 3
    s_lshl_b32 s4, s25, 2
    s_add_u32 s3, s3, s4
    s_mul_i32 s42, s3, 147456
    s_mul_i32 s3, s30, 14
    s_mul_i32 s4, s26, 7
    s_add_u32 s3, s3, s4
    s_lshl_b32 s3, s3, 9
    s_add_u32 s42, s42, s3
    s_add_u32 s42, s42, 20971520
    s_add_u32 s43, s42, 294912
    s_waitcnt lgkmcnt(6)
    v_pk_fma_f32 v[144:145], v[48:49], v[76:77], v[144:145] op_sel_hi:[1,0,1] neg_lo:[1,0,0] neg_hi:[1,0,0]
    v_pk_fma_f32 v[146:147], v[50:51], v[76:77], v[146:147] op_sel_hi:[1,0,1] neg_lo:[1,0,0] neg_hi:[1,0,0]
    v_pk_fma_f32 v[148:149], v[48:49], v[84:85], v[148:149] op_sel_hi:[1,0,1] neg_lo:[1,0,0] neg_hi:[1,0,0]
    v_pk_fma_f32 v[150:151], v[50:51], v[84:85], v[150:151] op_sel_hi:[1,0,1] neg_lo:[1,0,0] neg_hi:[1,0,0]
    v_pk_fma_f32 v[152:153], v[48:49], v[92:93], v[152:153] op_sel_hi:[1,0,1] neg_lo:[1,0,0] neg_hi:[1,0,0]
    v_pk_fma_f32 v[154:155], v[50:51], v[92:93], v[154:155] op_sel_hi:[1,0,1] neg_lo:[1,0,0] neg_hi:[1,0,0]
    v_pk_fma_f32 v[156:157], v[48:49], v[100:101], v[156:157] op_sel_hi:[1,0,1] neg_lo:[1,0,0] neg_hi:[1,0,0]
    v_pk_fma_f32 v[158:159], v[50:51], v[100:101], v[158:159] op_sel_hi:[1,0,1] neg_lo:[1,0,0] neg_hi:[1,0,0]
    v_pk_mul_f32 v[108:109], v[144:145], v[144:145]
    v_pk_mul_f32 v[110:111], v[146:147], v[146:147]
    v_pk_mul_f32 v[112:113], v[148:149], v[148:149]
    v_pk_mul_f32 v[114:115], v[150:151], v[150:151]
    v_pk_mul_f32 v[116:117], v[152:153], v[152:153]
    v_pk_mul_f32 v[118:119], v[154:155], v[154:155]
    v_pk_mul_f32 v[120:121], v[156:157], v[156:157]
    v_pk_mul_f32 v[122:123], v[158:159], v[158:159]
    v_pk_fma_f32 v[108:109], v[108:109], v[78:79], v[80:81] op_sel_hi:[1,0,0]
    v_pk_fma_f32 v[110:111], v[110:111], v[78:79], v[80:81] op_sel_hi:[1,0,0]
    v_pk_fma_f32 v[112:113], v[112:113], v[86:87], v[88:89] op_sel_hi:[1,0,0]
    v_pk_fma_f32 v[114:115], v[114:115], v[86:87], v[88:89] op_sel_hi:[1,0,0]
    v_pk_fma_f32 v[116:117], v[116:117], v[94:95], v[96:97] op_sel_hi:[1,0,0]
    v_pk_fma_f32 v[118:119], v[118:119], v[94:95], v[96:97] op_sel_hi:[1,0,0]
    v_pk_fma_f32 v[120:121], v[120:121], v[102:103], v[104:105] op_sel_hi:[1,0,0]
    v_pk_fma_f32 v[122:123], v[122:123], v[102:103], v[104:105] op_sel_hi:[1,0,0]
    v_pk_mul_f32 v[108:109], v[108:109], v[144:145]
    v_pk_mul_f32 v[110:111], v[110:111], v[146:147]
    v_pk_mul_f32 v[112:113], v[112:113], v[148:149]
    v_pk_mul_f32 v[114:115], v[114:115], v[150:151]
    v_pk_mul_f32 v[116:117], v[116:117], v[152:153]
    v_pk_mul_f32 v[118:119], v[118:119], v[154:155]
    v_pk_mul_f32 v[120:121], v[120:121], v[156:157]
    v_pk_mul_f32 v[122:123], v[122:123], v[158:159]
    v_exp_f32 v108, v108
    v_exp_f32 v109, v109
    v_exp_f32 v110, v110
    v_exp_f32 v111, v111
    v_exp_f32 v112, v112
    v_exp_f32 v113, v113
    v_exp_f32 v114, v114
    v_exp_f32 v115, v115
    v_exp_f32 v116, v116
    v_exp_f32 v117, v117
    v_exp_f32 v118, v118
    v_exp_f32 v119, v119
    v_exp_f32 v120, v120
    v_exp_f32 v121, v121
    v_exp_f32 v122, v122
    v_exp_f32 v123, v123
    v_pk_fma_f32 v[108:109], v[108:109], v[82:83], v[82:83] op_sel_hi:[1,0,0]
    v_pk_fma_f32 v[110:111], v[110:111], v[82:83], v[82:83] op_sel_hi:[1,0,0]
    v_pk_fma_f32 v[112:113], v[112:113], v[90:91], v[90:91] op_sel_hi:[1,0,0]
    v_pk_fma_f32 v[114:115], v[114:115], v[90:91], v[90:91] op_sel_hi:[1,0,0]
    v_pk_fma_f32 v[116:117], v[116:117], v[98:99], v[98:99] op_sel_hi:[1,0,0]
    v_pk_fma_f32 v[118:119], v[118:119], v[98:99], v[98:99] op_sel_hi:[1,0,0]
    v_pk_fma_f32 v[120:121], v[120:121], v[106:107], v[106:107] op_sel_hi:[1,0,0]
    v_pk_fma_f32 v[122:123], v[122:123], v[106:107], v[106:107] op_sel_hi:[1,0,0]
    v_rcp_f32 v108, v108
    v_rcp_f32 v109, v109
    v_rcp_f32 v110, v110
    v_rcp_f32 v111, v111
    v_rcp_f32 v112, v112
    v_rcp_f32 v113, v113
    v_rcp_f32 v114, v114
    v_rcp_f32 v115, v115
    v_rcp_f32 v116, v116
    v_rcp_f32 v117, v117
    v_rcp_f32 v118, v118
    v_rcp_f32 v119, v119
    v_rcp_f32 v120, v120
    v_rcp_f32 v121, v121
    v_rcp_f32 v122, v122
    v_rcp_f32 v123, v123
    v_pk_mul_f32 v[144:145], v[144:145], v[108:109]
    v_pk_mul_f32 v[146:147], v[146:147], v[110:111]
    v_pk_mul_f32 v[148:149], v[148:149], v[112:113]
    v_pk_mul_f32 v[150:151], v[150:151], v[114:115]
    v_pk_mul_f32 v[152:153], v[152:153], v[116:117]
    v_pk_mul_f32 v[154:155], v[154:155], v[118:119]
    v_pk_mul_f32 v[156:157], v[156:157], v[120:121]
    v_pk_mul_f32 v[158:159], v[158:159], v[122:123]
    v_cvt_pk_bf16_f32 v144, v144, v145
    v_cvt_pk_bf16_f32 v145, v146, v147
    v_cvt_pk_bf16_f32 v146, v148, v149
    v_cvt_pk_bf16_f32 v147, v150, v151
    v_cvt_pk_bf16_f32 v152, v152, v153
    v_cvt_pk_bf16_f32 v153, v154, v155
    v_cvt_pk_bf16_f32 v154, v156, v157
    v_cvt_pk_bf16_f32 v155, v158, v159
    v_permlane32_swap_b32 v144, v146
    v_permlane32_swap_b32 v145, v147
    v_permlane32_swap_b32 v152, v154
    v_permlane32_swap_b32 v153, v155
    buffer_store_dwordx4 v[144:147], v38, s[16:19], s42 offen offset:0 sc1
    buffer_store_dwordx4 v[152:155], v38, s[16:19], s43 offen offset:0 sc1
    s_waitcnt lgkmcnt(5)
    v_pk_fma_f32 v[160:161], v[52:53], v[76:77], v[160:161] op_sel_hi:[1,0,1] neg_lo:[1,0,0] neg_hi:[1,0,0]
    v_pk_fma_f32 v[162:163], v[54:55], v[76:77], v[162:163] op_sel_hi:[1,0,1] neg_lo:[1,0,0] neg_hi:[1,0,0]
    v_pk_fma_f32 v[164:165], v[52:53], v[84:85], v[164:165] op_sel_hi:[1,0,1] neg_lo:[1,0,0] neg_hi:[1,0,0]
    v_pk_fma_f32 v[166:167], v[54:55], v[84:85], v[166:167] op_sel_hi:[1,0,1] neg_lo:[1,0,0] neg_hi:[1,0,0]
    v_pk_fma_f32 v[168:169], v[52:53], v[92:93], v[168:169] op_sel_hi:[1,0,1] neg_lo:[1,0,0] neg_hi:[1,0,0]
    v_pk_fma_f32 v[170:171], v[54:55], v[92:93], v[170:171] op_sel_hi:[1,0,1] neg_lo:[1,0,0] neg_hi:[1,0,0]
    v_pk_fma_f32 v[172:173], v[52:53], v[100:101], v[172:173] op_sel_hi:[1,0,1] neg_lo:[1,0,0] neg_hi:[1,0,0]
    v_pk_fma_f32 v[174:175], v[54:55], v[100:101], v[174:175] op_sel_hi:[1,0,1] neg_lo:[1,0,0] neg_hi:[1,0,0]
    v_pk_mul_f32 v[124:125], v[160:161], v[160:161]
    v_pk_mul_f32 v[126:127], v[162:163], v[162:163]
    v_pk_mul_f32 v[128:129], v[164:165], v[164:165]
    v_pk_mul_f32 v[130:131], v[166:167], v[166:167]
    v_pk_mul_f32 v[132:133], v[168:169], v[168:169]
    v_pk_mul_f32 v[134:135], v[170:171], v[170:171]
    v_pk_mul_f32 v[136:137], v[172:173], v[172:173]
    v_pk_mul_f32 v[138:139], v[174:175], v[174:175]
    v_pk_fma_f32 v[124:125], v[124:125], v[78:79], v[80:81] op_sel_hi:[1,0,0]
    v_pk_fma_f32 v[126:127], v[126:127], v[78:79], v[80:81] op_sel_hi:[1,0,0]
    v_pk_fma_f32 v[128:129], v[128:129], v[86:87], v[88:89] op_sel_hi:[1,0,0]
    v_pk_fma_f32 v[130:131], v[130:131], v[86:87], v[88:89] op_sel_hi:[1,0,0]
    v_pk_fma_f32 v[132:133], v[132:133], v[94:95], v[96:97] op_sel_hi:[1,0,0]
    v_pk_fma_f32 v[134:135], v[134:135], v[94:95], v[96:97] op_sel_hi:[1,0,0]
    v_pk_fma_f32 v[136:137], v[136:137], v[102:103], v[104:105] op_sel_hi:[1,0,0]
    v_pk_fma_f32 v[138:139], v[138:139], v[102:103], v[104:105] op_sel_hi:[1,0,0]
    v_pk_mul_f32 v[124:125], v[124:125], v[160:161]
    v_pk_mul_f32 v[126:127], v[126:127], v[162:163]
    v_pk_mul_f32 v[128:129], v[128:129], v[164:165]
    v_pk_mul_f32 v[130:131], v[130:131], v[166:167]
    v_pk_mul_f32 v[132:133], v[132:133], v[168:169]
    v_pk_mul_f32 v[134:135], v[134:135], v[170:171]
    v_pk_mul_f32 v[136:137], v[136:137], v[172:173]
    v_pk_mul_f32 v[138:139], v[138:139], v[174:175]
    v_exp_f32 v124, v124
    v_exp_f32 v125, v125
    v_exp_f32 v126, v126
    v_exp_f32 v127, v127
    v_exp_f32 v128, v128
    v_exp_f32 v129, v129
    v_exp_f32 v130, v130
    v_exp_f32 v131, v131
    v_exp_f32 v132, v132
    v_exp_f32 v133, v133
    v_exp_f32 v134, v134
    v_exp_f32 v135, v135
    v_exp_f32 v136, v136
    v_exp_f32 v137, v137
    v_exp_f32 v138, v138
    v_exp_f32 v139, v139
    v_pk_fma_f32 v[124:125], v[124:125], v[82:83], v[82:83] op_sel_hi:[1,0,0]
    v_pk_fma_f32 v[126:127], v[126:127], v[82:83], v[82:83] op_sel_hi:[1,0,0]
    v_pk_fma_f32 v[128:129], v[128:129], v[90:91], v[90:91] op_sel_hi:[1,0,0]
    v_pk_fma_f32 v[130:131], v[130:131], v[90:91], v[90:91] op_sel_hi:[1,0,0]
    v_pk_fma_f32 v[132:133], v[132:133], v[98:99], v[98:99] op_sel_hi:[1,0,0]
    v_pk_fma_f32 v[134:135], v[134:135], v[98:99], v[98:99] op_sel_hi:[1,0,0]
    v_pk_fma_f32 v[136:137], v[136:137], v[106:107], v[106:107] op_sel_hi:[1,0,0]
    v_pk_fma_f32 v[138:139], v[138:139], v[106:107], v[106:107] op_sel_hi:[1,0,0]
    v_rcp_f32 v124, v124
    v_rcp_f32 v125, v125
    v_rcp_f32 v126, v126
    v_rcp_f32 v127, v127
    v_rcp_f32 v128, v128
    v_rcp_f32 v129, v129
    v_rcp_f32 v130, v130
    v_rcp_f32 v131, v131
    v_rcp_f32 v132, v132
    v_rcp_f32 v133, v133
    v_rcp_f32 v134, v134
    v_rcp_f32 v135, v135
    v_rcp_f32 v136, v136
    v_rcp_f32 v137, v137
    v_rcp_f32 v138, v138
    v_rcp_f32 v139, v139
    v_pk_mul_f32 v[160:161], v[160:161], v[124:125]
    v_pk_mul_f32 v[162:163], v[162:163], v[126:127]
    v_pk_mul_f32 v[164:165], v[164:165], v[128:129]
    v_pk_mul_f32 v[166:167], v[166:167], v[130:131]
    v_pk_mul_f32 v[168:169], v[168:169], v[132:133]
    v_pk_mul_f32 v[170:171], v[170:171], v[134:135]
    v_pk_mul_f32 v[172:173], v[172:173], v[136:137]
    v_pk_mul_f32 v[174:175], v[174:175], v[138:139]
    v_cvt_pk_bf16_f32 v160, v160, v161
    v_cvt_pk_bf16_f32 v161, v162, v163
    v_cvt_pk_bf16_f32 v162, v164, v165
    v_cvt_pk_bf16_f32 v163, v166, v167
    v_cvt_pk_bf16_f32 v168, v168, v169
    v_cvt_pk_bf16_f32 v169, v170, v171
    v_cvt_pk_bf16_f32 v170, v172, v173
    v_cvt_pk_bf16_f32 v171, v174, v175
    v_permlane32_swap_b32 v160, v162
    v_permlane32_swap_b32 v161, v163
    v_permlane32_swap_b32 v168, v170
    v_permlane32_swap_b32 v169, v171
    buffer_store_dwordx4 v[160:163], v38, s[16:19], s42 offen offset:512 sc1
    buffer_store_dwordx4 v[168:171], v38, s[16:19], s43 offen offset:512 sc1
    s_waitcnt lgkmcnt(4)
    v_pk_fma_f32 v[176:177], v[56:57], v[76:77], v[176:177] op_sel_hi:[1,0,1] neg_lo:[1,0,0] neg_hi:[1,0,0]
    v_pk_fma_f32 v[178:179], v[58:59], v[76:77], v[178:179] op_sel_hi:[1,0,1] neg_lo:[1,0,0] neg_hi:[1,0,0]
    v_pk_fma_f32 v[180:181], v[56:57], v[84:85], v[180:181] op_sel_hi:[1,0,1] neg_lo:[1,0,0] neg_hi:[1,0,0]
    v_pk_fma_f32 v[182:183], v[58:59], v[84:85], v[182:183] op_sel_hi:[1,0,1] neg_lo:[1,0,0] neg_hi:[1,0,0]
    v_pk_fma_f32 v[184:185], v[56:57], v[92:93], v[184:185] op_sel_hi:[1,0,1] neg_lo:[1,0,0] neg_hi:[1,0,0]
    v_pk_fma_f32 v[186:187], v[58:59], v[92:93], v[186:187] op_sel_hi:[1,0,1] neg_lo:[1,0,0] neg_hi:[1,0,0]
    v_pk_fma_f32 v[188:189], v[56:57], v[100:101], v[188:189] op_sel_hi:[1,0,1] neg_lo:[1,0,0] neg_hi:[1,0,0]
    v_pk_fma_f32 v[190:191], v[58:59], v[100:101], v[190:191] op_sel_hi:[1,0,1] neg_lo:[1,0,0] neg_hi:[1,0,0]
    v_pk_mul_f32 v[108:109], v[176:177], v[176:177]
    v_pk_mul_f32 v[110:111], v[178:179], v[178:179]
    v_pk_mul_f32 v[112:113], v[180:181], v[180:181]
    v_pk_mul_f32 v[114:115], v[182:183], v[182:183]
    v_pk_mul_f32 v[116:117], v[184:185], v[184:185]
    v_pk_mul_f32 v[118:119], v[186:187], v[186:187]
    v_pk_mul_f32 v[120:121], v[188:189], v[188:189]
    v_pk_mul_f32 v[122:123], v[190:191], v[190:191]
    v_pk_fma_f32 v[108:109], v[108:109], v[78:79], v[80:81] op_sel_hi:[1,0,0]
    v_pk_fma_f32 v[110:111], v[110:111], v[78:79], v[80:81] op_sel_hi:[1,0,0]
    v_pk_fma_f32 v[112:113], v[112:113], v[86:87], v[88:89] op_sel_hi:[1,0,0]
    v_pk_fma_f32 v[114:115], v[114:115], v[86:87], v[88:89] op_sel_hi:[1,0,0]
    v_pk_fma_f32 v[116:117], v[116:117], v[94:95], v[96:97] op_sel_hi:[1,0,0]
    v_pk_fma_f32 v[118:119], v[118:119], v[94:95], v[96:97] op_sel_hi:[1,0,0]
    v_pk_fma_f32 v[120:121], v[120:121], v[102:103], v[104:105] op_sel_hi:[1,0,0]
    v_pk_fma_f32 v[122:123], v[122:123], v[102:103], v[104:105] op_sel_hi:[1,0,0]
    v_pk_mul_f32 v[108:109], v[108:109], v[176:177]
    v_pk_mul_f32 v[110:111], v[110:111], v[178:179]
    v_pk_mul_f32 v[112:113], v[112:113], v[180:181]
    v_pk_mul_f32 v[114:115], v[114:115], v[182:183]
    v_pk_mul_f32 v[116:117], v[116:117], v[184:185]
    v_pk_mul_f32 v[118:119], v[118:119], v[186:187]
    v_pk_mul_f32 v[120:121], v[120:121], v[188:189]
    v_pk_mul_f32 v[122:123], v[122:123], v[190:191]
    v_exp_f32 v108, v108
    v_exp_f32 v109, v109
    v_exp_f32 v110, v110
    v_exp_f32 v111, v111
    v_exp_f32 v112, v112
    v_exp_f32 v113, v113
    v_exp_f32 v114, v114
    v_exp_f32 v115, v115
    v_exp_f32 v116, v116
    v_exp_f32 v117, v117
    v_exp_f32 v118, v118
    v_exp_f32 v119, v119
    v_exp_f32 v120, v120
    v_exp_f32 v121, v121
    v_exp_f32 v122, v122
    v_exp_f32 v123, v123
    v_pk_fma_f32 v[108:109], v[108:109], v[82:83], v[82:83] op_sel_hi:[1,0,0]
    v_pk_fma_f32 v[110:111], v[110:111], v[82:83], v[82:83] op_sel_hi:[1,0,0]
    v_pk_fma_f32 v[112:113], v[112:113], v[90:91], v[90:91] op_sel_hi:[1,0,0]
    v_pk_fma_f32 v[114:115], v[114:115], v[90:91], v[90:91] op_sel_hi:[1,0,0]
    v_pk_fma_f32 v[116:117], v[116:117], v[98:99], v[98:99] op_sel_hi:[1,0,0]
    v_pk_fma_f32 v[118:119], v[118:119], v[98:99], v[98:99] op_sel_hi:[1,0,0]
    v_pk_fma_f32 v[120:121], v[120:121], v[106:107], v[106:107] op_sel_hi:[1,0,0]
    v_pk_fma_f32 v[122:123], v[122:123], v[106:107], v[106:107] op_sel_hi:[1,0,0]
    v_rcp_f32 v108, v108
    v_rcp_f32 v109, v109
    v_rcp_f32 v110, v110
    v_rcp_f32 v111, v111
    v_rcp_f32 v112, v112
    v_rcp_f32 v113, v113
    v_rcp_f32 v114, v114
    v_rcp_f32 v115, v115
    v_rcp_f32 v116, v116
    v_rcp_f32 v117, v117
    v_rcp_f32 v118, v118
    v_rcp_f32 v119, v119
    v_rcp_f32 v120, v120
    v_rcp_f32 v121, v121
    v_rcp_f32 v122, v122
    v_rcp_f32 v123, v123
    v_pk_mul_f32 v[176:177], v[176:177], v[108:109]
    v_pk_mul_f32 v[178:179], v[178:179], v[110:111]
    v_pk_mul_f32 v[180:181], v[180:181], v[112:113]
    v_pk_mul_f32 v[182:183], v[182:183], v[114:115]
    v_pk_mul_f32 v[184:185], v[184:185], v[116:117]
    v_pk_mul_f32 v[186:187], v[186:187], v[118:119]
    v_pk_mul_f32 v[188:189], v[188:189], v[120:121]
    v_pk_mul_f32 v[190:191], v[190:191], v[122:123]
    v_cvt_pk_bf16_f32 v176, v176, v177
    v_cvt_pk_bf16_f32 v177, v178, v179
    v_cvt_pk_bf16_f32 v178, v180, v181
    v_cvt_pk_bf16_f32 v179, v182, v183
    v_cvt_pk_bf16_f32 v184, v184, v185
    v_cvt_pk_bf16_f32 v185, v186, v187
    v_cvt_pk_bf16_f32 v186, v188, v189
    v_cvt_pk_bf16_f32 v187, v190, v191
    v_permlane32_swap_b32 v176, v178
    v_permlane32_swap_b32 v177, v179
    v_permlane32_swap_b32 v184, v186
    v_permlane32_swap_b32 v185, v187
    buffer_store_dwordx4 v[176:179], v38, s[16:19], s42 offen offset:1024 sc1
    buffer_store_dwordx4 v[184:187], v38, s[16:19], s43 offen offset:1024 sc1
    s_waitcnt lgkmcnt(3)
    v_pk_fma_f32 v[192:193], v[60:61], v[76:77], v[192:193] op_sel_hi:[1,0,1] neg_lo:[1,0,0] neg_hi:[1,0,0]
    v_pk_fma_f32 v[194:195], v[62:63], v[76:77], v[194:195] op_sel_hi:[1,0,1] neg_lo:[1,0,0] neg_hi:[1,0,0]
    v_pk_fma_f32 v[196:197], v[60:61], v[84:85], v[196:197] op_sel_hi:[1,0,1] neg_lo:[1,0,0] neg_hi:[1,0,0]
    v_pk_fma_f32 v[198:199], v[62:63], v[84:85], v[198:199] op_sel_hi:[1,0,1] neg_lo:[1,0,0] neg_hi:[1,0,0]
    v_pk_fma_f32 v[200:201], v[60:61], v[92:93], v[200:201] op_sel_hi:[1,0,1] neg_lo:[1,0,0] neg_hi:[1,0,0]
    v_pk_fma_f32 v[202:203], v[62:63], v[92:93], v[202:203] op_sel_hi:[1,0,1] neg_lo:[1,0,0] neg_hi:[1,0,0]
    v_pk_fma_f32 v[204:205], v[60:61], v[100:101], v[204:205] op_sel_hi:[1,0,1] neg_lo:[1,0,0] neg_hi:[1,0,0]
    v_pk_fma_f32 v[206:207], v[62:63], v[100:101], v[206:207] op_sel_hi:[1,0,1] neg_lo:[1,0,0] neg_hi:[1,0,0]
    v_pk_mul_f32 v[124:125], v[192:193], v[192:193]
    v_pk_mul_f32 v[126:127], v[194:195], v[194:195]
    v_pk_mul_f32 v[128:129], v[196:197], v[196:197]
    v_pk_mul_f32 v[130:131], v[198:199], v[198:199]
    v_pk_mul_f32 v[132:133], v[200:201], v[200:201]
    v_pk_mul_f32 v[134:135], v[202:203], v[202:203]
    v_pk_mul_f32 v[136:137], v[204:205], v[204:205]
    v_pk_mul_f32 v[138:139], v[206:207], v[206:207]
    v_pk_fma_f32 v[124:125], v[124:125], v[78:79], v[80:81] op_sel_hi:[1,0,0]
    v_pk_fma_f32 v[126:127], v[126:127], v[78:79], v[80:81] op_sel_hi:[1,0,0]
    v_pk_fma_f32 v[128:129], v[128:129], v[86:87], v[88:89] op_sel_hi:[1,0,0]
    v_pk_fma_f32 v[130:131], v[130:131], v[86:87], v[88:89] op_sel_hi:[1,0,0]
    v_pk_fma_f32 v[132:133], v[132:133], v[94:95], v[96:97] op_sel_hi:[1,0,0]
    v_pk_fma_f32 v[134:135], v[134:135], v[94:95], v[96:97] op_sel_hi:[1,0,0]
    v_pk_fma_f32 v[136:137], v[136:137], v[102:103], v[104:105] op_sel_hi:[1,0,0]
    v_pk_fma_f32 v[138:139], v[138:139], v[102:103], v[104:105] op_sel_hi:[1,0,0]
    v_pk_mul_f32 v[124:125], v[124:125], v[192:193]
    v_pk_mul_f32 v[126:127], v[126:127], v[194:195]
    v_pk_mul_f32 v[128:129], v[128:129], v[196:197]
    v_pk_mul_f32 v[130:131], v[130:131], v[198:199]
    v_pk_mul_f32 v[132:133], v[132:133], v[200:201]
    v_pk_mul_f32 v[134:135], v[134:135], v[202:203]
    v_pk_mul_f32 v[136:137], v[136:137], v[204:205]
    v_pk_mul_f32 v[138:139], v[138:139], v[206:207]
    v_exp_f32 v124, v124
    v_exp_f32 v125, v125
    v_exp_f32 v126, v126
    v_exp_f32 v127, v127
    v_exp_f32 v128, v128
    v_exp_f32 v129, v129
    v_exp_f32 v130, v130
    v_exp_f32 v131, v131
    v_exp_f32 v132, v132
    v_exp_f32 v133, v133
    v_exp_f32 v134, v134
    v_exp_f32 v135, v135
    v_exp_f32 v136, v136
    v_exp_f32 v137, v137
    v_exp_f32 v138, v138
    v_exp_f32 v139, v139
    v_pk_fma_f32 v[124:125], v[124:125], v[82:83], v[82:83] op_sel_hi:[1,0,0]
    v_pk_fma_f32 v[126:127], v[126:127], v[82:83], v[82:83] op_sel_hi:[1,0,0]
    v_pk_fma_f32 v[128:129], v[128:129], v[90:91], v[90:91] op_sel_hi:[1,0,0]
    v_pk_fma_f32 v[130:131], v[130:131], v[90:91], v[90:91] op_sel_hi:[1,0,0]
    v_pk_fma_f32 v[132:133], v[132:133], v[98:99], v[98:99] op_sel_hi:[1,0,0]
    v_pk_fma_f32 v[134:135], v[134:135], v[98:99], v[98:99] op_sel_hi:[1,0,0]
    v_pk_fma_f32 v[136:137], v[136:137], v[106:107], v[106:107] op_sel_hi:[1,0,0]
    v_pk_fma_f32 v[138:139], v[138:139], v[106:107], v[106:107] op_sel_hi:[1,0,0]
    v_rcp_f32 v124, v124
    v_rcp_f32 v125, v125
    v_rcp_f32 v126, v126
    v_rcp_f32 v127, v127
    v_rcp_f32 v128, v128
    v_rcp_f32 v129, v129
    v_rcp_f32 v130, v130
    v_rcp_f32 v131, v131
    v_rcp_f32 v132, v132
    v_rcp_f32 v133, v133
    v_rcp_f32 v134, v134
    v_rcp_f32 v135, v135
    v_rcp_f32 v136, v136
    v_rcp_f32 v137, v137
    v_rcp_f32 v138, v138
    v_rcp_f32 v139, v139
    v_pk_mul_f32 v[192:193], v[192:193], v[124:125]
    v_pk_mul_f32 v[194:195], v[194:195], v[126:127]
    v_pk_mul_f32 v[196:197], v[196:197], v[128:129]
    v_pk_mul_f32 v[198:199], v[198:199], v[130:131]
    v_pk_mul_f32 v[200:201], v[200:201], v[132:133]
    v_pk_mul_f32 v[202:203], v[202:203], v[134:135]
    v_pk_mul_f32 v[204:205], v[204:205], v[136:137]
    v_pk_mul_f32 v[206:207], v[206:207], v[138:139]
    v_cvt_pk_bf16_f32 v192, v192, v193
    v_cvt_pk_bf16_f32 v193, v194, v195
    v_cvt_pk_bf16_f32 v194, v196, v197
    v_cvt_pk_bf16_f32 v195, v198, v199
    v_cvt_pk_bf16_f32 v200, v200, v201
    v_cvt_pk_bf16_f32 v201, v202, v203
    v_cvt_pk_bf16_f32 v202, v204, v205
    v_cvt_pk_bf16_f32 v203, v206, v207
    v_permlane32_swap_b32 v192, v194
    v_permlane32_swap_b32 v193, v195
    v_permlane32_swap_b32 v200, v202
    v_permlane32_swap_b32 v201, v203
    buffer_store_dwordx4 v[192:195], v38, s[16:19], s42 offen offset:1536 sc1
    buffer_store_dwordx4 v[200:203], v38, s[16:19], s43 offen offset:1536 sc1
    s_waitcnt lgkmcnt(2)
    v_pk_fma_f32 v[208:209], v[64:65], v[76:77], v[208:209] op_sel_hi:[1,0,1] neg_lo:[1,0,0] neg_hi:[1,0,0]
    v_pk_fma_f32 v[210:211], v[66:67], v[76:77], v[210:211] op_sel_hi:[1,0,1] neg_lo:[1,0,0] neg_hi:[1,0,0]
    v_pk_fma_f32 v[212:213], v[64:65], v[84:85], v[212:213] op_sel_hi:[1,0,1] neg_lo:[1,0,0] neg_hi:[1,0,0]
    v_pk_fma_f32 v[214:215], v[66:67], v[84:85], v[214:215] op_sel_hi:[1,0,1] neg_lo:[1,0,0] neg_hi:[1,0,0]
    v_pk_fma_f32 v[216:217], v[64:65], v[92:93], v[216:217] op_sel_hi:[1,0,1] neg_lo:[1,0,0] neg_hi:[1,0,0]
    v_pk_fma_f32 v[218:219], v[66:67], v[92:93], v[218:219] op_sel_hi:[1,0,1] neg_lo:[1,0,0] neg_hi:[1,0,0]
    v_pk_fma_f32 v[220:221], v[64:65], v[100:101], v[220:221] op_sel_hi:[1,0,1] neg_lo:[1,0,0] neg_hi:[1,0,0]
    v_pk_fma_f32 v[222:223], v[66:67], v[100:101], v[222:223] op_sel_hi:[1,0,1] neg_lo:[1,0,0] neg_hi:[1,0,0]
    v_pk_mul_f32 v[108:109], v[208:209], v[208:209]
    v_pk_mul_f32 v[110:111], v[210:211], v[210:211]
    v_pk_mul_f32 v[112:113], v[212:213], v[212:213]
    v_pk_mul_f32 v[114:115], v[214:215], v[214:215]
    v_pk_mul_f32 v[116:117], v[216:217], v[216:217]
    v_pk_mul_f32 v[118:119], v[218:219], v[218:219]
    v_pk_mul_f32 v[120:121], v[220:221], v[220:221]
    v_pk_mul_f32 v[122:123], v[222:223], v[222:223]
    v_pk_fma_f32 v[108:109], v[108:109], v[78:79], v[80:81] op_sel_hi:[1,0,0]
    v_pk_fma_f32 v[110:111], v[110:111], v[78:79], v[80:81] op_sel_hi:[1,0,0]
    v_pk_fma_f32 v[112:113], v[112:113], v[86:87], v[88:89] op_sel_hi:[1,0,0]
    v_pk_fma_f32 v[114:115], v[114:115], v[86:87], v[88:89] op_sel_hi:[1,0,0]
    v_pk_fma_f32 v[116:117], v[116:117], v[94:95], v[96:97] op_sel_hi:[1,0,0]
    v_pk_fma_f32 v[118:119], v[118:119], v[94:95], v[96:97] op_sel_hi:[1,0,0]
    v_pk_fma_f32 v[120:121], v[120:121], v[102:103], v[104:105] op_sel_hi:[1,0,0]
    v_pk_fma_f32 v[122:123], v[122:123], v[102:103], v[104:105] op_sel_hi:[1,0,0]
    v_pk_mul_f32 v[108:109], v[108:109], v[208:209]
    v_pk_mul_f32 v[110:111], v[110:111], v[210:211]
    v_pk_mul_f32 v[112:113], v[112:113], v[212:213]
    v_pk_mul_f32 v[114:115], v[114:115], v[214:215]
    v_pk_mul_f32 v[116:117], v[116:117], v[216:217]
    v_pk_mul_f32 v[118:119], v[118:119], v[218:219]
    v_pk_mul_f32 v[120:121], v[120:121], v[220:221]
    v_pk_mul_f32 v[122:123], v[122:123], v[222:223]
    v_exp_f32 v108, v108
    v_exp_f32 v109, v109
    v_exp_f32 v110, v110
    v_exp_f32 v111, v111
    v_exp_f32 v112, v112
    v_exp_f32 v113, v113
    v_exp_f32 v114, v114
    v_exp_f32 v115, v115
    v_exp_f32 v116, v116
    v_exp_f32 v117, v117
    v_exp_f32 v118, v118
    v_exp_f32 v119, v119
    v_exp_f32 v120, v120
    v_exp_f32 v121, v121
    v_exp_f32 v122, v122
    v_exp_f32 v123, v123
    v_pk_fma_f32 v[108:109], v[108:109], v[82:83], v[82:83] op_sel_hi:[1,0,0]
    v_pk_fma_f32 v[110:111], v[110:111], v[82:83], v[82:83] op_sel_hi:[1,0,0]
    v_pk_fma_f32 v[112:113], v[112:113], v[90:91], v[90:91] op_sel_hi:[1,0,0]
    v_pk_fma_f32 v[114:115], v[114:115], v[90:91], v[90:91] op_sel_hi:[1,0,0]
    v_pk_fma_f32 v[116:117], v[116:117], v[98:99], v[98:99] op_sel_hi:[1,0,0]
    v_pk_fma_f32 v[118:119], v[118:119], v[98:99], v[98:99] op_sel_hi:[1,0,0]
    v_pk_fma_f32 v[120:121], v[120:121], v[106:107], v[106:107] op_sel_hi:[1,0,0]
    v_pk_fma_f32 v[122:123], v[122:123], v[106:107], v[106:107] op_sel_hi:[1,0,0]
    v_rcp_f32 v108, v108
    v_rcp_f32 v109, v109
    v_rcp_f32 v110, v110
    v_rcp_f32 v111, v111
    v_rcp_f32 v112, v112
    v_rcp_f32 v113, v113
    v_rcp_f32 v114, v114
    v_rcp_f32 v115, v115
    v_rcp_f32 v116, v116
    v_rcp_f32 v117, v117
    v_rcp_f32 v118, v118
    v_rcp_f32 v119, v119
    v_rcp_f32 v120, v120
    v_rcp_f32 v121, v121
    v_rcp_f32 v122, v122
    v_rcp_f32 v123, v123
    v_pk_mul_f32 v[208:209], v[208:209], v[108:109]
    v_pk_mul_f32 v[210:211], v[210:211], v[110:111]
    v_pk_mul_f32 v[212:213], v[212:213], v[112:113]
    v_pk_mul_f32 v[214:215], v[214:215], v[114:115]
    v_pk_mul_f32 v[216:217], v[216:217], v[116:117]
    v_pk_mul_f32 v[218:219], v[218:219], v[118:119]
    v_pk_mul_f32 v[220:221], v[220:221], v[120:121]
    v_pk_mul_f32 v[222:223], v[222:223], v[122:123]
    v_cvt_pk_bf16_f32 v208, v208, v209
    v_cvt_pk_bf16_f32 v209, v210, v211
    v_cvt_pk_bf16_f32 v210, v212, v213
    v_cvt_pk_bf16_f32 v211, v214, v215
    v_cvt_pk_bf16_f32 v216, v216, v217
    v_cvt_pk_bf16_f32 v217, v218, v219
    v_cvt_pk_bf16_f32 v218, v220, v221
    v_cvt_pk_bf16_f32 v219, v222, v223
    v_permlane32_swap_b32 v208, v210
    v_permlane32_swap_b32 v209, v211
    v_permlane32_swap_b32 v216, v218
    v_permlane32_swap_b32 v217, v219
    buffer_store_dwordx4 v[208:211], v38, s[16:19], s42 offen offset:2048 sc1
    buffer_store_dwordx4 v[216:219], v38, s[16:19], s43 offen offset:2048 sc1
    s_waitcnt lgkmcnt(1)
    v_pk_fma_f32 v[224:225], v[68:69], v[76:77], v[224:225] op_sel_hi:[1,0,1] neg_lo:[1,0,0] neg_hi:[1,0,0]
    v_pk_fma_f32 v[226:227], v[70:71], v[76:77], v[226:227] op_sel_hi:[1,0,1] neg_lo:[1,0,0] neg_hi:[1,0,0]
    v_pk_fma_f32 v[228:229], v[68:69], v[84:85], v[228:229] op_sel_hi:[1,0,1] neg_lo:[1,0,0] neg_hi:[1,0,0]
    v_pk_fma_f32 v[230:231], v[70:71], v[84:85], v[230:231] op_sel_hi:[1,0,1] neg_lo:[1,0,0] neg_hi:[1,0,0]
    v_pk_fma_f32 v[232:233], v[68:69], v[92:93], v[232:233] op_sel_hi:[1,0,1] neg_lo:[1,0,0] neg_hi:[1,0,0]
    v_pk_fma_f32 v[234:235], v[70:71], v[92:93], v[234:235] op_sel_hi:[1,0,1] neg_lo:[1,0,0] neg_hi:[1,0,0]
    v_pk_fma_f32 v[236:237], v[68:69], v[100:101], v[236:237] op_sel_hi:[1,0,1] neg_lo:[1,0,0] neg_hi:[1,0,0]
    v_pk_fma_f32 v[238:239], v[70:71], v[100:101], v[238:239] op_sel_hi:[1,0,1] neg_lo:[1,0,0] neg_hi:[1,0,0]
    v_pk_mul_f32 v[124:125], v[224:225], v[224:225]
    v_pk_mul_f32 v[126:127], v[226:227], v[226:227]
    v_pk_mul_f32 v[128:129], v[228:229], v[228:229]
    v_pk_mul_f32 v[130:131], v[230:231], v[230:231]
    v_pk_mul_f32 v[132:133], v[232:233], v[232:233]
    v_pk_mul_f32 v[134:135], v[234:235], v[234:235]
    v_pk_mul_f32 v[136:137], v[236:237], v[236:237]
    v_pk_mul_f32 v[138:139], v[238:239], v[238:239]
    v_pk_fma_f32 v[124:125], v[124:125], v[78:79], v[80:81] op_sel_hi:[1,0,0]
    v_pk_fma_f32 v[126:127], v[126:127], v[78:79], v[80:81] op_sel_hi:[1,0,0]
    v_pk_fma_f32 v[128:129], v[128:129], v[86:87], v[88:89] op_sel_hi:[1,0,0]
    v_pk_fma_f32 v[130:131], v[130:131], v[86:87], v[88:89] op_sel_hi:[1,0,0]
    v_pk_fma_f32 v[132:133], v[132:133], v[94:95], v[96:97] op_sel_hi:[1,0,0]
    v_pk_fma_f32 v[134:135], v[134:135], v[94:95], v[96:97] op_sel_hi:[1,0,0]
    v_pk_fma_f32 v[136:137], v[136:137], v[102:103], v[104:105] op_sel_hi:[1,0,0]
    v_pk_fma_f32 v[138:139], v[138:139], v[102:103], v[104:105] op_sel_hi:[1,0,0]
    v_pk_mul_f32 v[124:125], v[124:125], v[224:225]
    v_pk_mul_f32 v[126:127], v[126:127], v[226:227]
    v_pk_mul_f32 v[128:129], v[128:129], v[228:229]
    v_pk_mul_f32 v[130:131], v[130:131], v[230:231]
    v_pk_mul_f32 v[132:133], v[132:133], v[232:233]
    v_pk_mul_f32 v[134:135], v[134:135], v[234:235]
    v_pk_mul_f32 v[136:137], v[136:137], v[236:237]
    v_pk_mul_f32 v[138:139], v[138:139], v[238:239]
    v_exp_f32 v124, v124
    v_exp_f32 v125, v125
    v_exp_f32 v126, v126
    v_exp_f32 v127, v127
    v_exp_f32 v128, v128
    v_exp_f32 v129, v129
    v_exp_f32 v130, v130
    v_exp_f32 v131, v131
    v_exp_f32 v132, v132
    v_exp_f32 v133, v133
    v_exp_f32 v134, v134
    v_exp_f32 v135, v135
    v_exp_f32 v136, v136
    v_exp_f32 v137, v137
    v_exp_f32 v138, v138
    v_exp_f32 v139, v139
    v_pk_fma_f32 v[124:125], v[124:125], v[82:83], v[82:83] op_sel_hi:[1,0,0]
    v_pk_fma_f32 v[126:127], v[126:127], v[82:83], v[82:83] op_sel_hi:[1,0,0]
    v_pk_fma_f32 v[128:129], v[128:129], v[90:91], v[90:91] op_sel_hi:[1,0,0]
    v_pk_fma_f32 v[130:131], v[130:131], v[90:91], v[90:91] op_sel_hi:[1,0,0]
    v_pk_fma_f32 v[132:133], v[132:133], v[98:99], v[98:99] op_sel_hi:[1,0,0]
    v_pk_fma_f32 v[134:135], v[134:135], v[98:99], v[98:99] op_sel_hi:[1,0,0]
    v_pk_fma_f32 v[136:137], v[136:137], v[106:107], v[106:107] op_sel_hi:[1,0,0]
    v_pk_fma_f32 v[138:139], v[138:139], v[106:107], v[106:107] op_sel_hi:[1,0,0]
    v_rcp_f32 v124, v124
    v_rcp_f32 v125, v125
    v_rcp_f32 v126, v126
    v_rcp_f32 v127, v127
    v_rcp_f32 v128, v128
    v_rcp_f32 v129, v129
    v_rcp_f32 v130, v130
    v_rcp_f32 v131, v131
    v_rcp_f32 v132, v132
    v_rcp_f32 v133, v133
    v_rcp_f32 v134, v134
    v_rcp_f32 v135, v135
    v_rcp_f32 v136, v136
    v_rcp_f32 v137, v137
    v_rcp_f32 v138, v138
    v_rcp_f32 v139, v139
    v_pk_mul_f32 v[224:225], v[224:225], v[124:125]
    v_pk_mul_f32 v[226:227], v[226:227], v[126:127]
    v_pk_mul_f32 v[228:229], v[228:229], v[128:129]
    v_pk_mul_f32 v[230:231], v[230:231], v[130:131]
    v_pk_mul_f32 v[232:233], v[232:233], v[132:133]
    v_pk_mul_f32 v[234:235], v[234:235], v[134:135]
    v_pk_mul_f32 v[236:237], v[236:237], v[136:137]
    v_pk_mul_f32 v[238:239], v[238:239], v[138:139]
    v_cvt_pk_bf16_f32 v224, v224, v225
    v_cvt_pk_bf16_f32 v225, v226, v227
    v_cvt_pk_bf16_f32 v226, v228, v229
    v_cvt_pk_bf16_f32 v227, v230, v231
    v_cvt_pk_bf16_f32 v232, v232, v233
    v_cvt_pk_bf16_f32 v233, v234, v235
    v_cvt_pk_bf16_f32 v234, v236, v237
    v_cvt_pk_bf16_f32 v235, v238, v239
    v_permlane32_swap_b32 v224, v226
    v_permlane32_swap_b32 v225, v227
    v_permlane32_swap_b32 v232, v234
    v_permlane32_swap_b32 v233, v235
    buffer_store_dwordx4 v[224:227], v38, s[16:19], s42 offen offset:2560 sc1
    buffer_store_dwordx4 v[232:235], v38, s[16:19], s43 offen offset:2560 sc1
    s_waitcnt lgkmcnt(0)
    v_pk_fma_f32 v[240:241], v[72:73], v[76:77], v[240:241] op_sel_hi:[1,0,1] neg_lo:[1,0,0] neg_hi:[1,0,0]
    v_pk_fma_f32 v[242:243], v[74:75], v[76:77], v[242:243] op_sel_hi:[1,0,1] neg_lo:[1,0,0] neg_hi:[1,0,0]
    v_pk_fma_f32 v[244:245], v[72:73], v[84:85], v[244:245] op_sel_hi:[1,0,1] neg_lo:[1,0,0] neg_hi:[1,0,0]
    v_pk_fma_f32 v[246:247], v[74:75], v[84:85], v[246:247] op_sel_hi:[1,0,1] neg_lo:[1,0,0] neg_hi:[1,0,0]
    v_pk_fma_f32 v[248:249], v[72:73], v[92:93], v[248:249] op_sel_hi:[1,0,1] neg_lo:[1,0,0] neg_hi:[1,0,0]
    v_pk_fma_f32 v[250:251], v[74:75], v[92:93], v[250:251] op_sel_hi:[1,0,1] neg_lo:[1,0,0] neg_hi:[1,0,0]
    v_pk_fma_f32 v[252:253], v[72:73], v[100:101], v[252:253] op_sel_hi:[1,0,1] neg_lo:[1,0,0] neg_hi:[1,0,0]
    v_pk_fma_f32 v[254:255], v[74:75], v[100:101], v[254:255] op_sel_hi:[1,0,1] neg_lo:[1,0,0] neg_hi:[1,0,0]
    v_pk_mul_f32 v[108:109], v[240:241], v[240:241]
    v_pk_mul_f32 v[110:111], v[242:243], v[242:243]
    v_pk_mul_f32 v[112:113], v[244:245], v[244:245]
    v_pk_mul_f32 v[114:115], v[246:247], v[246:247]
    v_pk_mul_f32 v[116:117], v[248:249], v[248:249]
    v_pk_mul_f32 v[118:119], v[250:251], v[250:251]
    v_pk_mul_f32 v[120:121], v[252:253], v[252:253]
    v_pk_mul_f32 v[122:123], v[254:255], v[254:255]
    v_pk_fma_f32 v[108:109], v[108:109], v[78:79], v[80:81] op_sel_hi:[1,0,0]
    v_pk_fma_f32 v[110:111], v[110:111], v[78:79], v[80:81] op_sel_hi:[1,0,0]
    v_pk_fma_f32 v[112:113], v[112:113], v[86:87], v[88:89] op_sel_hi:[1,0,0]
    v_pk_fma_f32 v[114:115], v[114:115], v[86:87], v[88:89] op_sel_hi:[1,0,0]
    v_pk_fma_f32 v[116:117], v[116:117], v[94:95], v[96:97] op_sel_hi:[1,0,0]
    v_pk_fma_f32 v[118:119], v[118:119], v[94:95], v[96:97] op_sel_hi:[1,0,0]
    v_pk_fma_f32 v[120:121], v[120:121], v[102:103], v[104:105] op_sel_hi:[1,0,0]
    v_pk_fma_f32 v[122:123], v[122:123], v[102:103], v[104:105] op_sel_hi:[1,0,0]
    v_pk_mul_f32 v[108:109], v[108:109], v[240:241]
    v_pk_mul_f32 v[110:111], v[110:111], v[242:243]
    v_pk_mul_f32 v[112:113], v[112:113], v[244:245]
    v_pk_mul_f32 v[114:115], v[114:115], v[246:247]
    v_pk_mul_f32 v[116:117], v[116:117], v[248:249]
    v_pk_mul_f32 v[118:119], v[118:119], v[250:251]
    v_pk_mul_f32 v[120:121], v[120:121], v[252:253]
    v_pk_mul_f32 v[122:123], v[122:123], v[254:255]
    v_exp_f32 v108, v108
    v_exp_f32 v109, v109
    v_exp_f32 v110, v110
    v_exp_f32 v111, v111
    v_exp_f32 v112, v112
    v_exp_f32 v113, v113
    v_exp_f32 v114, v114
    v_exp_f32 v115, v115
    v_exp_f32 v116, v116
    v_exp_f32 v117, v117
    v_exp_f32 v118, v118
    v_exp_f32 v119, v119
    v_exp_f32 v120, v120
    v_exp_f32 v121, v121
    v_exp_f32 v122, v122
    v_exp_f32 v123, v123
    v_pk_fma_f32 v[108:109], v[108:109], v[82:83], v[82:83] op_sel_hi:[1,0,0]
    v_pk_fma_f32 v[110:111], v[110:111], v[82:83], v[82:83] op_sel_hi:[1,0,0]
    v_pk_fma_f32 v[112:113], v[112:113], v[90:91], v[90:91] op_sel_hi:[1,0,0]
    v_pk_fma_f32 v[114:115], v[114:115], v[90:91], v[90:91] op_sel_hi:[1,0,0]
    v_pk_fma_f32 v[116:117], v[116:117], v[98:99], v[98:99] op_sel_hi:[1,0,0]
    v_pk_fma_f32 v[118:119], v[118:119], v[98:99], v[98:99] op_sel_hi:[1,0,0]
    v_pk_fma_f32 v[120:121], v[120:121], v[106:107], v[106:107] op_sel_hi:[1,0,0]
    v_pk_fma_f32 v[122:123], v[122:123], v[106:107], v[106:107] op_sel_hi:[1,0,0]
    v_rcp_f32 v108, v108
    v_rcp_f32 v109, v109
    v_rcp_f32 v110, v110
    v_rcp_f32 v111, v111
    v_rcp_f32 v112, v112
    v_rcp_f32 v113, v113
    v_rcp_f32 v114, v114
    v_rcp_f32 v115, v115
    v_rcp_f32 v116, v116
    v_rcp_f32 v117, v117
    v_rcp_f32 v118, v118
    v_rcp_f32 v119, v119
    v_rcp_f32 v120, v120
    v_rcp_f32 v121, v121
    v_rcp_f32 v122, v122
    v_rcp_f32 v123, v123
    v_pk_mul_f32 v[240:241], v[240:241], v[108:109]
    v_pk_mul_f32 v[242:243], v[242:243], v[110:111]
    v_pk_mul_f32 v[244:245], v[244:245], v[112:113]
    v_pk_mul_f32 v[246:247], v[246:247], v[114:115]
    v_pk_mul_f32 v[248:249], v[248:249], v[116:117]
    v_pk_mul_f32 v[250:251], v[250:251], v[118:119]
    v_pk_mul_f32 v[252:253], v[252:253], v[120:121]
    v_pk_mul_f32 v[254:255], v[254:255], v[122:123]
    v_cvt_pk_bf16_f32 v240, v240, v241
    v_cvt_pk_bf16_f32 v241, v242, v243
    v_cvt_pk_bf16_f32 v242, v244, v245
    v_cvt_pk_bf16_f32 v243, v246, v247
    v_cvt_pk_bf16_f32 v248, v248, v249
    v_cvt_pk_bf16_f32 v249, v250, v251
    v_cvt_pk_bf16_f32 v250, v252, v253
    v_cvt_pk_bf16_f32 v251, v254, v255
    v_permlane32_swap_b32 v240, v242
    v_permlane32_swap_b32 v241, v243
    v_permlane32_swap_b32 v248, v250
    v_permlane32_swap_b32 v249, v251
    buffer_store_dwordx4 v[240:243], v38, s[16:19], s42 offen offset:3072 sc1
    buffer_store_dwordx4 v[248:251], v38, s[16:19], s43 offen offset:3072 sc1
    s_mov_b32 s25, s24
    s_mov_b32 s43, s32
    s_waitcnt lgkmcnt(0)
    v_mov_b32 v136, 153352
    v_mov_b32 v137, 1
    s_mov_b64 exec, 1
    ds_add_u32 v136, v137
    s_mov_b64 exec, -1
    s_add_u32 s32, s32, 49152
    s_cmp_eq_u32 s32, 147456
    s_cselect_b32 s33, s39, 49152
    s_cselect_b32 s32, 0, s32
    s_mov_b32 s34, s32
    s_add_u32 s32, s32, 49152
    s_cmp_eq_u32 s32, 147456
    s_cselect_b32 s33, s39, 49152
    s_cselect_b32 s32, 0, s32
    s_mov_b32 s42, s32
    s_add_u32 s8, s86, 20971520
    s_addc_u32 s9, s87, 0
    s_mov_b32 s10, 18874368
    s_mov_b32 s11, 0x20000
    s_mov_b32 s12, s78
    s_mov_b32 s13, s79
    s_mov_b32 s14, 7340032
    s_mov_b32 s15, 0x20000
    s_lshl_b32 s3, s54, 3
    s_lshl_b32 s4, s25, 1
    s_add_u32 s3, s3, s4
    s_mul_i32 s3, s3, 147456
    s_mul_i32 s37, s25, 6144
    s_add_u32 s38, s37, 24576
    v_add_u32 v32, s3, v1
    v_add_u32 v35, 144384, v32
    v_add_u32 v36, 148480, v32
    v_lshrrev_b32 v128, 4, v0
    v_and_b32 v129, 15, v0
    v_lshlrev_b32 v130, 1, v128
    v_xor_b32 v129, v129, v130
    s_mul_i32 s3, s25, 24
    v_add_u32 v128, s3, v128
    v_lshlrev_b32 v128, 11, v128
    v_lshl_add_u32 v128, v129, 4, v128
    s_lshr_b32 s4, s55, 1
    s_lshl_b32 s4, s4, 8
    v_add_u32 v38, s4, v128
    v_xor_b32 v128, 128, v38
    v_add_u32 v39, 7168, v128
    v_add_u32 v40, 14336, v38
    v_add_u32 v41, 21504, v128
    v_add_u32 v42, 32768, v38
    v_add_u32 v43, 39936, v128
    s_and_b32 s3, s55, 1
    s_mul_i32 s35, s3, 55296
    s_mul_i32 s36, s3, 3538944
    s_lshr_b32 s3, s78, 7
    s_sub_u32 s3, 3, s3
    s_and_b32 s3, s3, 7
    s_lshr_b32 s4, s55, 1
    s_lshr_b32 s5, s3, 1
    s_sub_u32 s5, s4, s5
    s_and_b32 s5, s5, 3
    s_lshr_b32 s4, s4, 2
    s_lshl_b32 s4, s4, 10
    s_lshl_b32 s3, s3, 7
    s_add_u32 s4, s4, s3
    s_sub_u32 s6, s5, 1
    s_lshl_b32 s6, s6, 2
    s_and_b32 s3, s54, 3
    s_add_u32 s6, s6, s3
    s_lshl_b32 s6, s6, 2
    s_add_u32 s6, s6, s25
    s_lshl_b32 s6, s6, 12
    s_add_u32 s4, s4, s6
    s_add_u32 s4, s4, 196608
    s_cmp_eq_u32 s5, 0
    s_cselect_b32 s3, 0, 16
    s_cselect_b32 s99, 0x40000000, s4
    s_lshl_b32 s3, s51, 18
    s_add_u32 s3, s3, 4194304
    s_add_u32 s44, s86, s3
    s_addc_u32 s45, s87, 0
    s_mov_b32 s46, 0x40000
    s_mov_b32 s47, 0x20000
    s_lshl_b32 s4, s25, 10
    s_lshl_b32 s100, s41, 15
    s_add_u32 s100, s100, s4
    s_add_u32 s63, s4, 229376
    s_sub_u32 s3, s63, 32768
    s_cmp_ge_u32 s3, s100
    s_cselect_b32 s63, s63, s3
    s_add_u32 s48, s4, 147456
    s_waitcnt vmcnt(0)
    v_mov_b32 v136, 153364
    v_mov_b32 v137, 1
    s_mov_b64 exec, 1
    ds_add_rtn_u32 v136, v136, v137
    s_mov_b64 exec, -1
    s_waitcnt lgkmcnt(0)
    v_readfirstlane_b32 s3, v136
    s_nop 1
    s_and_b32 s3, s3, 3
    s_cmp_eq_u32 s3, 3
    s_cselect_b32 s3, s91, 62914560
    v_lshlrev_b32 v136, 2, v0
    s_mov_b64 exec, 15
    buffer_store_dword v137, v136, s[16:19], s3 offen sc1
    s_mov_b64 exec, -1
    s_add_u32 m0, s42, s38
    s_nop 0
    buffer_load_dwordx4 v38, s[12:15], s36 offen offset:0  lds
    buffer_load_dwordx4 v39, s[12:15], s36 offen offset:1024  lds
    buffer_load_dwordx4 v40, s[12:15], s36 offen offset:2048  lds
    buffer_load_dwordx4 v41, s[12:15], s36 offen offset:3072  lds
    s_add_u32 m0, m0, 4096
    s_nop 0
    buffer_load_dwordx4 v42, s[12:15], s36 offen offset:0  lds
    buffer_load_dwordx4 v43, s[12:15], s36 offen offset:1024  lds
    s_add_u32 s36, s36, 196608
    s_getpc_b64 s[4:5]
gated_mix__softmax_full_mha__mixer_s_mlp__prompt_kernel_pc80:
    s_sub_u32 s4, s4, gated_mix__softmax_full_mha__mixer_s_mlp__prompt_kernel_pc80-gated_mix__softmax_full_mha__mixer_s_mlp__prompt_kernel
    s_subb_u32 s5, s5, 0
    s_lshl_b32 s3, s28, 11
    s_and_b32 s6, s24, 3
    s_lshl_b32 s6, s6, 9
    s_add_u32 s3, s3, s6
    v_lshl_add_u32 v136, v0, 3, s3
    s_mov_b32 s3, gated_mix__softmax_full_mha__mixer_s_mlp__prompt_kernel_end-gated_mix__softmax_full_mha__mixer_s_mlp__prompt_kernel
    v_min_u32 v136, s3, v136
    v_mov_b32 v137, s5
    v_add_co_u32 v136, vcc, s4, v136
    s_nop 1
    v_addc_co_u32 v137, vcc, 0, v137, vcc
    global_load_dword v138, v[136:137], off
    v_mov_b32 v139, 153352
    s_mov_b32 s5, 1600000
gated_mix__softmax_full_mha__mixer_s_mlp__prompt_kernel_fr81:
    ds_read_b32 v137, v139
    s_sub_u32 s5, s5, 1
    s_cmp_eq_u32 s5, 0
    s_cbranch_scc1 gated_mix__softmax_full_mha__mixer_s_mlp__prompt_kernel_fre82
    s_waitcnt lgkmcnt(0)
    v_cmp_gt_u32 vcc, 16, v137
    s_nop 4
    s_cbranch_vccz gated_mix__softmax_full_mha__mixer_s_mlp__prompt_kernel_fre82
    s_sleep 2
    s_branch gated_mix__softmax_full_mha__mixer_s_mlp__prompt_kernel_fr81
gated_mix__softmax_full_mha__mixer_s_mlp__prompt_kernel_fre82:
    s_lshr_b32 s3, s42, 3
    s_add_u32 m0, s3, s48
    s_nop 0
    buffer_load_dwordx4 v1, s[44:47], s63 offen sc1 lds
    s_add_u32 s63, s63, 4096
    s_cmp_eq_u32 s63, s100
    s_cselect_b32 s3, 32768, 0
    s_add_u32 s63, s63, s3
    s_lshr_b32 s3, s43, 3
    s_add_u32 m0, s3, s48
    s_nop 0
    buffer_load_dwordx4 v1, s[44:47], s63 offen sc1 lds
    s_add_u32 s63, s63, 4096
    s_cmp_eq_u32 s63, s100
    s_cselect_b32 s3, 32768, 0
    s_add_u32 s63, s63, s3
    s_add_u32 m0, s43, s38
    s_nop 0
    buffer_load_dwordx4 v38, s[12:15], s36 offen offset:0  lds
    buffer_load_dwordx4 v39, s[12:15], s36 offen offset:1024  lds
    buffer_load_dwordx4 v40, s[12:15], s36 offen offset:2048  lds
    buffer_load_dwordx4 v41, s[12:15], s36 offen offset:3072  lds
    s_add_u32 m0, m0, 4096
    s_nop 0
    buffer_load_dwordx4 v42, s[12:15], s36 offen offset:0  lds
    buffer_load_dwordx4 v43, s[12:15], s36 offen offset:1024  lds
    s_add_u32 s36, s36, 196608
    v_mov_b32 v139, 153344
    s_cmp_eq_u32 s24, 0
    s_cbranch_scc0 gated_mix__softmax_full_mha__mixer_s_mlp__prompt_kernel_gw83
    v_and_b32 v136, 15, v0
    s_lshr_b32 s3, s54, 0
    s_lshl_b32 s3, s3, 4
    v_add_u32 v136, s3, v136
    v_lshlrev_b32 v136, 7, v136
    s_mov_b32 s40, 45711360
    buffer_load_dwordx4 v[140:143], v136, s[16:19], s40 offen sc1
    s_mov_b32 s5, 100000
gated_mix__softmax_full_mha__mixer_s_mlp__prompt_kernel_poll86:
    s_waitcnt vmcnt(0) lgkmcnt(0)
    v_min3_u32 v137, v140, v141, v142
    v_min_u32 v137, v137, v143
    v_cmp_eq_u32 vcc, 0, v137
    s_nop 4
    s_cbranch_vccz gated_mix__softmax_full_mha__mixer_s_mlp__prompt_kernel_pollx87
    s_sub_u32 s5, s5, 1
    s_cmp_eq_u32 s5, 0
    s_cbranch_scc1 gated_mix__softmax_full_mha__mixer_s_mlp__prompt_kernel_pollx87
    s_sleep 4
    s_mov_b64 exec, vcc
    buffer_load_dwordx4 v[140:143], v136, s[16:19], s40 offen sc1
    s_mov_b64 exec, -1
    s_waitcnt vmcnt(0)
    s_branch gated_mix__softmax_full_mha__mixer_s_mlp__prompt_kernel_poll86
gated_mix__softmax_full_mha__mixer_s_mlp__prompt_kernel_pollx87:
    v_mov_b32 v139, 153344
    v_mov_b32 v137, 4
    ds_write_b32 v139, v137
    s_branch gated_mix__softmax_full_mha__mixer_s_mlp__prompt_kernel_gwe84
gated_mix__softmax_full_mha__mixer_s_mlp__prompt_kernel_gw83:
    s_mov_b32 s5, 1600000
gated_mix__softmax_full_mha__mixer_s_mlp__prompt_kernel_gws85:
    s_sleep 1
    s_waitcnt lgkmcnt(0)
    ds_read_b32 v137, v139
    s_sub_u32 s5, s5, 1
    s_cmp_eq_u32 s5, 0
    s_cbranch_scc1 gated_mix__softmax_full_mha__mixer_s_mlp__prompt_kernel_gwe84
    s_waitcnt lgkmcnt(0)
    v_cmp_gt_u32 vcc, 4, v137
    s_nop 4
    s_cbranch_vccnz gated_mix__softmax_full_mha__mixer_s_mlp__prompt_kernel_gws85
gated_mix__softmax_full_mha__mixer_s_mlp__prompt_kernel_gwe84:
    s_add_u32 m0, s42, s37
    s_nop 0
    buffer_load_dwordx4 v32, s[8:11], s35 offen offset:0 sc1 lds
    buffer_load_dwordx4 v32, s[8:11], s35 offen offset:1024 sc1 lds
    buffer_load_dwordx4 v32, s[8:11], s35 offen offset:2048 sc1 lds
    buffer_load_dwordx4 v35, s[8:11], s35 offen offset:3072 sc1 lds
    s_add_u32 m0, m0, 4096
    s_nop 0
    buffer_load_dwordx4 v36, s[8:11], s35 offen offset:0 sc1 lds
    buffer_load_dwordx4 v36, s[8:11], s35 offen offset:1024 sc1 lds
    s_add_u32 s35, s35, 3072
    s_add_u32 m0, s43, s37
    s_nop 0
    buffer_load_dwordx4 v32, s[8:11], s35 offen offset:0 sc1 lds
    buffer_load_dwordx4 v32, s[8:11], s35 offen offset:1024 sc1 lds
    buffer_load_dwordx4 v32, s[8:11], s35 offen offset:2048 sc1 lds
    buffer_load_dwordx4 v35, s[8:11], s35 offen offset:3072 sc1 lds
    s_add_u32 m0, m0, 4096
    s_nop 0
    buffer_load_dwordx4 v36, s[8:11], s35 offen offset:0 sc1 lds
    buffer_load_dwordx4 v36, s[8:11], s35 offen offset:1024 sc1 lds
    s_add_u32 s35, s35, 3072
    s_lshl_b32 s3, s2, 2
    s_and_b32 s4, s24, 3
    s_add_u32 s3, s3, s4
    s_mov_b32 m0, 158720
    s_mov_b32 s20, s68
    s_mov_b32 s21, s69
    s_mov_b32 s22, 2097152
    s_mov_b32 s23, 0x20000
    s_mul_i32 s5, s3, 2048
    buffer_load_dwordx4 v[4:7], v1, s[20:23], s5 offen
    s_add_u32 s5, s5, 1024
    buffer_load_dwordx4 v[8:11], v1, s[20:23], s5 offen
    s_setprio 0
    s_and_b32 s25, s24, 1
    v_lshrrev_b32 v129, 4, v0
    v_bfe_u32 v130, v0, 2, 2
    v_and_b32 v131, 3, v0
    s_mul_i32 s3, s25, 12288
    s_add_u32 s3, s3, s32
    v_add_u32 v32, s3, v1
    v_and_b32 v133, 1, v129
    v_lshl_add_u32 v133, v133, 2, v130
    v_lshrrev_b32 v132, 1, v129
    v_lshl_add_u32 v132, v132, 4, v133
    v_lshlrev_b32 v132, 8, v132
    v_lshl_add_u32 v132, v131, 3, v132
    s_add_u32 s3, s32, 24576
    v_add_u32 v132, s3, v132
    s_and_b32 s3, s55, 1
    s_lshl_b32 s3, s3, 2
    s_lshl_b32 s4, s26, 1
    s_add_u32 s3, s3, s4
    v_xor_b32 v134, s3, v133
    v_lshl_add_u32 v35, v134, 5, v132
    v_xor_b32 v36, 32, v35
    v_xor_b32 v33, 128, v35
    v_xor_b32 v34, 160, v35
    s_waitcnt vmcnt(8)
    s_barrier
    ds_read_b128 v[48:51], v32 offset:0
    ds_read_b128 v[52:55], v32 offset:1024
    ds_read_b128 v[56:59], v32 offset:2048
    ds_read_b64_tr_b16 v[144:145], v33 offset:0
    ds_read_b64_tr_b16 v[146:147], v33 offset:2048
    ds_read_b64_tr_b16 v[148:149], v33 offset:8192
    ds_read_b64_tr_b16 v[150:151], v33 offset:10240
    ds_read_b64_tr_b16 v[152:153], v33 offset:16384
    ds_read_b64_tr_b16 v[154:155], v33 offset:18432
    ds_read_b128 v[60:63], v32 offset:3072
    ds_read_b128 v[64:67], v32 offset:4096
    ds_read_b128 v[68:71], v32 offset:5120
    ds_read_b128 v[72:75], v32 offset:6144
    ds_read_b128 v[76:79], v32 offset:7168
    ds_read_b128 v[80:83], v32 offset:8192
    ds_read_b128 v[84:87], v32 offset:9216
    ds_read_b128 v[88:91], v32 offset:10240
    ds_read_b128 v[92:95], v32 offset:11264
    ds_read_b64_tr_b16 v[156:157], v34 offset:0
    ds_read_b64_tr_b16 v[158:159], v34 offset:2048
    ds_read_b64_tr_b16 v[160:161], v34 offset:8192
    ds_read_b64_tr_b16 v[162:163], v34 offset:10240
    ds_read_b64_tr_b16 v[164:165], v34 offset:16384
    ds_read_b64_tr_b16 v[166:167], v34 offset:18432
    s_mov_b32 s31, 22
    s_waitcnt lgkmcnt(12)
    v_mfma_f32_16x16x32_bf16 v[192:195], v[144:147], v[48:51], 0
    ds_read_b64_tr_b16 v[168:169], v35 offset:0
    v_mfma_f32_16x16x32_bf16 v[192:195], v[148:151], v[52:55], v[192:195]
    ds_read_b64_tr_b16 v[170:171], v35 offset:2048
    v_mfma_f32_16x16x32_bf16 v[192:195], v[152:155], v[56:59], v[192:195]
    ds_read_b64_tr_b16 v[172:173], v35 offset:8192
    v_mfma_f32_16x16x32_bf16 v[196:199], v[152:155], v[68:71], 0
    ds_read_b64_tr_b16 v[174:175], v35 offset:10240
    v_mfma_f32_16x16x32_bf16 v[196:199], v[148:151], v[64:67], v[196:199]
    ds_read_b64_tr_b16 v[176:177], v35 offset:16384
    v_mfma_f32_16x16x32_bf16 v[196:199], v[144:147], v[60:63], v[196:199]
    ds_read_b64_tr_b16 v[178:179], v35 offset:18432
    s_waitcnt lgkmcnt(15)
    v_mfma_f32_16x16x32_bf16 v[200:203], v[144:147], v[72:75], 0
    s_add_u32 s32, s32, 49152
    v_mfma_f32_16x16x32_bf16 v[200:203], v[148:151], v[76:79], v[200:203]
    s_cmp_eq_u32 s32, 147456
    v_mfma_f32_16x16x32_bf16 v[200:203], v[152:155], v[80:83], v[200:203]
    s_cselect_b32 s33, s39, 49152
    s_waitcnt lgkmcnt(12)
    v_mfma_f32_16x16x32_bf16 v[204:207], v[152:155], v[92:95], 0
    s_cselect_b32 s32, 0, s32
    v_mfma_f32_16x16x32_bf16 v[204:207], v[148:151], v[88:91], v[204:207]
    v_mfma_f32_16x16x32_bf16 v[204:207], v[144:147], v[84:87], v[204:207]
    s_waitcnt lgkmcnt(6)
    v_mfma_f32_16x16x32_bf16 v[220:223], v[156:159], v[84:87], 0
    ds_read_b64_tr_b16 v[180:181], v36 offset:0
    v_mfma_f32_16x16x32_bf16 v[220:223], v[160:163], v[88:91], v[220:223]
    ds_read_b64_tr_b16 v[182:183], v36 offset:2048
    v_mfma_f32_16x16x32_bf16 v[220:223], v[164:167], v[92:95], v[220:223]
    ds_read_b64_tr_b16 v[184:185], v36 offset:8192
    v_mfma_f32_16x16x32_bf16 v[216:219], v[164:167], v[80:83], 0
    ds_read_b64_tr_b16 v[186:187], v36 offset:10240
    v_mfma_f32_16x16x32_bf16 v[216:219], v[160:163], v[76:79], v[216:219]
    ds_read_b64_tr_b16 v[188:189], v36 offset:16384
    v_mfma_f32_16x16x32_bf16 v[216:219], v[156:159], v[72:75], v[216:219]
    ds_read_b64_tr_b16 v[190:191], v36 offset:18432
    v_mfma_f32_16x16x32_bf16 v[212:215], v[156:159], v[60:63], 0
    v_add_u32 v32, s33, v32
    v_mfma_f32_16x16x32_bf16 v[212:215], v[160:163], v[64:67], v[212:215]
    v_add_u32 v33, s33, v33
    v_mfma_f32_16x16x32_bf16 v[212:215], v[164:167], v[68:71], v[212:215]
    v_add_u32 v34, s33, v34
    v_mfma_f32_16x16x32_bf16 v[208:211], v[164:167], v[56:59], 0
    v_add_u32 v35, s33, v35
    v_mfma_f32_16x16x32_bf16 v[208:211], v[160:163], v[52:55], v[208:211]
    v_add_u32 v36, s33, v36
    v_mfma_f32_16x16x32_bf16 v[208:211], v[156:159], v[48:51], v[208:211]
    s_waitcnt vmcnt(2) lgkmcnt(0)
    s_barrier
    v_mfma_f32_16x16x32_bf16 v[224:227], v[168:171], v[48:51], 0
    ds_read_b128 v[96:99], v32 offset:0
    v_mfma_f32_16x16x32_bf16 v[224:227], v[172:175], v[52:55], v[224:227]
    ds_read_b128 v[100:103], v32 offset:1024
    v_mfma_f32_16x16x32_bf16 v[224:227], v[176:179], v[56:59], v[224:227]
    ds_read_b128 v[104:107], v32 offset:2048
    v_mfma_f32_16x16x32_bf16 v[228:231], v[176:179], v[68:71], 0
    ds_read_b64_tr_b16 v[144:145], v33 offset:0
    v_mfma_f32_16x16x32_bf16 v[228:231], v[172:175], v[64:67], v[228:231]
    ds_read_b64_tr_b16 v[146:147], v33 offset:2048
    v_mfma_f32_16x16x32_bf16 v[228:231], v[168:171], v[60:63], v[228:231]
    ds_read_b64_tr_b16 v[148:149], v33 offset:8192
    v_mfma_f32_16x16x32_bf16 v[232:235], v[168:171], v[72:75], 0
    ds_read_b64_tr_b16 v[150:151], v33 offset:10240
    v_mfma_f32_16x16x32_bf16 v[232:235], v[172:175], v[76:79], v[232:235]
    ds_read_b64_tr_b16 v[152:153], v33 offset:16384
    v_mfma_f32_16x16x32_bf16 v[232:235], v[176:179], v[80:83], v[232:235]
    ds_read_b64_tr_b16 v[154:155], v33 offset:18432
    v_mfma_f32_16x16x32_bf16 v[236:239], v[176:179], v[92:95], 0
    ds_read_b128 v[108:111], v32 offset:3072
    v_mfma_f32_16x16x32_bf16 v[236:239], v[172:175], v[88:91], v[236:239]
    ds_read_b128 v[112:115], v32 offset:4096
    v_mfma_f32_16x16x32_bf16 v[236:239], v[168:171], v[84:87], v[236:239]
    ds_read_b128 v[116:119], v32 offset:5120
    v_mfma_f32_16x16x32_bf16 v[252:255], v[180:183], v[84:87], 0
    ds_read_b128 v[120:123], v32 offset:6144
    v_mfma_f32_16x16x32_bf16 v[252:255], v[184:187], v[88:91], v[252:255]
    ds_read_b128 v[124:127], v32 offset:7168
    v_mfma_f32_16x16x32_bf16 v[252:255], v[188:191], v[92:95], v[252:255]
    ds_read_b128 v[128:131], v32 offset:8192
    v_mfma_f32_16x16x32_bf16 v[248:251], v[188:191], v[80:83], 0
    ds_read_b128 v[132:135], v32 offset:9216
    v_mfma_f32_16x16x32_bf16 v[248:251], v[184:187], v[76:79], v[248:251]
    ds_read_b128 v[136:139], v32 offset:10240
    v_mfma_f32_16x16x32_bf16 v[248:251], v[180:183], v[72:75], v[248:251]
    ds_read_b128 v[140:143], v32 offset:11264
    v_mfma_f32_16x16x32_bf16 v[244:247], v[180:183], v[60:63], 0
    ds_read_b64_tr_b16 v[156:157], v34 offset:0
    v_mfma_f32_16x16x32_bf16 v[244:247], v[184:187], v[64:67], v[244:247]
    ds_read_b64_tr_b16 v[158:159], v34 offset:2048
    v_mfma_f32_16x16x32_bf16 v[244:247], v[188:191], v[68:71], v[244:247]
    ds_read_b64_tr_b16 v[160:161], v34 offset:8192
    v_mfma_f32_16x16x32_bf16 v[240:243], v[188:191], v[56:59], 0
    ds_read_b64_tr_b16 v[162:163], v34 offset:10240
    v_mfma_f32_16x16x32_bf16 v[240:243], v[184:187], v[52:55], v[240:243]
    ds_read_b64_tr_b16 v[164:165], v34 offset:16384
    v_mfma_f32_16x16x32_bf16 v[240:243], v[180:183], v[48:51], v[240:243]
    ds_read_b64_tr_b16 v[166:167], v34 offset:18432
    .p2align 5
gated_mix__softmax_full_mha__mixer_s_mlp__prompt_kernel_gl88:
    s_waitcnt lgkmcnt(12)
    v_mfma_f32_16x16x32_bf16 v[192:195], v[144:147], v[96:99], v[192:195]
    ds_read_b64_tr_b16 v[168:169], v35 offset:0
    v_mfma_f32_16x16x32_bf16 v[192:195], v[148:151], v[100:103], v[192:195]
    ds_read_b64_tr_b16 v[170:171], v35 offset:2048
    v_mfma_f32_16x16x32_bf16 v[192:195], v[152:155], v[104:107], v[192:195]
    ds_read_b64_tr_b16 v[172:173], v35 offset:8192
    v_mfma_f32_16x16x32_bf16 v[196:199], v[152:155], v[116:119], v[196:199]
    ds_read_b64_tr_b16 v[174:175], v35 offset:10240
    v_mfma_f32_16x16x32_bf16 v[196:199], v[148:151], v[112:115], v[196:199]
    ds_read_b64_tr_b16 v[176:177], v35 offset:16384
    v_mfma_f32_16x16x32_bf16 v[196:199], v[144:147], v[108:111], v[196:199]
    ds_read_b64_tr_b16 v[178:179], v35 offset:18432
    s_waitcnt lgkmcnt(15)
    v_mfma_f32_16x16x32_bf16 v[200:203], v[144:147], v[120:123], v[200:203]
    s_add_u32 s32, s32, 49152
    v_mfma_f32_16x16x32_bf16 v[200:203], v[148:151], v[124:127], v[200:203]
    s_cmp_eq_u32 s32, 147456
    v_mfma_f32_16x16x32_bf16 v[200:203], v[152:155], v[128:131], v[200:203]
    s_cselect_b32 s33, s39, 49152
    s_waitcnt lgkmcnt(12)
    v_mfma_f32_16x16x32_bf16 v[204:207], v[152:155], v[140:143], v[204:207]
    s_cselect_b32 s32, 0, s32
    v_mfma_f32_16x16x32_bf16 v[204:207], v[148:151], v[136:139], v[204:207]
    v_mfma_f32_16x16x32_bf16 v[204:207], v[144:147], v[132:135], v[204:207]
    s_waitcnt lgkmcnt(6)
    v_mfma_f32_16x16x32_bf16 v[220:223], v[156:159], v[132:135], v[220:223]
    ds_read_b64_tr_b16 v[180:181], v36 offset:0
    v_mfma_f32_16x16x32_bf16 v[220:223], v[160:163], v[136:139], v[220:223]
    ds_read_b64_tr_b16 v[182:183], v36 offset:2048
    v_mfma_f32_16x16x32_bf16 v[220:223], v[164:167], v[140:143], v[220:223]
    ds_read_b64_tr_b16 v[184:185], v36 offset:8192
    v_mfma_f32_16x16x32_bf16 v[216:219], v[164:167], v[128:131], v[216:219]
    ds_read_b64_tr_b16 v[186:187], v36 offset:10240
    v_mfma_f32_16x16x32_bf16 v[216:219], v[160:163], v[124:127], v[216:219]
    ds_read_b64_tr_b16 v[188:189], v36 offset:16384
    v_mfma_f32_16x16x32_bf16 v[216:219], v[156:159], v[120:123], v[216:219]
    ds_read_b64_tr_b16 v[190:191], v36 offset:18432
    v_mfma_f32_16x16x32_bf16 v[212:215], v[156:159], v[108:111], v[212:215]
    v_add_u32 v32, s33, v32
    v_mfma_f32_16x16x32_bf16 v[212:215], v[160:163], v[112:115], v[212:215]
    v_add_u32 v33, s33, v33
    v_mfma_f32_16x16x32_bf16 v[212:215], v[164:167], v[116:119], v[212:215]
    v_add_u32 v34, s33, v34
    v_mfma_f32_16x16x32_bf16 v[208:211], v[164:167], v[104:107], v[208:211]
    v_add_u32 v35, s33, v35
    v_mfma_f32_16x16x32_bf16 v[208:211], v[160:163], v[100:103], v[208:211]
    v_add_u32 v36, s33, v36
    v_mfma_f32_16x16x32_bf16 v[208:211], v[156:159], v[96:99], v[208:211]
    s_waitcnt lgkmcnt(0)
    s_barrier
    v_mfma_f32_16x16x32_bf16 v[224:227], v[168:171], v[96:99], v[224:227]
    ds_read_b128 v[48:51], v32 offset:0
    v_mfma_f32_16x16x32_bf16 v[224:227], v[172:175], v[100:103], v[224:227]
    ds_read_b128 v[52:55], v32 offset:1024
    v_mfma_f32_16x16x32_bf16 v[224:227], v[176:179], v[104:107], v[224:227]
    ds_read_b128 v[56:59], v32 offset:2048
    v_mfma_f32_16x16x32_bf16 v[228:231], v[176:179], v[116:119], v[228:231]
    ds_read_b64_tr_b16 v[144:145], v33 offset:0
    v_mfma_f32_16x16x32_bf16 v[228:231], v[172:175], v[112:115], v[228:231]
    ds_read_b64_tr_b16 v[146:147], v33 offset:2048
    v_mfma_f32_16x16x32_bf16 v[228:231], v[168:171], v[108:111], v[228:231]
    ds_read_b64_tr_b16 v[148:149], v33 offset:8192
    v_mfma_f32_16x16x32_bf16 v[232:235], v[168:171], v[120:123], v[232:235]
    ds_read_b64_tr_b16 v[150:151], v33 offset:10240
    v_mfma_f32_16x16x32_bf16 v[232:235], v[172:175], v[124:127], v[232:235]
    ds_read_b64_tr_b16 v[152:153], v33 offset:16384
    v_mfma_f32_16x16x32_bf16 v[232:235], v[176:179], v[128:131], v[232:235]
    ds_read_b64_tr_b16 v[154:155], v33 offset:18432
    v_mfma_f32_16x16x32_bf16 v[236:239], v[176:179], v[140:143], v[236:239]
    ds_read_b128 v[60:63], v32 offset:3072
    v_mfma_f32_16x16x32_bf16 v[236:239], v[172:175], v[136:139], v[236:239]
    ds_read_b128 v[64:67], v32 offset:4096
    v_mfma_f32_16x16x32_bf16 v[236:239], v[168:171], v[132:135], v[236:239]
    ds_read_b128 v[68:71], v32 offset:5120
    v_mfma_f32_16x16x32_bf16 v[252:255], v[180:183], v[132:135], v[252:255]
    ds_read_b128 v[72:75], v32 offset:6144
    v_mfma_f32_16x16x32_bf16 v[252:255], v[184:187], v[136:139], v[252:255]
    ds_read_b128 v[76:79], v32 offset:7168
    v_mfma_f32_16x16x32_bf16 v[252:255], v[188:191], v[140:143], v[252:255]
    ds_read_b128 v[80:83], v32 offset:8192
    v_mfma_f32_16x16x32_bf16 v[248:251], v[188:191], v[128:131], v[248:251]
    ds_read_b128 v[84:87], v32 offset:9216
    v_mfma_f32_16x16x32_bf16 v[248:251], v[184:187], v[124:127], v[248:251]
    ds_read_b128 v[88:91], v32 offset:10240
    v_mfma_f32_16x16x32_bf16 v[248:251], v[180:183], v[120:123], v[248:251]
    ds_read_b128 v[92:95], v32 offset:11264
    v_mfma_f32_16x16x32_bf16 v[244:247], v[180:183], v[108:111], v[244:247]
    ds_read_b64_tr_b16 v[156:157], v34 offset:0
    v_mfma_f32_16x16x32_bf16 v[244:247], v[184:187], v[112:115], v[244:247]
    ds_read_b64_tr_b16 v[158:159], v34 offset:2048
    v_mfma_f32_16x16x32_bf16 v[244:247], v[188:191], v[116:119], v[244:247]
    ds_read_b64_tr_b16 v[160:161], v34 offset:8192
    v_mfma_f32_16x16x32_bf16 v[240:243], v[188:191], v[104:107], v[240:243]
    ds_read_b64_tr_b16 v[162:163], v34 offset:10240
    v_mfma_f32_16x16x32_bf16 v[240:243], v[184:187], v[100:103], v[240:243]
    ds_read_b64_tr_b16 v[164:165], v34 offset:16384
    v_mfma_f32_16x16x32_bf16 v[240:243], v[180:183], v[96:99], v[240:243]
    ds_read_b64_tr_b16 v[166:167], v34 offset:18432
gated_mix__softmax_full_mha__mixer_s_mlp__prompt_kernel_ge89:
    s_waitcnt lgkmcnt(12)
    v_mfma_f32_16x16x32_bf16 v[192:195], v[144:147], v[48:51], v[192:195]
    ds_read_b64_tr_b16 v[168:169], v35 offset:0
    v_mfma_f32_16x16x32_bf16 v[192:195], v[148:151], v[52:55], v[192:195]
    ds_read_b64_tr_b16 v[170:171], v35 offset:2048
    v_mfma_f32_16x16x32_bf16 v[192:195], v[152:155], v[56:59], v[192:195]
    ds_read_b64_tr_b16 v[172:173], v35 offset:8192
    v_mfma_f32_16x16x32_bf16 v[196:199], v[152:155], v[68:71], v[196:199]
    ds_read_b64_tr_b16 v[174:175], v35 offset:10240
    v_mfma_f32_16x16x32_bf16 v[196:199], v[148:151], v[64:67], v[196:199]
    ds_read_b64_tr_b16 v[176:177], v35 offset:16384
    v_mfma_f32_16x16x32_bf16 v[196:199], v[144:147], v[60:63], v[196:199]
    ds_read_b64_tr_b16 v[178:179], v35 offset:18432
    s_waitcnt lgkmcnt(15)
    v_mfma_f32_16x16x32_bf16 v[200:203], v[144:147], v[72:75], v[200:203]
    s_add_u32 s32, s32, 49152
    v_mfma_f32_16x16x32_bf16 v[200:203], v[148:151], v[76:79], v[200:203]
    s_cmp_eq_u32 s32, 147456
    v_mfma_f32_16x16x32_bf16 v[200:203], v[152:155], v[80:83], v[200:203]
    s_cselect_b32 s33, s39, 49152
    s_waitcnt lgkmcnt(12)
    v_mfma_f32_16x16x32_bf16 v[204:207], v[152:155], v[92:95], v[204:207]
    s_cselect_b32 s32, 0, s32
    v_mfma_f32_16x16x32_bf16 v[204:207], v[148:151], v[88:91], v[204:207]
    v_mfma_f32_16x16x32_bf16 v[204:207], v[144:147], v[84:87], v[204:207]
    s_waitcnt lgkmcnt(6)
    v_mfma_f32_16x16x32_bf16 v[220:223], v[156:159], v[84:87], v[220:223]
    ds_read_b64_tr_b16 v[180:181], v36 offset:0
    v_mfma_f32_16x16x32_bf16 v[220:223], v[160:163], v[88:91], v[220:223]
    ds_read_b64_tr_b16 v[182:183], v36 offset:2048
    v_mfma_f32_16x16x32_bf16 v[220:223], v[164:167], v[92:95], v[220:223]
    ds_read_b64_tr_b16 v[184:185], v36 offset:8192
    v_mfma_f32_16x16x32_bf16 v[216:219], v[164:167], v[80:83], v[216:219]
    ds_read_b64_tr_b16 v[186:187], v36 offset:10240
    v_mfma_f32_16x16x32_bf16 v[216:219], v[160:163], v[76:79], v[216:219]
    ds_read_b64_tr_b16 v[188:189], v36 offset:16384
    v_mfma_f32_16x16x32_bf16 v[216:219], v[156:159], v[72:75], v[216:219]
    ds_read_b64_tr_b16 v[190:191], v36 offset:18432
    v_mfma_f32_16x16x32_bf16 v[212:215], v[156:159], v[60:63], v[212:215]
    v_add_u32 v32, s33, v32
    v_mfma_f32_16x16x32_bf16 v[212:215], v[160:163], v[64:67], v[212:215]
    v_add_u32 v33, s33, v33
    v_mfma_f32_16x16x32_bf16 v[212:215], v[164:167], v[68:71], v[212:215]
    v_add_u32 v34, s33, v34
    v_mfma_f32_16x16x32_bf16 v[208:211], v[164:167], v[56:59], v[208:211]
    v_add_u32 v35, s33, v35
    v_mfma_f32_16x16x32_bf16 v[208:211], v[160:163], v[52:55], v[208:211]
    v_add_u32 v36, s33, v36
    v_mfma_f32_16x16x32_bf16 v[208:211], v[156:159], v[48:51], v[208:211]
    s_waitcnt lgkmcnt(0)
    s_barrier
    v_mfma_f32_16x16x32_bf16 v[224:227], v[168:171], v[48:51], v[224:227]
    ds_read_b128 v[96:99], v32 offset:0
    v_mfma_f32_16x16x32_bf16 v[224:227], v[172:175], v[52:55], v[224:227]
    ds_read_b128 v[100:103], v32 offset:1024
    v_mfma_f32_16x16x32_bf16 v[224:227], v[176:179], v[56:59], v[224:227]
    ds_read_b128 v[104:107], v32 offset:2048
    v_mfma_f32_16x16x32_bf16 v[228:231], v[176:179], v[68:71], v[228:231]
    ds_read_b64_tr_b16 v[144:145], v33 offset:0
    v_mfma_f32_16x16x32_bf16 v[228:231], v[172:175], v[64:67], v[228:231]
    ds_read_b64_tr_b16 v[146:147], v33 offset:2048
    v_mfma_f32_16x16x32_bf16 v[228:231], v[168:171], v[60:63], v[228:231]
    ds_read_b64_tr_b16 v[148:149], v33 offset:8192
    v_mfma_f32_16x16x32_bf16 v[232:235], v[168:171], v[72:75], v[232:235]
    ds_read_b64_tr_b16 v[150:151], v33 offset:10240
    v_mfma_f32_16x16x32_bf16 v[232:235], v[172:175], v[76:79], v[232:235]
    ds_read_b64_tr_b16 v[152:153], v33 offset:16384
    v_mfma_f32_16x16x32_bf16 v[232:235], v[176:179], v[80:83], v[232:235]
    ds_read_b64_tr_b16 v[154:155], v33 offset:18432
    v_mfma_f32_16x16x32_bf16 v[236:239], v[176:179], v[92:95], v[236:239]
    ds_read_b128 v[108:111], v32 offset:3072
    v_mfma_f32_16x16x32_bf16 v[236:239], v[172:175], v[88:91], v[236:239]
    ds_read_b128 v[112:115], v32 offset:4096
    v_mfma_f32_16x16x32_bf16 v[236:239], v[168:171], v[84:87], v[236:239]
    ds_read_b128 v[116:119], v32 offset:5120
    ds_read_b128 v[120:123], v32 offset:6144
    v_mfma_f32_16x16x32_bf16 v[252:255], v[180:183], v[84:87], v[252:255]
    ds_read_b128 v[124:127], v32 offset:7168
    v_mfma_f32_16x16x32_bf16 v[252:255], v[184:187], v[88:91], v[252:255]
    ds_read_b128 v[128:131], v32 offset:8192
    v_mfma_f32_16x16x32_bf16 v[252:255], v[188:191], v[92:95], v[252:255]
    ds_read_b128 v[132:135], v32 offset:9216
    v_mfma_f32_16x16x32_bf16 v[248:251], v[188:191], v[80:83], v[248:251]
    ds_read_b128 v[136:139], v32 offset:10240
    v_mfma_f32_16x16x32_bf16 v[248:251], v[184:187], v[76:79], v[248:251]
    ds_read_b128 v[140:143], v32 offset:11264
    v_mfma_f32_16x16x32_bf16 v[248:251], v[180:183], v[72:75], v[248:251]
    ds_read_b64_tr_b16 v[156:157], v34 offset:0
    v_mfma_f32_16x16x32_bf16 v[244:247], v[180:183], v[60:63], v[244:247]
    ds_read_b64_tr_b16 v[158:159], v34 offset:2048
    v_mfma_f32_16x16x32_bf16 v[244:247], v[184:187], v[64:67], v[244:247]
    ds_read_b64_tr_b16 v[160:161], v34 offset:8192
    v_mfma_f32_16x16x32_bf16 v[244:247], v[188:191], v[68:71], v[244:247]
    ds_read_b64_tr_b16 v[162:163], v34 offset:10240
    v_mfma_f32_16x16x32_bf16 v[240:243], v[188:191], v[56:59], v[240:243]
    ds_read_b64_tr_b16 v[164:165], v34 offset:16384
    v_mfma_f32_16x16x32_bf16 v[240:243], v[184:187], v[52:55], v[240:243]
    ds_read_b64_tr_b16 v[166:167], v34 offset:18432
    v_mfma_f32_16x16x32_bf16 v[240:243], v[180:183], v[48:51], v[240:243]
    s_sub_u32 s31, s31, 2
    s_bitcmp1_b32 0x7feffe, s31
    s_cbranch_scc1 gated_mix__softmax_full_mha__mixer_s_mlp__prompt_kernel_gl88
    s_cmp_lg_u32 s31, 0
    s_cbranch_scc1 gated_mix__softmax_full_mha__mixer_s_mlp__prompt_kernel_gev90
    s_waitcnt lgkmcnt(9)
    v_and_b32 v128, 15, v0
    s_lshl_b32 s4, s54, 11
    s_lshl_b32 s5, s25, 10
    s_add_u32 s4, s4, s5
    s_add_u32 s4, s4, 42991628
    v_lshlrev_b32 v36, 4, v128
    buffer_load_dword v2, v36, s[16:19], s4 offen offset:0 sc1
    s_waitcnt vmcnt(2)
    buffer_load_dword v4, v36, s[16:19], s4 offen offset:256 sc1
    buffer_load_dword v6, v36, s[16:19], s4 offen offset:512 sc1
    s_waitcnt vmcnt(3)
    buffer_load_dword v8, v36, s[16:19], s4 offen offset:768 sc1
    s_lshl_b32 s3, s54, 4
    s_mov_b32 s4, s55
    s_add_u32 s3, s3, s4
    s_lshl_b32 s3, s3, 2
    s_add_u32 s3, s3, s24
    s_lshl_b32 s3, s3, 13
    s_add_u32 s3, s3, 50331648
    s_add_u32 s4, s3, 4096
    v_cvt_pk_bf16_f32 v144, v192, v193
    v_cvt_pk_bf16_f32 v145, v194, v195
    v_cvt_pk_bf16_f32 v146, v208, v209
    v_cvt_pk_bf16_f32 v147, v210, v211
    v_min_u32 v144, -2, v144
    v_min_u32 v145, -2, v145
    v_min_u32 v146, -2, v146
    v_min_u32 v147, -2, v147
    buffer_store_dwordx4 v[144:147], v1, s[16:19], s3 offen offset:0 sc1
    v_cvt_pk_bf16_f32 v148, v196, v197
    v_cvt_pk_bf16_f32 v149, v198, v199
    v_cvt_pk_bf16_f32 v150, v212, v213
    v_cvt_pk_bf16_f32 v151, v214, v215
    v_min_u32 v148, -2, v148
    v_min_u32 v149, -2, v149
    v_min_u32 v150, -2, v150
    v_min_u32 v151, -2, v151
    buffer_store_dwordx4 v[148:151], v1, s[16:19], s3 offen offset:1024 sc1
    v_cvt_pk_bf16_f32 v152, v200, v201
    v_cvt_pk_bf16_f32 v153, v202, v203
    v_cvt_pk_bf16_f32 v154, v216, v217
    v_cvt_pk_bf16_f32 v155, v218, v219
    v_min_u32 v152, -2, v152
    v_min_u32 v153, -2, v153
    v_min_u32 v154, -2, v154
    v_min_u32 v155, -2, v155
    buffer_store_dwordx4 v[152:155], v1, s[16:19], s3 offen offset:2048 sc1
    s_waitcnt lgkmcnt(5)
    v_cvt_pk_bf16_f32 v156, v204, v205
    v_cvt_pk_bf16_f32 v157, v206, v207
    s_waitcnt lgkmcnt(4)
    v_cvt_pk_bf16_f32 v158, v220, v221
    v_cvt_pk_bf16_f32 v159, v222, v223
    v_min_u32 v156, -2, v156
    v_min_u32 v157, -2, v157
    v_min_u32 v158, -2, v158
    v_min_u32 v159, -2, v159
    buffer_store_dwordx4 v[156:159], v1, s[16:19], s3 offen offset:3072 sc1
    s_waitcnt lgkmcnt(0)
    v_and_b32 v128, 15, v0
    v_lshrrev_b32 v129, 4, v0
    v_bfe_u32 v130, v0, 2, 2
    v_and_b32 v131, 3, v0
    s_lshl_b32 s3, s25, 14
    s_add_u32 s3, s3, s32
    v_add_u32 v32, s3, v1
    v_lshrrev_b32 v132, 1, v129
    v_lshl_add_u32 v132, v132, 4, v130
    v_and_b32 v133, 1, v129
    v_lshl_add_u32 v132, v133, 2, v132
    v_lshlrev_b32 v132, 7, v132
    v_lshrrev_b32 v133, 1, v130
    v_and_b32 v134, 1, v129
    v_lshl_or_b32 v133, v134, 1, v133
    s_lshl_b32 s3, s26, 1
    v_xor_b32 v133, s3, v133
    v_lshl_add_u32 v132, v133, 5, v132
    v_lshl_add_u32 v132, v131, 3, v132
    s_add_u32 s3, s32, 32768
    v_add_u32 v34, s3, v132
    v_xor_b32 v35, 32, v34
    ds_read_b128 v[48:51], v32 offset:0
    ds_read_b128 v[52:55], v32 offset:1024
    ds_read_b64_tr_b16 v[80:81], v34 offset:0
    ds_read_b64_tr_b16 v[82:83], v34 offset:1024
    ds_read_b64_tr_b16 v[84:85], v34 offset:4096
    ds_read_b64_tr_b16 v[86:87], v34 offset:5120
    ds_read_b128 v[56:59], v32 offset:4096
    ds_read_b128 v[60:63], v32 offset:5120
    ds_read_b128 v[64:67], v32 offset:8192
    ds_read_b128 v[68:71], v32 offset:9216
    ds_read_b128 v[72:75], v32 offset:12288
    ds_read_b128 v[76:79], v32 offset:13312
    ds_read_b64_tr_b16 v[88:89], v35 offset:0
    ds_read_b64_tr_b16 v[90:91], v35 offset:1024
    ds_read_b64_tr_b16 v[92:93], v35 offset:4096
    ds_read_b64_tr_b16 v[94:95], v35 offset:5120
    s_waitcnt lgkmcnt(12)
    v_mfma_f32_16x16x32_bf16 v[224:227], v[80:83], v[48:51], v[224:227]
    ds_read_b128 v[96:99], v32 offset:2048
    s_waitcnt lgkmcnt(11)
    v_mfma_f32_16x16x32_bf16 v[224:227], v[84:87], v[52:55], v[224:227]
    ds_read_b128 v[100:103], v32 offset:3072
    s_waitcnt lgkmcnt(10)
    v_mfma_f32_16x16x32_bf16 v[228:231], v[84:87], v[60:63], v[228:231]
    ds_read_b64_tr_b16 v[128:129], v34 offset:8192
    v_mfma_f32_16x16x32_bf16 v[228:231], v[80:83], v[56:59], v[228:231]
    ds_read_b64_tr_b16 v[130:131], v34 offset:9216
    s_waitcnt lgkmcnt(11)
    v_mfma_f32_16x16x32_bf16 v[232:235], v[80:83], v[64:67], v[232:235]
    ds_read_b64_tr_b16 v[132:133], v34 offset:12288
    s_waitcnt lgkmcnt(11)
    v_mfma_f32_16x16x32_bf16 v[232:235], v[84:87], v[68:71], v[232:235]
    ds_read_b64_tr_b16 v[134:135], v34 offset:13312
    s_waitcnt lgkmcnt(10)
    v_mfma_f32_16x16x32_bf16 v[236:239], v[84:87], v[76:79], v[236:239]
    ds_read_b128 v[104:107], v32 offset:6144
    v_mfma_f32_16x16x32_bf16 v[236:239], v[80:83], v[72:75], v[236:239]
    ds_read_b128 v[108:111], v32 offset:7168
    s_waitcnt lgkmcnt(10)
    v_mfma_f32_16x16x32_bf16 v[252:255], v[88:91], v[72:75], v[252:255]
    ds_read_b128 v[112:115], v32 offset:10240
    s_waitcnt lgkmcnt(9)
    v_mfma_f32_16x16x32_bf16 v[252:255], v[92:95], v[76:79], v[252:255]
    ds_read_b128 v[116:119], v32 offset:11264
    v_mfma_f32_16x16x32_bf16 v[248:251], v[92:95], v[68:71], v[248:251]
    ds_read_b128 v[120:123], v32 offset:14336
    v_mfma_f32_16x16x32_bf16 v[248:251], v[88:91], v[64:67], v[248:251]
    ds_read_b128 v[124:127], v32 offset:15360
    v_mfma_f32_16x16x32_bf16 v[244:247], v[88:91], v[56:59], v[244:247]
    ds_read_b64_tr_b16 v[136:137], v35 offset:8192
    v_mfma_f32_16x16x32_bf16 v[244:247], v[92:95], v[60:63], v[244:247]
    ds_read_b64_tr_b16 v[138:139], v35 offset:9216
    v_mfma_f32_16x16x32_bf16 v[240:243], v[92:95], v[52:55], v[240:243]
    ds_read_b64_tr_b16 v[140:141], v35 offset:12288
    v_mfma_f32_16x16x32_bf16 v[240:243], v[88:91], v[48:51], v[240:243]
    ds_read_b64_tr_b16 v[142:143], v35 offset:13312
    s_waitcnt lgkmcnt(12)
    v_mfma_f32_16x16x32_bf16 v[224:227], v[128:131], v[96:99], v[224:227]
    s_add_u32 s32, s32, 49152
    s_waitcnt lgkmcnt(10)
    v_mfma_f32_16x16x32_bf16 v[224:227], v[132:135], v[100:103], v[224:227]
    s_cmp_eq_u32 s32, 147456
    s_cselect_b32 s33, s39, 49152
    s_waitcnt lgkmcnt(8)
    v_mfma_f32_16x16x32_bf16 v[228:231], v[132:135], v[108:111], v[228:231]
    s_cselect_b32 s32, 0, s32
    v_add_u32 v32, s33, v32
    v_mfma_f32_16x16x32_bf16 v[228:231], v[128:131], v[104:107], v[228:231]
    v_add_u32 v34, s33, v34
    v_add_u32 v35, s33, v35
    s_waitcnt lgkmcnt(0)
    s_barrier
    v_mfma_f32_16x16x32_bf16 v[232:235], v[128:131], v[112:115], v[232:235]
    ds_read_b128 v[48:51], v32 offset:2048
    ds_read_b128 v[52:55], v32 offset:3072
    v_mfma_f32_16x16x32_bf16 v[232:235], v[132:135], v[116:119], v[232:235]
    ds_read_b64_tr_b16 v[80:81], v34 offset:8192
    ds_read_b64_tr_b16 v[82:83], v34 offset:9216
    v_mfma_f32_16x16x32_bf16 v[236:239], v[132:135], v[124:127], v[236:239]
    ds_read_b64_tr_b16 v[84:85], v34 offset:12288
    ds_read_b64_tr_b16 v[86:87], v34 offset:13312
    v_mfma_f32_16x16x32_bf16 v[236:239], v[128:131], v[120:123], v[236:239]
    ds_read_b128 v[56:59], v32 offset:6144
    ds_read_b128 v[60:63], v32 offset:7168
    v_mfma_f32_16x16x32_bf16 v[252:255], v[136:139], v[120:123], v[252:255]
    ds_read_b128 v[64:67], v32 offset:10240
    ds_read_b128 v[68:71], v32 offset:11264
    v_mfma_f32_16x16x32_bf16 v[252:255], v[140:143], v[124:127], v[252:255]
    ds_read_b128 v[72:75], v32 offset:14336
    ds_read_b128 v[76:79], v32 offset:15360
    v_mfma_f32_16x16x32_bf16 v[248:251], v[140:143], v[116:119], v[248:251]
    ds_read_b64_tr_b16 v[88:89], v35 offset:8192
    ds_read_b64_tr_b16 v[90:91], v35 offset:9216
    v_mfma_f32_16x16x32_bf16 v[248:251], v[136:139], v[112:115], v[248:251]
    ds_read_b64_tr_b16 v[92:93], v35 offset:12288
    ds_read_b64_tr_b16 v[94:95], v35 offset:13312
    v_mfma_f32_16x16x32_bf16 v[244:247], v[136:139], v[104:107], v[244:247]
    v_mfma_f32_16x16x32_bf16 v[244:247], v[140:143], v[108:111], v[244:247]
    v_mfma_f32_16x16x32_bf16 v[240:243], v[140:143], v[100:103], v[240:243]
    v_mfma_f32_16x16x32_bf16 v[240:243], v[136:139], v[96:99], v[240:243]
    s_lshl_b32 s3, s54, 4
    s_xor_b32 s4, s55, 1
    s_add_u32 s3, s3, s4
    s_lshl_b32 s3, s3, 2
    s_add_u32 s3, s3, s24
    s_lshl_b32 s3, s3, 13
    s_add_u32 s49, s3, 50331648
    buffer_load_dwordx4 v[160:163], v1, s[16:19], s49 offen offset:0 sc1
    buffer_load_dwordx4 v[164:167], v1, s[16:19], s49 offen offset:1024 sc1
    buffer_load_dwordx4 v[168:171], v1, s[16:19], s49 offen offset:2048 sc1
    buffer_load_dwordx4 v[172:175], v1, s[16:19], s49 offen offset:3072 sc1
    s_add_u32 s32, s32, 49152
    s_cmp_eq_u32 s32, 147456
    s_cselect_b32 s33, s39, 49152
    s_cselect_b32 s32, 0, s32
    s_waitcnt lgkmcnt(12)
    v_mfma_f32_16x16x32_bf16 v[224:227], v[80:83], v[48:51], v[224:227]
    s_waitcnt lgkmcnt(10)
    v_mfma_f32_16x16x32_bf16 v[224:227], v[84:87], v[52:55], v[224:227]
    s_waitcnt lgkmcnt(8)
    v_mfma_f32_16x16x32_bf16 v[228:231], v[84:87], v[60:63], v[228:231]
    v_mfma_f32_16x16x32_bf16 v[228:231], v[80:83], v[56:59], v[228:231]
    s_waitcnt lgkmcnt(7)
    v_mfma_f32_16x16x32_bf16 v[232:235], v[80:83], v[64:67], v[232:235]
    s_waitcnt lgkmcnt(6)
    v_mfma_f32_16x16x32_bf16 v[232:235], v[84:87], v[68:71], v[232:235]
    s_waitcnt lgkmcnt(4)
    v_mfma_f32_16x16x32_bf16 v[236:239], v[84:87], v[76:79], v[236:239]
    v_mfma_f32_16x16x32_bf16 v[236:239], v[80:83], v[72:75], v[236:239]
    s_waitcnt lgkmcnt(2)
    v_mfma_f32_16x16x32_bf16 v[252:255], v[88:91], v[72:75], v[252:255]
    s_waitcnt lgkmcnt(0)
    v_mfma_f32_16x16x32_bf16 v[252:255], v[92:95], v[76:79], v[252:255]
    v_mfma_f32_16x16x32_bf16 v[248:251], v[92:95], v[68:71], v[248:251]
    v_mfma_f32_16x16x32_bf16 v[248:251], v[88:91], v[64:67], v[248:251]
    v_mfma_f32_16x16x32_bf16 v[244:247], v[88:91], v[56:59], v[244:247]
    v_mfma_f32_16x16x32_bf16 v[244:247], v[92:95], v[60:63], v[244:247]
    v_mfma_f32_16x16x32_bf16 v[240:243], v[92:95], v[52:55], v[240:243]
    v_mfma_f32_16x16x32_bf16 v[240:243], v[88:91], v[48:51], v[240:243]
    s_barrier
    s_mul_i32 s3, s24, 12288
    s_add_u32 s3, s3, s32
    v_add_u32 v37, s3, v1
    ds_read_b128 v[96:99], v37 offset:0
    ds_read_b128 v[100:103], v37 offset:1024
    ds_read_b128 v[104:107], v37 offset:2048
    ds_read_b128 v[108:111], v37 offset:3072
    s_mov_b32 s20, s82
    s_mov_b32 s21, s83
    s_mov_b32 s22, 4194304
    s_mov_b32 s23, 0x20000
    v_and_b32 v128, 15, v0
    v_lshrrev_b32 v129, 4, v0
    s_lshl_b32 s3, s54, 7
    s_lshl_b32 s4, s25, 6
    s_add_u32 s3, s3, s4
    v_add_u32 v36, s3, v128
    v_lshlrev_b32 v36, 11, v36
    v_and_b32 v130, 1, v129
    v_lshrrev_b32 v131, 1, v129
    v_lshl_add_u32 v36, v130, 5, v36
    v_lshl_add_u32 v36, v131, 4, v36
    s_lshl_b32 s3, s55, 7
    s_lshl_b32 s4, s26, 6
    s_add_u32 s42, s3, s4
    s_waitcnt lgkmcnt(3)
    v_lshlrev_b32 v48, 16, v96
    v_and_b32 v49, 0xffff0000, v96
    s_waitcnt vmcnt(11)
    v_pk_fma_f32 v[224:225], v[48:49], v[2:3], v[224:225] op_sel_hi:[1,0,1]
    v_lshlrev_b32 v48, 16, v97
    v_and_b32 v49, 0xffff0000, v97
    v_pk_fma_f32 v[226:227], v[48:49], v[2:3], v[226:227] op_sel_hi:[1,0,1]
    v_lshlrev_b32 v48, 16, v98
    v_and_b32 v49, 0xffff0000, v98
    v_pk_fma_f32 v[240:241], v[48:49], v[2:3], v[240:241] op_sel_hi:[1,0,1]
    v_lshlrev_b32 v48, 16, v99
    v_and_b32 v49, 0xffff0000, v99
    v_pk_fma_f32 v[242:243], v[48:49], v[2:3], v[242:243] op_sel_hi:[1,0,1]
    s_waitcnt lgkmcnt(2)
    v_lshlrev_b32 v48, 16, v100
    v_and_b32 v49, 0xffff0000, v100
    s_waitcnt vmcnt(10)
    v_pk_fma_f32 v[228:229], v[48:49], v[4:5], v[228:229] op_sel_hi:[1,0,1]
    v_lshlrev_b32 v48, 16, v101
    v_and_b32 v49, 0xffff0000, v101
    v_pk_fma_f32 v[230:231], v[48:49], v[4:5], v[230:231] op_sel_hi:[1,0,1]
    v_lshlrev_b32 v48, 16, v102
    v_and_b32 v49, 0xffff0000, v102
    v_pk_fma_f32 v[244:245], v[48:49], v[4:5], v[244:245] op_sel_hi:[1,0,1]
    v_lshlrev_b32 v48, 16, v103
    v_and_b32 v49, 0xffff0000, v103
    v_pk_fma_f32 v[246:247], v[48:49], v[4:5], v[246:247] op_sel_hi:[1,0,1]
    s_waitcnt lgkmcnt(1)
    v_lshlrev_b32 v48, 16, v104
    v_and_b32 v49, 0xffff0000, v104
    s_waitcnt vmcnt(9)
    v_pk_fma_f32 v[232:233], v[48:49], v[6:7], v[232:233] op_sel_hi:[1,0,1]
    v_lshlrev_b32 v48, 16, v105
    v_and_b32 v49, 0xffff0000, v105
    v_pk_fma_f32 v[234:235], v[48:49], v[6:7], v[234:235] op_sel_hi:[1,0,1]
    v_lshlrev_b32 v48, 16, v106
    v_and_b32 v49, 0xffff0000, v106
    v_pk_fma_f32 v[248:249], v[48:49], v[6:7], v[248:249] op_sel_hi:[1,0,1]
    v_lshlrev_b32 v48, 16, v107
    v_and_b32 v49, 0xffff0000, v107
    v_pk_fma_f32 v[250:251], v[48:49], v[6:7], v[250:251] op_sel_hi:[1,0,1]
    s_waitcnt lgkmcnt(0)
    v_lshlrev_b32 v48, 16, v108
    v_and_b32 v49, 0xffff0000, v108
    s_waitcnt vmcnt(8)
    v_pk_fma_f32 v[236:237], v[48:49], v[8:9], v[236:237] op_sel_hi:[1,0,1]
    v_lshlrev_b32 v48, 16, v109
    v_and_b32 v49, 0xffff0000, v109
    v_pk_fma_f32 v[238:239], v[48:49], v[8:9], v[238:239] op_sel_hi:[1,0,1]
    v_lshlrev_b32 v48, 16, v110
    v_and_b32 v49, 0xffff0000, v110
    v_pk_fma_f32 v[252:253], v[48:49], v[8:9], v[252:253] op_sel_hi:[1,0,1]
    v_lshlrev_b32 v48, 16, v111
    v_and_b32 v49, 0xffff0000, v111
    v_pk_fma_f32 v[254:255], v[48:49], v[8:9], v[254:255] op_sel_hi:[1,0,1]
    s_mov_b32 s5, 100000
gated_mix__softmax_full_mha__mixer_s_mlp__prompt_kernel_xw91:
    s_waitcnt vmcnt(3)
    v_max3_u32 v50, v160, v161, v162
    s_waitcnt vmcnt(2)
    v_max3_u32 v50, v50, v163, v164
    v_max3_u32 v50, v50, v165, v166
    s_waitcnt vmcnt(1)
    v_max3_u32 v50, v50, v167, v168
    v_max3_u32 v50, v50, v169, v170
    s_waitcnt vmcnt(0)
    v_max3_u32 v50, v50, v171, v172
    v_max3_u32 v50, v50, v173, v174
    v_max_u32 v50, v50, v175
    v_cmp_eq_u32 vcc, -1, v50
    s_nop 4
    s_cbranch_vccz gated_mix__softmax_full_mha__mixer_s_mlp__prompt_kernel_xwe92
    s_sub_u32 s5, s5, 1
    s_cmp_eq_u32 s5, 0
    s_cbranch_scc1 gated_mix__softmax_full_mha__mixer_s_mlp__prompt_kernel_xwe92
    s_sleep 2
    buffer_load_dwordx4 v[160:163], v1, s[16:19], s49 offen offset:0 sc1
    buffer_load_dwordx4 v[164:167], v1, s[16:19], s49 offen offset:1024 sc1
    buffer_load_dwordx4 v[168:171], v1, s[16:19], s49 offen offset:2048 sc1
    buffer_load_dwordx4 v[172:175], v1, s[16:19], s49 offen offset:3072 sc1
    s_waitcnt vmcnt(0)
    s_branch gated_mix__softmax_full_mha__mixer_s_mlp__prompt_kernel_xw91
gated_mix__softmax_full_mha__mixer_s_mlp__prompt_kernel_xwe92:
    v_lshlrev_b32 v48, 16, v160
    v_and_b32 v49, 0xffff0000, v160
    v_lshlrev_b32 v50, 16, v161
    v_and_b32 v51, 0xffff0000, v161
    v_lshlrev_b32 v52, 16, v162
    v_and_b32 v53, 0xffff0000, v162
    v_lshlrev_b32 v54, 16, v163
    v_and_b32 v55, 0xffff0000, v163
    v_pk_add_f32 v[224:225], v[224:225], v[48:49]
    v_pk_add_f32 v[226:227], v[226:227], v[50:51]
    v_pk_add_f32 v[240:241], v[240:241], v[52:53]
    v_pk_add_f32 v[242:243], v[242:243], v[54:55]
    v_cvt_pk_bf16_f32 v72, v224, v225
    v_cvt_pk_bf16_f32 v73, v226, v227
    v_cvt_pk_bf16_f32 v74, v240, v241
    v_cvt_pk_bf16_f32 v75, v242, v243
    s_nop 0
    v_permlane16_swap_b32 v72, v74
    v_permlane16_swap_b32 v73, v75
    buffer_store_dwordx4 v[72:75], v36, s[20:23], s42 offen nt
    s_add_u32 s42, s42, 32768
    v_lshlrev_b32 v48, 16, v164
    v_and_b32 v49, 0xffff0000, v164
    v_lshlrev_b32 v50, 16, v165
    v_and_b32 v51, 0xffff0000, v165
    v_lshlrev_b32 v52, 16, v166
    v_and_b32 v53, 0xffff0000, v166
    v_lshlrev_b32 v54, 16, v167
    v_and_b32 v55, 0xffff0000, v167
    v_pk_add_f32 v[228:229], v[228:229], v[48:49]
    v_pk_add_f32 v[230:231], v[230:231], v[50:51]
    v_pk_add_f32 v[244:245], v[244:245], v[52:53]
    v_pk_add_f32 v[246:247], v[246:247], v[54:55]
    v_cvt_pk_bf16_f32 v76, v228, v229
    v_cvt_pk_bf16_f32 v77, v230, v231
    v_cvt_pk_bf16_f32 v78, v244, v245
    v_cvt_pk_bf16_f32 v79, v246, v247
    s_nop 0
    v_permlane16_swap_b32 v76, v78
    v_permlane16_swap_b32 v77, v79
    buffer_store_dwordx4 v[76:79], v36, s[20:23], s42 offen nt
    s_add_u32 s42, s42, 32768
    v_lshlrev_b32 v48, 16, v168
    v_and_b32 v49, 0xffff0000, v168
    v_lshlrev_b32 v50, 16, v169
    v_and_b32 v51, 0xffff0000, v169
    v_lshlrev_b32 v52, 16, v170
    v_and_b32 v53, 0xffff0000, v170
    v_lshlrev_b32 v54, 16, v171
    v_and_b32 v55, 0xffff0000, v171
    v_pk_add_f32 v[232:233], v[232:233], v[48:49]
    v_pk_add_f32 v[234:235], v[234:235], v[50:51]
    v_pk_add_f32 v[248:249], v[248:249], v[52:53]
    v_pk_add_f32 v[250:251], v[250:251], v[54:55]
    v_cvt_pk_bf16_f32 v80, v232, v233
    v_cvt_pk_bf16_f32 v81, v234, v235
    v_cvt_pk_bf16_f32 v82, v248, v249
    v_cvt_pk_bf16_f32 v83, v250, v251
    s_nop 0
    v_permlane16_swap_b32 v80, v82
    v_permlane16_swap_b32 v81, v83
    buffer_store_dwordx4 v[80:83], v36, s[20:23], s42 offen nt
    s_add_u32 s42, s42, 32768
    v_lshlrev_b32 v48, 16, v172
    v_and_b32 v49, 0xffff0000, v172
    v_lshlrev_b32 v50, 16, v173
    v_and_b32 v51, 0xffff0000, v173
    v_lshlrev_b32 v52, 16, v174
    v_and_b32 v53, 0xffff0000, v174
    v_lshlrev_b32 v54, 16, v175
    v_and_b32 v55, 0xffff0000, v175
    v_pk_add_f32 v[236:237], v[236:237], v[48:49]
    v_pk_add_f32 v[238:239], v[238:239], v[50:51]
    v_pk_add_f32 v[252:253], v[252:253], v[52:53]
    v_pk_add_f32 v[254:255], v[254:255], v[54:55]
    v_cvt_pk_bf16_f32 v84, v236, v237
    v_cvt_pk_bf16_f32 v85, v238, v239
    v_cvt_pk_bf16_f32 v86, v252, v253
    v_cvt_pk_bf16_f32 v87, v254, v255
    s_nop 0
    v_permlane16_swap_b32 v84, v86
    v_permlane16_swap_b32 v85, v87
    buffer_store_dwordx4 v[84:87], v36, s[20:23], s42 offen nt
    s_endpgm
gated_mix__softmax_full_mha__mixer_s_mlp__prompt_kernel_fbk39:
    s_lshl_b32 s5, s51, 18
    s_add_u32 s5, s5, 4194304
    s_mov_b32 s6, s5
    s_mov_b32 s7, 64
    v_mov_b32 v248, 0xff800000
gated_mix__softmax_full_mha__mixer_s_mlp__prompt_kernel_fb93:
    buffer_load_dwordx4 v[96:99], v1, s[16:19], s6 offen sc1
    buffer_load_dwordx4 v[100:103], v1, s[16:19], s6 offen offset:1024 sc1
    s_waitcnt vmcnt(0)
    v_mfma_f32_32x32x16_bf16 v[64:79], v[96:99], v[224:227], 0
    v_mfma_f32_32x32x16_bf16 v[64:79], v[100:103], v[228:231], v[64:79]
    s_nop 11
    v_max3_f32 v248, v248, v64, v65
    v_max3_f32 v248, v248, v66, v67
    v_max3_f32 v248, v248, v68, v69
    v_max3_f32 v248, v248, v70, v71
    v_max3_f32 v248, v248, v72, v73
    v_max3_f32 v248, v248, v74, v75
    v_max3_f32 v248, v248, v76, v77
    v_max3_f32 v248, v248, v78, v79
    s_add_u32 s6, s6, 4096
    s_sub_u32 s7, s7, 1
    s_cmp_lg_u32 s7, 0
    s_cbranch_scc1 gated_mix__softmax_full_mha__mixer_s_mlp__prompt_kernel_fb93
    v_mov_b32 v128, v248
    s_nop 1
    v_permlane32_swap_b32 v248, v128
    v_max_f32 v248, v248, v128
    v_sub_f32 v248, 0, v248
    s_mov_b32 s7, 64
    v_mov_b32 v48, v248
    v_mov_b32 v49, v248
    v_mov_b32 v50, v248
    v_mov_b32 v51, v248
    v_mov_b32 v52, v248
    v_mov_b32 v53, v248
    v_mov_b32 v54, v248
    v_mov_b32 v55, v248
    v_mov_b32 v56, v248
    v_mov_b32 v57, v248
    v_mov_b32 v58, v248
    v_mov_b32 v59, v248
    v_mov_b32 v60, v248
    v_mov_b32 v61, v248
    v_mov_b32 v62, v248
    v_mov_b32 v63, v248
    v_mov_b32 v192, 0
    v_mov_b32 v193, 0
    v_mov_b32 v194, 0
    v_mov_b32 v195, 0
    v_mov_b32 v196, 0
    v_mov_b32 v197, 0
    v_mov_b32 v198, 0
    v_mov_b32 v199, 0
    v_mov_b32 v200, 0
    v_mov_b32 v201, 0
    v_mov_b32 v202, 0
    v_mov_b32 v203, 0
    v_mov_b32 v204, 0
    v_mov_b32 v205, 0
    v_mov_b32 v206, 0
    v_mov_b32 v207, 0
    v_mov_b32 v240, 0
    v_mov_b32 v241, 0
    v_mov_b32 v242, 0
    v_mov_b32 v243, 0
gated_mix__softmax_full_mha__mixer_s_mlp__prompt_kernel_fb94:
    buffer_load_dwordx4 v[96:99], v1, s[16:19], s5 offen sc1
    buffer_load_dwordx4 v[100:103], v1, s[16:19], s5 offen offset:1024 sc1
    buffer_load_dwordx4 v[104:107], v1, s[16:19], s5 offen offset:2048 sc1
    buffer_load_dwordx4 v[112:115], v1, s[16:19], s5 offen offset:3072 sc1
    s_waitcnt vmcnt(0)
    v_mfma_f32_32x32x16_bf16 v[64:79], v[96:99], v[224:227], v[48:63]
    v_mfma_f32_32x32x16_bf16 v[64:79], v[100:103], v[228:231], v[64:79]
    s_nop 11
    v_exp_f32 v64, v64
    v_exp_f32 v65, v65
    v_exp_f32 v66, v66
    v_exp_f32 v67, v67
    v_exp_f32 v68, v68
    v_exp_f32 v69, v69
    v_exp_f32 v70, v70
    v_exp_f32 v71, v71
    v_exp_f32 v72, v72
    v_exp_f32 v73, v73
    v_exp_f32 v74, v74
    v_exp_f32 v75, v75
    v_exp_f32 v76, v76
    v_exp_f32 v77, v77
    v_exp_f32 v78, v78
    v_exp_f32 v79, v79
    v_cvt_pk_bf16_f32 v120, v64, v65
    v_cvt_pk_bf16_f32 v121, v66, v67
    v_cvt_pk_bf16_f32 v122, v68, v69
    v_cvt_pk_bf16_f32 v123, v70, v71
    v_cvt_pk_bf16_f32 v124, v72, v73
    v_cvt_pk_bf16_f32 v125, v74, v75
    v_cvt_pk_bf16_f32 v126, v76, v77
    v_cvt_pk_bf16_f32 v127, v78, v79
    v_mfma_f32_32x32x16_bf16 v[192:207], v[104:107], v[120:123], v[192:207]
    s_nop 0
    v_mfma_f32_32x32x16_bf16 v[192:207], v[112:115], v[124:127], v[192:207]
    v_smfmac_f32_16x16x64_bf16 v[240:243], v[144:147], v[120:127], v149
    s_add_u32 s5, s5, 4096
    s_sub_u32 s7, s7, 1
    s_cmp_lg_u32 s7, 0
    s_cbranch_scc1 gated_mix__softmax_full_mha__mixer_s_mlp__prompt_kernel_fb94
    s_nop 7
    v_add_f32 v18, v240, v241
    s_branch gated_mix__softmax_full_mha__mixer_s_mlp__prompt_kernel_ok38
gated_mix__softmax_full_mha__mixer_s_mlp__prompt_kernel_fbk41:
    s_lshl_b32 s5, s51, 18
    s_add_u32 s5, s5, 4194304
    s_mov_b32 s6, s5
    s_mov_b32 s7, 64
    v_mov_b32 v249, 0xff800000
gated_mix__softmax_full_mha__mixer_s_mlp__prompt_kernel_fb95:
    buffer_load_dwordx4 v[96:99], v1, s[16:19], s6 offen sc1
    buffer_load_dwordx4 v[100:103], v1, s[16:19], s6 offen offset:1024 sc1
    s_waitcnt vmcnt(0)
    v_mfma_f32_32x32x16_bf16 v[64:79], v[96:99], v[232:235], 0
    v_mfma_f32_32x32x16_bf16 v[64:79], v[100:103], v[236:239], v[64:79]
    s_nop 11
    v_max3_f32 v249, v249, v64, v65
    v_max3_f32 v249, v249, v66, v67
    v_max3_f32 v249, v249, v68, v69
    v_max3_f32 v249, v249, v70, v71
    v_max3_f32 v249, v249, v72, v73
    v_max3_f32 v249, v249, v74, v75
    v_max3_f32 v249, v249, v76, v77
    v_max3_f32 v249, v249, v78, v79
    s_add_u32 s6, s6, 4096
    s_sub_u32 s7, s7, 1
    s_cmp_lg_u32 s7, 0
    s_cbranch_scc1 gated_mix__softmax_full_mha__mixer_s_mlp__prompt_kernel_fb95
    v_mov_b32 v128, v249
    s_nop 1
    v_permlane32_swap_b32 v249, v128
    v_max_f32 v249, v249, v128
    v_sub_f32 v249, 0, v249
    s_mov_b32 s7, 64
    v_mov_b32 v2, v249
    v_mov_b32 v3, v249
    v_mov_b32 v4, v249
    v_mov_b32 v5, v249
    v_mov_b32 v6, v249
    v_mov_b32 v7, v249
    v_mov_b32 v8, v249
    v_mov_b32 v9, v249
    v_mov_b32 v10, v249
    v_mov_b32 v11, v249
    v_mov_b32 v12, v249
    v_mov_b32 v13, v249
    v_mov_b32 v14, v249
    v_mov_b32 v15, v249
    v_mov_b32 v16, v249
    v_mov_b32 v17, v249
    v_mov_b32 v208, 0
    v_mov_b32 v209, 0
    v_mov_b32 v210, 0
    v_mov_b32 v211, 0
    v_mov_b32 v212, 0
    v_mov_b32 v213, 0
    v_mov_b32 v214, 0
    v_mov_b32 v215, 0
    v_mov_b32 v216, 0
    v_mov_b32 v217, 0
    v_mov_b32 v218, 0
    v_mov_b32 v219, 0
    v_mov_b32 v220, 0
    v_mov_b32 v221, 0
    v_mov_b32 v222, 0
    v_mov_b32 v223, 0
    v_mov_b32 v244, 0
    v_mov_b32 v245, 0
    v_mov_b32 v246, 0
    v_mov_b32 v247, 0
gated_mix__softmax_full_mha__mixer_s_mlp__prompt_kernel_fb96:
    buffer_load_dwordx4 v[96:99], v1, s[16:19], s5 offen sc1
    buffer_load_dwordx4 v[100:103], v1, s[16:19], s5 offen offset:1024 sc1
    buffer_load_dwordx4 v[104:107], v1, s[16:19], s5 offen offset:2048 sc1
    buffer_load_dwordx4 v[112:115], v1, s[16:19], s5 offen offset:3072 sc1
    s_waitcnt vmcnt(0)
    v_mfma_f32_32x32x16_bf16 v[64:79], v[96:99], v[232:235], v[2:17]
    v_mfma_f32_32x32x16_bf16 v[64:79], v[100:103], v[236:239], v[64:79]
    s_nop 11
    v_exp_f32 v64, v64
    v_exp_f32 v65, v65
    v_exp_f32 v66, v66
    v_exp_f32 v67, v67
    v_exp_f32 v68, v68
    v_exp_f32 v69, v69
    v_exp_f32 v70, v70
    v_exp_f32 v71, v71
    v_exp_f32 v72, v72
    v_exp_f32 v73, v73
    v_exp_f32 v74, v74
    v_exp_f32 v75, v75
    v_exp_f32 v76, v76
    v_exp_f32 v77, v77
    v_exp_f32 v78, v78
    v_exp_f32 v79, v79
    v_cvt_pk_bf16_f32 v120, v64, v65
    v_cvt_pk_bf16_f32 v121, v66, v67
    v_cvt_pk_bf16_f32 v122, v68, v69
    v_cvt_pk_bf16_f32 v123, v70, v71
    v_cvt_pk_bf16_f32 v124, v72, v73
    v_cvt_pk_bf16_f32 v125, v74, v75
    v_cvt_pk_bf16_f32 v126, v76, v77
    v_cvt_pk_bf16_f32 v127, v78, v79
    v_mfma_f32_32x32x16_bf16 v[208:223], v[104:107], v[120:123], v[208:223]
    s_nop 0
    v_mfma_f32_32x32x16_bf16 v[208:223], v[112:115], v[124:127], v[208:223]
    v_smfmac_f32_16x16x64_bf16 v[244:247], v[144:147], v[120:127], v149
    s_add_u32 s5, s5, 4096
    s_sub_u32 s7, s7, 1
    s_cmp_lg_u32 s7, 0
    s_cbranch_scc1 gated_mix__softmax_full_mha__mixer_s_mlp__prompt_kernel_fb96
    s_nop 7
    v_add_f32 v19, v244, v245
    s_branch gated_mix__softmax_full_mha__mixer_s_mlp__prompt_kernel_ok40
gated_mix__softmax_full_mha__mixer_s_mlp__prompt_kernel_gev51:
    s_waitcnt vmcnt(0)
    s_lshl_b32 s3, s24, 2
    v_mov_b32 v28, s3
    v_mov_b32 v29, 1
    s_mov_b64 exec, 1
    buffer_store_dword v29, v28, s[16:19], s94 offen sc1
    s_mov_b64 exec, -1
    s_branch gated_mix__softmax_full_mha__mixer_s_mlp__prompt_kernel_gl49
gated_mix__softmax_full_mha__mixer_s_mlp__prompt_kernel_gev90:
    s_cmp_eq_u32 s24, 0
    s_cbranch_scc0 gated_mix__softmax_full_mha__mixer_s_mlp__prompt_kernel_pub99
    v_lshlrev_b32 v28, 2, v0
    v_mov_b32 v29, 1
    s_mov_b64 exec, 15
    buffer_store_dword v29, v28, s[16:19], s92 offen sc1
    s_mov_b64 exec, -1
gated_mix__softmax_full_mha__mixer_s_mlp__prompt_kernel_pub99:
    s_branch gated_mix__softmax_full_mha__mixer_s_mlp__prompt_kernel_gl88
gated_mix__softmax_full_mha__mixer_s_mlp__prompt_kernel_end:
    s_endpgm

.section .rodata,"a"
.p2align 6
.amdhsa_kernel gated_mix__softmax_full_mha__mixer_s_mlp__prompt_kernel
  .amdhsa_next_free_vgpr 256
  .amdhsa_next_free_sgpr 102
  .amdhsa_accum_offset 256
  .amdhsa_group_segment_fixed_size 0
  .amdhsa_kernarg_size 96
  .amdhsa_user_sgpr_count 2
  .amdhsa_user_sgpr_kernarg_segment_ptr 1
  .amdhsa_system_sgpr_workgroup_id_x 1
.end_amdhsa_kernel
```
